```python
import torch

def _softmax(x, axis=-1):
    return torch.softmax(x, dim=axis)
def _gelu(x):
    return torch.nn.functional.gelu(x, approximate="tanh")
def _silu(x):
    return torch.nn.functional.silu(x)
def _sigmoid(x):
    return torch.sigmoid(x)
def _layernorm(x, axis=-1, eps=1e-5):
    m = x.mean(dim=axis, keepdim=True)
    v = x.var(dim=axis, keepdim=True, unbiased=False)
    return (x - m) / torch.sqrt(v + eps)
def _scatter_add(tgt, idx, src, axis=0):
    return tgt.clone().index_add_(axis, idx, src)
def _segment_sum(src, seg, n):
    out = torch.zeros((n,) + src.shape[1:], dtype=src.dtype)
    return out.index_add_(0, seg, src)
def _pad(x, pw):
    flat = tuple(v for pair in reversed(pw) for v in pair)
    return torch.nn.functional.pad(x, flat)

kernel_name = 'interleave_layers__mha_block_cached__glu_gated_bilinear__decode'

def setup_inputs():

    _w = (lambda a: (lambda t: t.to(torch.bfloat16) if t.is_floating_point() else t)(torch.as_tensor(a)))
    def _A_setup():
        B, Sq, D = 2, 1, 448
        H, Sk, Dh = 16, 8192, 256
        return {
            "x": _w((lambda *s: torch.randn(*s, dtype=torch.bfloat16) * 0.05)(B, Sq, D)),
            "k_cache": _w((lambda *s: torch.randn(*s, dtype=torch.bfloat16) * 0.8)(B, H, Sk, Dh)),
            "v_cache": _w((lambda *s: torch.randn(*s, dtype=torch.bfloat16) * 1.6)(B, H, Sk, Dh)),
            "wq": _w((lambda *s: torch.randn(*s, dtype=torch.bfloat16) * 0.8)(D, H * Dh) * (D ** -0.5)),
            "wo": _w((lambda *s: torch.randn(*s, dtype=torch.bfloat16) * 1.6)(H * Dh, D) * ((H * Dh) ** -0.5)),
        }
    _A_in = _A_setup()

    def _B_setup():
        B, S, D, F = 2, 1, 448, 1792
        return {
            "x": _w((lambda *s: torch.randn(*s, dtype=torch.bfloat16) * 0.05)(B, S, D)),
            "w_gate": _w((lambda *s: torch.randn(*s, dtype=torch.bfloat16) * 0.4)(D, F) * (D ** -0.5)),
            "w_up": _w((lambda *s: torch.randn(*s, dtype=torch.bfloat16) * 0.4)(D, F) * (D ** -0.5)),
            "w_down": _w((lambda *s: torch.randn(*s, dtype=torch.bfloat16) * 0.4)(F, D) * (F ** -0.5)),
        }
    _B_in = _B_setup()

    return {
        "A_x": _A_in["x"],
        "A_k_cache": _A_in["k_cache"],
        "A_v_cache": _A_in["v_cache"],
        "A_wq": _A_in["wq"],
        "A_wo": _A_in["wo"],
        "B_x": _B_in["x"],
        "B_w_gate": _B_in["w_gate"],
        "B_w_up": _B_in["w_up"],
        "B_w_down": _B_in["w_down"],
    }

def reference(A_x, A_k_cache, A_v_cache, A_wq, A_wo, B_x, B_w_gate, B_w_up, B_w_down):
    def _A_ref(x, k_cache, v_cache, wq, wo):
        B, Sq, D = x.shape
        H, Dh = 16, 256
        q = (lambda x, *d: x.permute(*d))((x @ wq).reshape(B, Sq, H, Dh), 0, 2, 1, 3)
        scores = torch.einsum("bhqd,bhkd->bhqk", q, k_cache) * (Dh ** -0.5)
        p = _softmax(scores, axis=-1)
        o = torch.einsum("bhqk,bhkd->bhqd", p, v_cache)
        return (lambda x, *d: x.permute(*d))(o, 0, 2, 1, 3).reshape(B, Sq, H * Dh) @ wo

    def _B_ref(x, w_gate, w_up, w_down):
        g = torch.einsum("bsd,df->bsf", x, w_gate)
        u = torch.einsum("bsd,df->bsf", x, w_up)
        h = g * u
        return torch.einsum("bsf,fd->bsd", h, w_down)

    x = A_x
    x = x + _A_ref(_layernorm(x, axis=-1), A_k_cache, A_v_cache, A_wq, A_wo)
    x = x + _B_ref(_layernorm(x, axis=-1), B_w_gate, B_w_up, B_w_down)
    x = x + _A_ref(_layernorm(x, axis=-1), A_k_cache, A_v_cache, A_wq, A_wo)
    x = x + _B_ref(_layernorm(x, axis=-1), B_w_gate, B_w_up, B_w_down)
    return x
```

```asm
; @launch grid=(256,1,1) block=(256,1,1) lds=163840
.amdgcn_target "amdgcn-amd-amdhsa--gfx950"
.text
.globl interleave_layers__mha_block_cached__glu_gated_bilinear__decode_kernel
.p2align 8
.type interleave_layers__mha_block_cached__glu_gated_bilinear__decode_kernel,@function
interleave_layers__mha_block_cached__glu_gated_bilinear__decode_kernel:
    s_cmp_ge_u32 s2, 0x100
    s_cbranch_scc1 L_end
    s_load_dwordx16 s[72:87], s[0:1], 0
    s_load_dwordx8 s[88:95], s[0:1], 64
    s_and_b32 s48, s2, 7
    s_lshr_b32 s49, s2, 3
    s_mov_b32 s62, 0x61a80
    v_lshrrev_b32 v72, 6, v0
    s_nop 0
    v_readfirstlane_b32 s52, v72
    v_and_b32 v0, 63, v0
    v_and_b32 v73, 15, v0
    v_lshrrev_b32 v74, 4, v0
    v_mov_b32 v8, 0x3db8aa3b
    v_mov_b32 v9, 0xbdb8aa3b
    v_cmp_eq_u32 s[98:99], 0, v73
    s_waitcnt lgkmcnt(0)
    s_mov_b32 s12, s94
    s_and_b32 s13, s95, 0xffff
    s_mov_b32 s14, 0x20000000
    s_mov_b32 s15, 0x20000
    s_mov_b32 s16, s92
    s_and_b32 s17, s93, 0xffff
    s_mov_b32 s18, 0x100
    s_mov_b32 s19, 0x20000
    s_cmp_ge_u32 s49, 28
    s_cbranch_scc1 L_chain
    s_mov_b32 s4, s74
    s_and_b32 s5, s75, 0xffff
    s_mov_b32 s6, 0x8000000
    s_mov_b32 s7, 0x20000
    s_mov_b32 s8, s76
    s_and_b32 s9, s77, 0xffff
    s_mov_b32 s10, 0x8000000
    s_mov_b32 s11, 0x20000
    v_lshrrev_b32 v75, 1, v73
    v_lshlrev_b32 v1, 9, v75
    v_lshl_add_u32 v1, v74, 5, v1
    v_and_b32 v75, 1, v73
    v_lshl_add_u32 v1, v75, 4, v1
    v_lshlrev_b32 v2, 10, v74
    v_lshl_add_u32 v2, v73, 4, v2
    v_cmp_eq_u32 s[64:65], 1, v75
    v_and_b32 v76, 2, v73
    v_cmp_eq_u32 vcc, 2, v76
    v_mov_b32 v77, 0xffff
    v_mov_b32 v78, 0xffff0000
    v_cndmask_b32 v77, v77, v78, vcc
    v_cndmask_b32 v77, 0, v77, s[64:65]
    v_lshrrev_b32 v76, 2, v73
    v_cmp_eq_u32 vcc, 0, v76
    s_nop 1
    v_cndmask_b32 v4, 0, v77, vcc
    v_cmp_eq_u32 vcc, 1, v76
    s_nop 1
    v_cndmask_b32 v5, 0, v77, vcc
    v_cmp_eq_u32 vcc, 2, v76
    s_nop 1
    v_cndmask_b32 v6, 0, v77, vcc
    v_cmp_eq_u32 vcc, 3, v76
    s_nop 1
    v_cndmask_b32 v7, 0, v77, vcc
    s_mul_i32 s63, s52, 0x410
    s_add_u32 s63, s63, 0x20000
    v_mov_b32 v10, s63
    v_lshl_add_u32 v11, v74, 7, v10
    v_lshl_add_u32 v11, v73, 1, v11
    v_add_u32 v11, -2, v11
    s_cmp_ge_u32 s49, 14
    s_cselect_b32 s63, 1, 0
    s_lshl_b32 s50, s48, 1
    s_add_u32 s50, s50, s63
    s_mul_i32 s63, s63, 14
    s_sub_u32 s51, s49, s63
    s_lshl_b32 s63, s51, 2
    s_add_u32 s63, s63, s52
    s_min_u32 s70, s63, 16
    s_mul_i32 s71, s63, 18
    s_add_u32 s71, s71, s70
    s_lshl_b32 s71, s71, 12
    s_lshl_b32 s54, s50, 22
    s_add_u32 s54, s54, s71
    s_add_u32 s55, s54, 0x4000000
    s_add_u32 s20, s54, 0x12000
    s_add_u32 s21, s55, 0x12000
    s_cmp_lt_u32 s63, 16
    s_cselect_b32 s20, s20, 0x40000000
    s_cselect_b32 s21, s21, 0x40000000
    s_cselect_b32 s22, 0, 0xf149f2ca
    s_lshl_b32 s23, s48, 5
    s_add_u32 s23, s23, s49
    s_and_b32 s24, s50, 3
    s_lshl_b32 s24, s24, 6
    s_lshr_b32 s70, s50, 2
    s_lshl_b32 s70, s70, 2
    s_add_u32 s24, s24, s70
    s_add_u32 s24, s24, 16
    s_mul_i32 s97, s52, 0x8000
    v_lshlrev_b32 v3, 4, v0
    v_add_u32 v3, s97, v3
    s_lshl_b32 s71, s49, 2
    s_add_u32 s71, s71, s52
    v_lshlrev_b32 v72, 4, v0
    s_mov_b32 s28, s80
    s_and_b32 s29, s81, 0xffff
    s_mov_b32 s30, 0x380000
    s_mov_b32 s31, 0x20000
    s_mov_b32 s32, s88
    s_and_b32 s33, s89, 0xffff
    s_mov_b32 s34, 0x188000
    s_mov_b32 s35, 0x20000
    s_mul_i32 s63, s48, 0x70000
    s_lshl_b32 s96, s71, 10
    s_add_u32 s63, s63, s96
    buffer_load_dwordx4 v[80:83], v72, s[28:31], s63 offen
    s_add_u32 s63, s63, 0x1c000
    buffer_load_dwordx4 v[84:87], v72, s[28:31], s63 offen
    s_add_u32 s63, s63, 0x1c000
    buffer_load_dwordx4 v[88:91], v72, s[28:31], s63 offen
    s_add_u32 s63, s63, 0x1c000
    buffer_load_dwordx4 v[92:95], v72, s[28:31], s63 offen
    s_mul_i32 s63, s48, 0x31000
    s_add_u32 s63, s63, s96
    buffer_load_dwordx4 v[96:99], v72, s[32:35], s63 offen
    s_add_u32 s63, s63, 0x1c000
    s_cmp_lt_u32 s71, 0x54
    s_cselect_b32 s63, s63, 0
    buffer_load_dwordx4 v[100:103], v72, s[32:35], s63 offen
    s_mov_b32 s36, s84
    s_and_b32 s37, s85, 0xffff
    s_mov_b32 s38, 0x188000
    s_mov_b32 s39, 0x20000
    s_mov_b32 s40, s86
    s_and_b32 s41, s87, 0xffff
    s_mov_b32 s42, 0x188000
    s_mov_b32 s43, 0x20000
    v_lshrrev_b32 v73, 5, v0
    v_mul_u32_u24 v73, 0xe00, v73
    v_and_b32 v74, 31, v0
    v_min_u32 v74, 27, v74
    v_lshl_add_u32 v73, v74, 4, v73
    s_mul_i32 s63, s48, 0x1c0
    s_mul_i32 s96, s71, 0x1c00
    s_add_u32 s63, s63, s96
    buffer_load_dwordx4 v[104:107], v73, s[36:39], s63 offen
    buffer_load_dwordx4 v[108:111], v73, s[40:43], s63 offen
    s_add_u32 s63, s63, 0xc4000
    buffer_load_dwordx4 v[112:115], v73, s[36:39], s63 offen
    buffer_load_dwordx4 v[116:119], v73, s[40:43], s63 offen
    s_cmp_lg_u32 s52, 0
    s_cbranch_scc1 L1
    v_mov_b32 v48, -1
    v_mov_b32 v49, -1
    v_mov_b32 v50, -1
    v_mov_b32 v51, -1
    v_lshrrev_b32 v72, 5, v0
    v_lshlrev_b32 v72, 17, v72
    v_and_b32 v73, 31, v0
    v_lshl_add_u32 v72, v73, 4, v72
    s_lshl_b32 s63, s23, 9
    s_add_u32 s63, s63, 0x10000
    buffer_store_dwordx4 v[48:51], v72, s[12:15], s63 offen sc1
    s_add_u32 s70, s63, 0x40000
    buffer_store_dwordx4 v[48:51], v72, s[12:15], s70 offen sc1
    s_mov_b64 exec, 15
    v_lshlrev_b32 v72, 11, v0
    s_lshl_b32 s63, s23, 3
    s_add_u32 s63, s63, 0x8000
    buffer_store_dwordx2 v[48:49], v72, s[12:15], s63 offen sc1
    v_mov_b32 v72, 0
    v_lshlrev_b32 v73, 2, v0
    v_add_u32 v73, 0x22080, v73
    ds_write_b32 v73, v72
    s_mov_b64 exec, -1
    s_waitcnt vmcnt(0) lgkmcnt(0)
    s_getreg_b32 s63, hwreg(HW_REG_XCC_ID)
    s_and_b32 s63, s63, 7
    s_mul_i32 s70, s63, s63
    s_lshl_b32 s70, s70, 20
    s_lshl_b32 s63, s63, 8
    s_add_u32 s63, s63, s70
    s_add_u32 s63, s63, 1
    v_mov_b32 v73, s63
    s_and_b32 s63, s48, 3
    s_lshl_b32 s63, s63, 6
    s_lshr_b32 s70, s48, 2
    s_lshl_b32 s70, s70, 2
    s_add_u32 s63, s63, s70
    v_mov_b32 v72, s63
    s_mov_b64 exec, 1
    buffer_atomic_add v73, v72, s[16:19], 0 offen sc1
    s_mov_b64 exec, -1
L1:
    s_nop 7
    s_add_u32 s56, s54, 0x10000
    buffer_load_dwordx4 v[80:83], v1, s[4:7], s56 offen
    buffer_load_dwordx4 v[84:87], v1, s[4:7], s56 offen offset:128
    buffer_load_dwordx4 v[88:91], v1, s[4:7], s56 offen offset:256
    buffer_load_dwordx4 v[92:95], v1, s[4:7], s56 offen offset:384
    buffer_load_dwordx4 v[96:99], v2, s[8:11], s56 offen
    buffer_load_dwordx4 v[100:103], v2, s[8:11], s56 offen offset:256
    buffer_load_dwordx4 v[104:107], v2, s[8:11], s56 offen offset:512
    buffer_load_dwordx4 v[108:111], v2, s[8:11], s56 offen offset:768
    s_add_u32 s57, s54, 0
    buffer_load_dwordx4 a[0:3], v1, s[4:7], s57 offen nt
    buffer_load_dwordx4 a[4:7], v1, s[4:7], s57 offen offset:128 nt
    buffer_load_dwordx4 a[8:11], v1, s[4:7], s57 offen offset:256 nt
    buffer_load_dwordx4 a[12:15], v1, s[4:7], s57 offen offset:384 nt
    s_add_u32 s58, s54, 0x1000
    buffer_load_dwordx4 a[32:35], v1, s[4:7], s58 offen nt
    buffer_load_dwordx4 a[36:39], v1, s[4:7], s58 offen offset:128 nt
    buffer_load_dwordx4 a[40:43], v1, s[4:7], s58 offen offset:256 nt
    buffer_load_dwordx4 a[44:47], v1, s[4:7], s58 offen offset:384 nt
    s_barrier
    s_waitcnt vmcnt(15)
    s_add_u32 s59, s54, 0x2000
    buffer_load_dwordx4 a[64:67], v1, s[4:7], s59 offen nt
    s_waitcnt vmcnt(15)
    buffer_load_dwordx4 a[68:71], v1, s[4:7], s59 offen offset:128 nt
    s_waitcnt vmcnt(15)
    buffer_load_dwordx4 a[72:75], v1, s[4:7], s59 offen offset:256 nt
    s_waitcnt vmcnt(15)
    buffer_load_dwordx4 a[76:79], v1, s[4:7], s59 offen offset:384 nt
    s_waitcnt vmcnt(15)
    s_add_u32 s56, s54, 0x3000
    buffer_load_dwordx4 a[96:99], v1, s[4:7], s56 offen nt
    s_waitcnt vmcnt(15)
    buffer_load_dwordx4 a[100:103], v1, s[4:7], s56 offen offset:128 nt
    s_waitcnt vmcnt(15)
    buffer_load_dwordx4 a[104:107], v1, s[4:7], s56 offen offset:256 nt
    s_waitcnt vmcnt(15)
    buffer_load_dwordx4 a[108:111], v1, s[4:7], s56 offen offset:384 nt
    s_waitcnt vmcnt(15)
    buffer_load_dwordx4 a[16:19], v2, s[8:11], s57 offen nt
    s_waitcnt vmcnt(15)
    buffer_load_dwordx4 a[20:23], v2, s[8:11], s57 offen offset:256 nt
    s_waitcnt vmcnt(15)
    buffer_load_dwordx4 a[24:27], v2, s[8:11], s57 offen offset:512 nt
    s_waitcnt vmcnt(15)
    buffer_load_dwordx4 a[28:31], v2, s[8:11], s57 offen offset:768 nt
    s_waitcnt vmcnt(15)
    buffer_load_dwordx4 a[48:51], v2, s[8:11], s58 offen nt
    s_waitcnt vmcnt(15)
    buffer_load_dwordx4 a[52:55], v2, s[8:11], s58 offen offset:256 nt
    s_waitcnt vmcnt(15)
    buffer_load_dwordx4 a[56:59], v2, s[8:11], s58 offen offset:512 nt
    s_waitcnt vmcnt(15)
    buffer_load_dwordx4 a[60:63], v2, s[8:11], s58 offen offset:768 nt
    s_waitcnt vmcnt(15)
    buffer_load_dwordx4 a[80:83], v2, s[8:11], s59 offen nt
    s_waitcnt vmcnt(15)
    buffer_load_dwordx4 a[84:87], v2, s[8:11], s59 offen offset:256 nt
    s_waitcnt vmcnt(15)
    buffer_load_dwordx4 a[88:91], v2, s[8:11], s59 offen offset:512 nt
    s_waitcnt vmcnt(15)
    buffer_load_dwordx4 a[92:95], v2, s[8:11], s59 offen offset:768 nt
    s_waitcnt vmcnt(15)
    buffer_load_dwordx4 a[112:115], v2, s[8:11], s56 offen nt
    s_waitcnt vmcnt(15)
    buffer_load_dwordx4 a[116:119], v2, s[8:11], s56 offen offset:256 nt
    s_waitcnt vmcnt(15)
    buffer_load_dwordx4 a[120:123], v2, s[8:11], s56 offen offset:512 nt
    s_waitcnt vmcnt(15)
    buffer_load_dwordx4 a[124:127], v2, s[8:11], s56 offen offset:768 nt
    s_waitcnt vmcnt(15)
    s_add_u32 s57, s54, 0x4000
    buffer_load_dwordx4 a[128:131], v1, s[4:7], s57 offen nt
    s_waitcnt vmcnt(15)
    buffer_load_dwordx4 a[132:135], v1, s[4:7], s57 offen offset:128 nt
    s_waitcnt vmcnt(15)
    buffer_load_dwordx4 a[136:139], v1, s[4:7], s57 offen offset:256 nt
    s_waitcnt vmcnt(15)
    buffer_load_dwordx4 a[140:143], v1, s[4:7], s57 offen offset:384 nt
    s_waitcnt vmcnt(15)
    s_add_u32 s58, s54, 0x5000
    buffer_load_dwordx4 a[160:163], v1, s[4:7], s58 offen nt
    s_waitcnt vmcnt(15)
    buffer_load_dwordx4 a[164:167], v1, s[4:7], s58 offen offset:128 nt
    s_waitcnt vmcnt(15)
    buffer_load_dwordx4 a[168:171], v1, s[4:7], s58 offen offset:256 nt
    s_waitcnt vmcnt(15)
    buffer_load_dwordx4 a[172:175], v1, s[4:7], s58 offen offset:384 nt
    s_waitcnt vmcnt(15)
    s_add_u32 s59, s54, 0x6000
    buffer_load_dwordx4 a[192:195], v1, s[4:7], s59 offen nt
    s_waitcnt vmcnt(15)
    buffer_load_dwordx4 a[196:199], v1, s[4:7], s59 offen offset:128 nt
    s_waitcnt vmcnt(15)
    buffer_load_dwordx4 a[200:203], v1, s[4:7], s59 offen offset:256 nt
    s_waitcnt vmcnt(15)
    buffer_load_dwordx4 a[204:207], v1, s[4:7], s59 offen offset:384 nt
    s_waitcnt vmcnt(15)
    s_add_u32 s56, s54, 0x7000
    buffer_load_dwordx4 a[224:227], v1, s[4:7], s56 offen nt
    s_waitcnt vmcnt(15)
    buffer_load_dwordx4 a[228:231], v1, s[4:7], s56 offen offset:128 nt
    s_waitcnt vmcnt(15)
    buffer_load_dwordx4 a[232:235], v1, s[4:7], s56 offen offset:256 nt
    s_waitcnt vmcnt(15)
    buffer_load_dwordx4 a[236:239], v1, s[4:7], s56 offen offset:384 nt
    s_waitcnt vmcnt(15)
    buffer_load_dwordx4 a[144:147], v2, s[8:11], s57 offen nt
    s_waitcnt vmcnt(15)
    buffer_load_dwordx4 a[148:151], v2, s[8:11], s57 offen offset:256 nt
    s_waitcnt vmcnt(15)
    buffer_load_dwordx4 a[152:155], v2, s[8:11], s57 offen offset:512 nt
    s_waitcnt vmcnt(15)
    buffer_load_dwordx4 a[156:159], v2, s[8:11], s57 offen offset:768 nt
    s_waitcnt vmcnt(15)
    buffer_load_dwordx4 a[176:179], v2, s[8:11], s58 offen nt
    s_waitcnt vmcnt(15)
    buffer_load_dwordx4 a[180:183], v2, s[8:11], s58 offen offset:256 nt
    s_waitcnt vmcnt(15)
    buffer_load_dwordx4 a[184:187], v2, s[8:11], s58 offen offset:512 nt
    s_waitcnt vmcnt(15)
    buffer_load_dwordx4 a[188:191], v2, s[8:11], s58 offen offset:768 nt
    s_waitcnt vmcnt(15)
    buffer_load_dwordx4 a[208:211], v2, s[8:11], s59 offen nt
    s_waitcnt vmcnt(15)
    buffer_load_dwordx4 a[212:215], v2, s[8:11], s59 offen offset:256 nt
    s_waitcnt vmcnt(15)
    buffer_load_dwordx4 a[216:219], v2, s[8:11], s59 offen offset:512 nt
    s_waitcnt vmcnt(15)
    buffer_load_dwordx4 a[220:223], v2, s[8:11], s59 offen offset:768 nt
    s_waitcnt vmcnt(15)
    buffer_load_dwordx4 a[240:243], v2, s[8:11], s56 offen nt
    s_waitcnt vmcnt(15)
    buffer_load_dwordx4 a[244:247], v2, s[8:11], s56 offen offset:256 nt
    s_waitcnt vmcnt(15)
    buffer_load_dwordx4 a[248:251], v2, s[8:11], s56 offen offset:512 nt
    s_waitcnt vmcnt(15)
    buffer_load_dwordx4 a[252:255], v2, s[8:11], s56 offen offset:768 nt
    s_waitcnt vmcnt(15)
    s_add_u32 s57, s54, 0x8000
    buffer_load_dwordx4 v[128:131], v1, s[4:7], s57 offen nt
    s_waitcnt vmcnt(15)
    buffer_load_dwordx4 v[132:135], v1, s[4:7], s57 offen offset:128 nt
    s_waitcnt vmcnt(15)
    buffer_load_dwordx4 v[136:139], v1, s[4:7], s57 offen offset:256 nt
    s_waitcnt vmcnt(15)
    buffer_load_dwordx4 v[140:143], v1, s[4:7], s57 offen offset:384 nt
    s_waitcnt vmcnt(15)
    s_add_u32 s58, s54, 0x9000
    buffer_load_dwordx4 v[160:163], v1, s[4:7], s58 offen nt
    s_waitcnt vmcnt(15)
    buffer_load_dwordx4 v[164:167], v1, s[4:7], s58 offen offset:128 nt
    s_waitcnt vmcnt(15)
    buffer_load_dwordx4 v[168:171], v1, s[4:7], s58 offen offset:256 nt
    s_waitcnt vmcnt(15)
    buffer_load_dwordx4 v[172:175], v1, s[4:7], s58 offen offset:384 nt
    v_mov_b32 v76, s24
    buffer_load_dword v78, v76, s[16:19], 0 offen sc1
    s_waitcnt vmcnt(16)
    s_add_u32 s59, s54, 0xa000
    buffer_load_dwordx4 v[192:195], v1, s[4:7], s59 offen nt
    s_waitcnt vmcnt(16)
    buffer_load_dwordx4 v[196:199], v1, s[4:7], s59 offen offset:128 nt
    s_waitcnt vmcnt(16)
    buffer_load_dwordx4 v[200:203], v1, s[4:7], s59 offen offset:256 nt
    s_waitcnt vmcnt(16)
    buffer_load_dwordx4 v[204:207], v1, s[4:7], s59 offen offset:384 nt
    s_waitcnt vmcnt(16)
    s_add_u32 s56, s54, 0xb000
    buffer_load_dwordx4 v[224:227], v1, s[4:7], s56 offen nt
    s_waitcnt vmcnt(16)
    buffer_load_dwordx4 v[228:231], v1, s[4:7], s56 offen offset:128 nt
    s_waitcnt vmcnt(16)
    buffer_load_dwordx4 v[232:235], v1, s[4:7], s56 offen offset:256 nt
    s_waitcnt vmcnt(16)
    buffer_load_dwordx4 v[236:239], v1, s[4:7], s56 offen offset:384 nt
    s_waitcnt vmcnt(16)
    buffer_load_dwordx4 v[144:147], v2, s[8:11], s57 offen nt
    s_waitcnt vmcnt(16)
    buffer_load_dwordx4 v[148:151], v2, s[8:11], s57 offen offset:256 nt
    s_waitcnt vmcnt(16)
    buffer_load_dwordx4 v[152:155], v2, s[8:11], s57 offen offset:512 nt
    s_waitcnt vmcnt(16)
    buffer_load_dwordx4 v[156:159], v2, s[8:11], s57 offen offset:768 nt
    s_waitcnt vmcnt(12)
    v_cmp_gt_u32 vcc, 8, v78
    s_cbranch_vccz L2
L3:
    s_nop 7
    buffer_load_dword v78, v76, s[16:19], 0 offen sc1
    s_waitcnt vmcnt(0)
    v_cmp_gt_u32 vcc, 8, v78
    s_cbranch_vccz L4
    s_sleep 8
    s_sub_u32 s62, s62, 1
    s_cmp_eq_u32 s62, 0
    s_cbranch_scc1 L_end
    s_branch L3
L4:
    s_nop 7
L2:
    s_nop 7
    s_lshl_b32 s70, s50, 6
    s_add_u32 s70, s70, 0xa000
    v_mov_b32 v76, 0
    buffer_load_dword v78, v76, s[12:15], s70 offen sc1
    v_and_b32 v72, 0x7f, v1
    s_lshl_b32 s63, s50, 9
    s_add_u32 s63, s63, 0
    v_and_b32 v72, 0x7f, v1
    s_lshl_b32 s71, s50, 9
    s_add_u32 s71, s71, 0x2000
    buffer_load_dwordx4 v[32:35], v72, s[12:15], s63 offen sc1
    buffer_load_dwordx4 v[36:39], v72, s[12:15], s63 offen offset:128 sc1
    buffer_load_dwordx4 v[40:43], v72, s[12:15], s63 offen offset:256 sc1
    buffer_load_dwordx4 v[44:47], v72, s[12:15], s63 offen offset:384 sc1
    buffer_load_dwordx4 v[48:51], v72, s[12:15], s71 offen sc1
    buffer_load_dwordx4 v[52:55], v72, s[12:15], s71 offen offset:128 sc1
    buffer_load_dwordx4 v[56:59], v72, s[12:15], s71 offen offset:256 sc1
    buffer_load_dwordx4 v[60:63], v72, s[12:15], s71 offen offset:384 sc1
    buffer_load_dwordx4 v[176:179], v2, s[8:11], s58 offen nt
    buffer_load_dwordx4 v[180:183], v2, s[8:11], s58 offen offset:256 nt
    buffer_load_dwordx4 v[184:187], v2, s[8:11], s58 offen offset:512 nt
    buffer_load_dwordx4 v[188:191], v2, s[8:11], s58 offen offset:768 nt
    s_waitcnt vmcnt(24)
    buffer_load_dwordx4 v[208:211], v2, s[8:11], s59 offen nt
    s_waitcnt vmcnt(24)
    buffer_load_dwordx4 v[212:215], v2, s[8:11], s59 offen offset:256 nt
    s_waitcnt vmcnt(24)
    buffer_load_dwordx4 v[216:219], v2, s[8:11], s59 offen offset:512 nt
    s_waitcnt vmcnt(24)
    buffer_load_dwordx4 v[220:223], v2, s[8:11], s59 offen offset:768 nt
    s_waitcnt vmcnt(24)
    buffer_load_dwordx4 v[240:243], v2, s[8:11], s56 offen nt
    s_waitcnt vmcnt(24)
    buffer_load_dwordx4 v[244:247], v2, s[8:11], s56 offen offset:256 nt
    s_waitcnt vmcnt(24)
    buffer_load_dwordx4 v[248:251], v2, s[8:11], s56 offen offset:512 nt
    s_waitcnt vmcnt(24)
    buffer_load_dwordx4 v[252:255], v2, s[8:11], s56 offen offset:768 nt
    s_waitcnt vmcnt(12)
    v_readfirstlane_b32 s3, v78
    v_and_b32 v73, 0x7f, v1
    v_add_u32 v73, 0x22300, v73
    ds_write_b128 v73, v[48:51]
    ds_write_b128 v73, v[52:55] offset:128
    ds_write_b128 v73, v[56:59] offset:256
    ds_write_b128 v73, v[60:63] offset:384
    s_waitcnt lgkmcnt(0)
    v_mov_b32 v20, 0
    v_mfma_f32_16x16x32_bf16 v[56:59], v[80:83], v[32:35], 0
    v_mfma_f32_16x16x32_bf16 v[56:59], v[84:87], v[36:39], v[56:59]
    v_mfma_f32_16x16x32_bf16 v[56:59], v[88:91], v[40:43], v[56:59]
    v_mfma_f32_16x16x32_bf16 v[56:59], v[92:95], v[44:47], v[56:59]
    s_nop 7
    v_add_f32_dpp v48, v56, v57 quad_perm:[1,0,3,2] row_mask:0xf bank_mask:0xf
    v_add_f32_dpp v49, v58, v59 quad_perm:[1,0,3,2] row_mask:0xf bank_mask:0xf
    v_max_f32 v72, v48, v49
    s_nop 1
    v_max_f32_dpp v72, v72, v72 row_bcast:15 row_mask:0xa bank_mask:0xf
    s_nop 1
    v_max_f32_dpp v72, v72, v72 row_bcast:31 row_mask:0xc bank_mask:0xf
    s_nop 0
    v_readlane_b32 s60, v72, 63
    s_nop 1
    v_mul_f32 v21, s60, v9
    v_fma_f32 v48, v48, v8, v21
    v_fma_f32 v49, v49, v8, v21
    v_exp_f32 v48, v48
    v_exp_f32 v49, v49
    v_add_f32 v20, v20, v48
    v_cvt_pk_bf16_f32 v75, v48, v48
    v_and_b32 v64, v75, v4
    v_and_b32 v65, v75, v5
    v_and_b32 v66, v75, v6
    v_and_b32 v67, v75, v7
    s_nop 1
    v_mfma_f32_16x16x32_bf16 v[12:15], v[96:99], v[64:67], 0
    v_mfma_f32_16x16x32_bf16 v[16:19], v[100:103], v[64:67], 0
    v_add_f32 v20, v20, v49
    v_cvt_pk_bf16_f32 v75, v49, v49
    v_and_b32 v68, v75, v4
    v_and_b32 v69, v75, v5
    v_and_b32 v70, v75, v6
    v_and_b32 v71, v75, v7
    s_nop 1
    v_mfma_f32_16x16x32_bf16 v[12:15], v[104:107], v[68:71], v[12:15]
    v_mfma_f32_16x16x32_bf16 v[16:19], v[108:111], v[68:71], v[16:19]
    s_add_u32 s57, s54, 0xc000
    s_add_u32 m0, s97, 0
    s_nop 0
    buffer_load_dwordx4 v1, s[4:7], s57 offen nt lds
    v_mfma_f32_16x16x32_bf16 v[56:59], a[0:3], v[32:35], 0
    v_mfma_f32_16x16x32_bf16 v[56:59], a[4:7], v[36:39], v[56:59]
    v_mfma_f32_16x16x32_bf16 v[56:59], a[8:11], v[40:43], v[56:59]
    v_mfma_f32_16x16x32_bf16 v[56:59], a[12:15], v[44:47], v[56:59]
    s_add_u32 m0, s97, 0x380
    s_nop 0
    buffer_load_dwordx4 v1, s[4:7], s57 offen offset:128 nt lds
    v_mfma_f32_16x16x32_bf16 v[60:63], a[32:35], v[32:35], 0
    v_mfma_f32_16x16x32_bf16 v[60:63], a[36:39], v[36:39], v[60:63]
    v_mfma_f32_16x16x32_bf16 v[60:63], a[40:43], v[40:43], v[60:63]
    v_mfma_f32_16x16x32_bf16 v[60:63], a[44:47], v[44:47], v[60:63]
    s_nop 0
    v_add_f32_dpp v48, v56, v57 quad_perm:[1,0,3,2] row_mask:0xf bank_mask:0xf
    v_add_f32_dpp v49, v58, v59 quad_perm:[1,0,3,2] row_mask:0xf bank_mask:0xf
    v_mfma_f32_16x16x32_bf16 v[56:59], a[64:67], v[32:35], 0
    v_mfma_f32_16x16x32_bf16 v[56:59], a[68:71], v[36:39], v[56:59]
    v_mfma_f32_16x16x32_bf16 v[56:59], a[72:75], v[40:43], v[56:59]
    v_mfma_f32_16x16x32_bf16 v[56:59], a[76:79], v[44:47], v[56:59]
    s_add_u32 m0, s97, 0x700
    s_nop 0
    buffer_load_dwordx4 v1, s[4:7], s57 offen offset:256 nt lds
    v_add_f32_dpp v50, v60, v61 quad_perm:[1,0,3,2] row_mask:0xf bank_mask:0xf
    v_add_f32_dpp v51, v62, v63 quad_perm:[1,0,3,2] row_mask:0xf bank_mask:0xf
    v_mfma_f32_16x16x32_bf16 v[60:63], a[96:99], v[32:35], 0
    v_mfma_f32_16x16x32_bf16 v[60:63], a[100:103], v[36:39], v[60:63]
    v_mfma_f32_16x16x32_bf16 v[60:63], a[104:107], v[40:43], v[60:63]
    v_mfma_f32_16x16x32_bf16 v[60:63], a[108:111], v[44:47], v[60:63]
    s_add_u32 m0, s97, 0xa80
    s_nop 0
    buffer_load_dwordx4 v1, s[4:7], s57 offen offset:384 nt lds
    v_add_f32_dpp v52, v56, v57 quad_perm:[1,0,3,2] row_mask:0xf bank_mask:0xf
    v_add_f32_dpp v53, v58, v59 quad_perm:[1,0,3,2] row_mask:0xf bank_mask:0xf
    s_nop 2
    v_add_f32_dpp v54, v60, v61 quad_perm:[1,0,3,2] row_mask:0xf bank_mask:0xf
    v_add_f32_dpp v55, v62, v63 quad_perm:[1,0,3,2] row_mask:0xf bank_mask:0xf
    v_max3_f32 v72, v48, v49, v50
    v_max3_f32 v72, v72, v51, v52
    v_max3_f32 v72, v72, v53, v54
    v_max_f32 v72, v72, v55
    s_nop 1
    v_max_f32_dpp v72, v72, v72 row_bcast:15 row_mask:0xa bank_mask:0xf
    s_nop 1
    v_max_f32_dpp v72, v72, v72 row_bcast:31 row_mask:0xc bank_mask:0xf
    v_max_f32 v72, s60, v72
    s_nop 0
    v_readlane_b32 s60, v72, 63
    s_nop 1
    v_mul_f32 v73, s60, v9
    v_sub_f32 v74, v73, v21
    v_exp_f32 v74, v74
    v_mov_b32 v21, v73
    v_mul_f32 v20, v20, v74
    v_mul_f32 v12, v12, v74
    v_mul_f32 v13, v13, v74
    v_mul_f32 v14, v14, v74
    v_mul_f32 v15, v15, v74
    v_mul_f32 v16, v16, v74
    v_mul_f32 v17, v17, v74
    v_mul_f32 v18, v18, v74
    v_mul_f32 v19, v19, v74
    v_fma_f32 v48, v48, v8, v21
    v_fma_f32 v49, v49, v8, v21
    v_fma_f32 v50, v50, v8, v21
    v_fma_f32 v51, v51, v8, v21
    v_fma_f32 v52, v52, v8, v21
    v_fma_f32 v53, v53, v8, v21
    v_fma_f32 v54, v54, v8, v21
    v_fma_f32 v55, v55, v8, v21
    v_exp_f32 v48, v48
    v_exp_f32 v49, v49
    v_exp_f32 v50, v50
    v_exp_f32 v51, v51
    v_exp_f32 v52, v52
    v_exp_f32 v53, v53
    v_exp_f32 v54, v54
    v_exp_f32 v55, v55
    v_add_f32 v20, v20, v48
    v_cvt_pk_bf16_f32 v75, v48, v48
    v_and_b32 v64, v75, v4
    v_and_b32 v65, v75, v5
    v_and_b32 v66, v75, v6
    v_and_b32 v67, v75, v7
    s_nop 1
    v_mfma_f32_16x16x32_bf16 v[12:15], a[16:19], v[64:67], v[12:15]
    v_mfma_f32_16x16x32_bf16 v[16:19], a[20:23], v[64:67], v[16:19]
    v_add_f32 v20, v20, v49
    v_cvt_pk_bf16_f32 v75, v49, v49
    v_and_b32 v68, v75, v4
    v_and_b32 v69, v75, v5
    v_and_b32 v70, v75, v6
    v_and_b32 v71, v75, v7
    s_nop 1
    v_mfma_f32_16x16x32_bf16 v[12:15], a[24:27], v[68:71], v[12:15]
    v_mfma_f32_16x16x32_bf16 v[16:19], a[28:31], v[68:71], v[16:19]
    v_add_f32 v20, v20, v50
    v_cvt_pk_bf16_f32 v75, v50, v50
    v_and_b32 v64, v75, v4
    v_and_b32 v65, v75, v5
    v_and_b32 v66, v75, v6
    v_and_b32 v67, v75, v7
    s_nop 1
    v_mfma_f32_16x16x32_bf16 v[12:15], a[48:51], v[64:67], v[12:15]
    v_mfma_f32_16x16x32_bf16 v[16:19], a[52:55], v[64:67], v[16:19]
    v_add_f32 v20, v20, v51
    v_cvt_pk_bf16_f32 v75, v51, v51
    v_and_b32 v68, v75, v4
    v_and_b32 v69, v75, v5
    v_and_b32 v70, v75, v6
    v_and_b32 v71, v75, v7
    s_nop 1
    v_mfma_f32_16x16x32_bf16 v[12:15], a[56:59], v[68:71], v[12:15]
    v_mfma_f32_16x16x32_bf16 v[16:19], a[60:63], v[68:71], v[16:19]
    s_waitcnt vmcnt(15)
    s_add_u32 s58, s54, 0xd000
    s_add_u32 m0, s97, 0x2000
    s_nop 0
    buffer_load_dwordx4 v1, s[4:7], s58 offen nt lds
    v_add_f32 v20, v20, v52
    v_cvt_pk_bf16_f32 v75, v52, v52
    v_and_b32 v64, v75, v4
    v_and_b32 v65, v75, v5
    v_and_b32 v66, v75, v6
    v_and_b32 v67, v75, v7
    s_nop 1
    v_mfma_f32_16x16x32_bf16 v[12:15], a[80:83], v[64:67], v[12:15]
    v_mfma_f32_16x16x32_bf16 v[16:19], a[84:87], v[64:67], v[16:19]
    v_add_f32 v20, v20, v53
    v_cvt_pk_bf16_f32 v75, v53, v53
    v_and_b32 v68, v75, v4
    v_and_b32 v69, v75, v5
    v_and_b32 v70, v75, v6
    v_and_b32 v71, v75, v7
    s_nop 1
    v_mfma_f32_16x16x32_bf16 v[12:15], a[88:91], v[68:71], v[12:15]
    v_mfma_f32_16x16x32_bf16 v[16:19], a[92:95], v[68:71], v[16:19]
    s_waitcnt vmcnt(15)
    s_add_u32 m0, s97, 0x2380
    s_nop 0
    buffer_load_dwordx4 v1, s[4:7], s58 offen offset:128 nt lds
    v_add_f32 v20, v20, v54
    v_cvt_pk_bf16_f32 v75, v54, v54
    v_and_b32 v64, v75, v4
    v_and_b32 v65, v75, v5
    v_and_b32 v66, v75, v6
    v_and_b32 v67, v75, v7
    s_nop 1
    v_mfma_f32_16x16x32_bf16 v[12:15], a[112:115], v[64:67], v[12:15]
    v_mfma_f32_16x16x32_bf16 v[16:19], a[116:119], v[64:67], v[16:19]
    v_add_f32 v20, v20, v55
    v_cvt_pk_bf16_f32 v75, v55, v55
    v_and_b32 v68, v75, v4
    v_and_b32 v69, v75, v5
    v_and_b32 v70, v75, v6
    v_and_b32 v71, v75, v7
    s_nop 1
    v_mfma_f32_16x16x32_bf16 v[12:15], a[120:123], v[68:71], v[12:15]
    v_mfma_f32_16x16x32_bf16 v[16:19], a[124:127], v[68:71], v[16:19]
    v_mfma_f32_16x16x32_bf16 v[56:59], a[128:131], v[32:35], 0
    v_mfma_f32_16x16x32_bf16 v[56:59], a[132:135], v[36:39], v[56:59]
    v_mfma_f32_16x16x32_bf16 v[56:59], a[136:139], v[40:43], v[56:59]
    v_mfma_f32_16x16x32_bf16 v[56:59], a[140:143], v[44:47], v[56:59]
    s_waitcnt vmcnt(15)
    s_add_u32 m0, s97, 0x2700
    s_nop 0
    buffer_load_dwordx4 v1, s[4:7], s58 offen offset:256 nt lds
    v_mfma_f32_16x16x32_bf16 v[60:63], a[160:163], v[32:35], 0
    v_mfma_f32_16x16x32_bf16 v[60:63], a[164:167], v[36:39], v[60:63]
    v_mfma_f32_16x16x32_bf16 v[60:63], a[168:171], v[40:43], v[60:63]
    v_mfma_f32_16x16x32_bf16 v[60:63], a[172:175], v[44:47], v[60:63]
    s_waitcnt vmcnt(15)
    s_add_u32 m0, s97, 0x2a80
    s_nop 0
    buffer_load_dwordx4 v1, s[4:7], s58 offen offset:384 nt lds
    v_add_f32_dpp v48, v56, v57 quad_perm:[1,0,3,2] row_mask:0xf bank_mask:0xf
    v_add_f32_dpp v49, v58, v59 quad_perm:[1,0,3,2] row_mask:0xf bank_mask:0xf
    v_mfma_f32_16x16x32_bf16 v[56:59], a[192:195], v[32:35], 0
    v_mfma_f32_16x16x32_bf16 v[56:59], a[196:199], v[36:39], v[56:59]
    v_mfma_f32_16x16x32_bf16 v[56:59], a[200:203], v[40:43], v[56:59]
    v_mfma_f32_16x16x32_bf16 v[56:59], a[204:207], v[44:47], v[56:59]
    v_add_f32_dpp v50, v60, v61 quad_perm:[1,0,3,2] row_mask:0xf bank_mask:0xf
    v_add_f32_dpp v51, v62, v63 quad_perm:[1,0,3,2] row_mask:0xf bank_mask:0xf
    v_mfma_f32_16x16x32_bf16 v[60:63], a[224:227], v[32:35], 0
    v_mfma_f32_16x16x32_bf16 v[60:63], a[228:231], v[36:39], v[60:63]
    v_mfma_f32_16x16x32_bf16 v[60:63], a[232:235], v[40:43], v[60:63]
    v_mfma_f32_16x16x32_bf16 v[60:63], a[236:239], v[44:47], v[60:63]
    s_waitcnt vmcnt(15)
    s_add_u32 s59, s54, 0xe000
    s_add_u32 m0, s97, 0x4000
    s_nop 0
    buffer_load_dwordx4 v1, s[4:7], s59 offen nt lds
    v_add_f32_dpp v52, v56, v57 quad_perm:[1,0,3,2] row_mask:0xf bank_mask:0xf
    v_add_f32_dpp v53, v58, v59 quad_perm:[1,0,3,2] row_mask:0xf bank_mask:0xf
    s_nop 0
    v_add_f32_dpp v54, v60, v61 quad_perm:[1,0,3,2] row_mask:0xf bank_mask:0xf
    v_add_f32_dpp v55, v62, v63 quad_perm:[1,0,3,2] row_mask:0xf bank_mask:0xf
    v_max3_f32 v72, v48, v49, v50
    v_max3_f32 v72, v72, v51, v52
    v_max3_f32 v72, v72, v53, v54
    v_max_f32 v72, v72, v55
    s_nop 1
    v_max_f32_dpp v72, v72, v72 row_bcast:15 row_mask:0xa bank_mask:0xf
    s_nop 1
    v_max_f32_dpp v72, v72, v72 row_bcast:31 row_mask:0xc bank_mask:0xf
    v_max_f32 v72, s60, v72
    s_nop 0
    v_readlane_b32 s60, v72, 63
    s_nop 1
    v_mul_f32 v73, s60, v9
    v_sub_f32 v74, v73, v21
    v_exp_f32 v74, v74
    v_mov_b32 v21, v73
    v_mul_f32 v20, v20, v74
    v_mul_f32 v12, v12, v74
    v_mul_f32 v13, v13, v74
    v_mul_f32 v14, v14, v74
    v_mul_f32 v15, v15, v74
    v_mul_f32 v16, v16, v74
    v_mul_f32 v17, v17, v74
    v_mul_f32 v18, v18, v74
    v_mul_f32 v19, v19, v74
    v_fma_f32 v48, v48, v8, v21
    v_fma_f32 v49, v49, v8, v21
    v_fma_f32 v50, v50, v8, v21
    v_fma_f32 v51, v51, v8, v21
    v_fma_f32 v52, v52, v8, v21
    v_fma_f32 v53, v53, v8, v21
    v_fma_f32 v54, v54, v8, v21
    v_fma_f32 v55, v55, v8, v21
    v_exp_f32 v48, v48
    v_exp_f32 v49, v49
    v_exp_f32 v50, v50
    v_exp_f32 v51, v51
    v_exp_f32 v52, v52
    v_exp_f32 v53, v53
    v_exp_f32 v54, v54
    v_exp_f32 v55, v55
    v_add_f32 v20, v20, v48
    v_cvt_pk_bf16_f32 v75, v48, v48
    v_and_b32 v64, v75, v4
    v_and_b32 v65, v75, v5
    v_and_b32 v66, v75, v6
    v_and_b32 v67, v75, v7
    s_nop 1
    v_mfma_f32_16x16x32_bf16 v[12:15], a[144:147], v[64:67], v[12:15]
    v_mfma_f32_16x16x32_bf16 v[16:19], a[148:151], v[64:67], v[16:19]
    v_add_f32 v20, v20, v49
    v_cvt_pk_bf16_f32 v75, v49, v49
    v_and_b32 v68, v75, v4
    v_and_b32 v69, v75, v5
    v_and_b32 v70, v75, v6
    v_and_b32 v71, v75, v7
    s_nop 1
    v_mfma_f32_16x16x32_bf16 v[12:15], a[152:155], v[68:71], v[12:15]
    v_mfma_f32_16x16x32_bf16 v[16:19], a[156:159], v[68:71], v[16:19]
    s_waitcnt vmcnt(15)
    s_add_u32 m0, s97, 0x4380
    s_nop 0
    buffer_load_dwordx4 v1, s[4:7], s59 offen offset:128 nt lds
    v_add_f32 v20, v20, v50
    v_cvt_pk_bf16_f32 v75, v50, v50
    v_and_b32 v64, v75, v4
    v_and_b32 v65, v75, v5
    v_and_b32 v66, v75, v6
    v_and_b32 v67, v75, v7
    s_nop 1
    v_mfma_f32_16x16x32_bf16 v[12:15], a[176:179], v[64:67], v[12:15]
    v_mfma_f32_16x16x32_bf16 v[16:19], a[180:183], v[64:67], v[16:19]
    v_add_f32 v20, v20, v51
    v_cvt_pk_bf16_f32 v75, v51, v51
    v_and_b32 v68, v75, v4
    v_and_b32 v69, v75, v5
    v_and_b32 v70, v75, v6
    v_and_b32 v71, v75, v7
    s_nop 1
    v_mfma_f32_16x16x32_bf16 v[12:15], a[184:187], v[68:71], v[12:15]
    v_mfma_f32_16x16x32_bf16 v[16:19], a[188:191], v[68:71], v[16:19]
    v_add_f32 v20, v20, v52
    v_cvt_pk_bf16_f32 v75, v52, v52
    v_and_b32 v64, v75, v4
    v_and_b32 v65, v75, v5
    v_and_b32 v66, v75, v6
    v_and_b32 v67, v75, v7
    s_nop 1
    v_mfma_f32_16x16x32_bf16 v[12:15], a[208:211], v[64:67], v[12:15]
    v_mfma_f32_16x16x32_bf16 v[16:19], a[212:215], v[64:67], v[16:19]
    v_add_f32 v20, v20, v53
    v_cvt_pk_bf16_f32 v75, v53, v53
    v_and_b32 v68, v75, v4
    v_and_b32 v69, v75, v5
    v_and_b32 v70, v75, v6
    v_and_b32 v71, v75, v7
    s_nop 1
    v_mfma_f32_16x16x32_bf16 v[12:15], a[216:219], v[68:71], v[12:15]
    v_mfma_f32_16x16x32_bf16 v[16:19], a[220:223], v[68:71], v[16:19]
    s_waitcnt vmcnt(15)
    s_add_u32 m0, s97, 0x4700
    s_nop 0
    buffer_load_dwordx4 v1, s[4:7], s59 offen offset:256 nt lds
    v_add_f32 v20, v20, v54
    v_cvt_pk_bf16_f32 v75, v54, v54
    v_and_b32 v64, v75, v4
    v_and_b32 v65, v75, v5
    v_and_b32 v66, v75, v6
    v_and_b32 v67, v75, v7
    s_nop 1
    v_mfma_f32_16x16x32_bf16 v[12:15], a[240:243], v[64:67], v[12:15]
    v_mfma_f32_16x16x32_bf16 v[16:19], a[244:247], v[64:67], v[16:19]
    v_add_f32 v20, v20, v55
    v_cvt_pk_bf16_f32 v75, v55, v55
    v_and_b32 v68, v75, v4
    v_and_b32 v69, v75, v5
    v_and_b32 v70, v75, v6
    v_and_b32 v71, v75, v7
    s_nop 1
    v_mfma_f32_16x16x32_bf16 v[12:15], a[248:251], v[68:71], v[12:15]
    v_mfma_f32_16x16x32_bf16 v[16:19], a[252:255], v[68:71], v[16:19]
    s_waitcnt vmcnt(15)
    s_add_u32 m0, s97, 0x4a80
    s_nop 0
    buffer_load_dwordx4 v1, s[4:7], s59 offen offset:384 nt lds
    v_mfma_f32_16x16x32_bf16 v[56:59], v[128:131], v[32:35], 0
    v_mfma_f32_16x16x32_bf16 v[56:59], v[132:135], v[36:39], v[56:59]
    v_mfma_f32_16x16x32_bf16 v[56:59], v[136:139], v[40:43], v[56:59]
    v_mfma_f32_16x16x32_bf16 v[56:59], v[140:143], v[44:47], v[56:59]
    v_mfma_f32_16x16x32_bf16 v[60:63], v[160:163], v[32:35], 0
    v_mfma_f32_16x16x32_bf16 v[60:63], v[164:167], v[36:39], v[60:63]
    v_mfma_f32_16x16x32_bf16 v[60:63], v[168:171], v[40:43], v[60:63]
    v_mfma_f32_16x16x32_bf16 v[60:63], v[172:175], v[44:47], v[60:63]
    s_waitcnt vmcnt(15)
    s_add_u32 s56, s54, 0xf000
    s_add_u32 m0, s97, 0x6000
    s_nop 0
    buffer_load_dwordx4 v1, s[4:7], s56 offen nt lds
    v_add_f32_dpp v48, v56, v57 quad_perm:[1,0,3,2] row_mask:0xf bank_mask:0xf
    v_add_f32_dpp v49, v58, v59 quad_perm:[1,0,3,2] row_mask:0xf bank_mask:0xf
    v_mfma_f32_16x16x32_bf16 v[56:59], v[192:195], v[32:35], 0
    v_mfma_f32_16x16x32_bf16 v[56:59], v[196:199], v[36:39], v[56:59]
    v_mfma_f32_16x16x32_bf16 v[56:59], v[200:203], v[40:43], v[56:59]
    v_mfma_f32_16x16x32_bf16 v[56:59], v[204:207], v[44:47], v[56:59]
    s_waitcnt vmcnt(15)
    s_add_u32 m0, s97, 0x6380
    s_nop 0
    buffer_load_dwordx4 v1, s[4:7], s56 offen offset:128 nt lds
    v_add_f32_dpp v50, v60, v61 quad_perm:[1,0,3,2] row_mask:0xf bank_mask:0xf
    v_add_f32_dpp v51, v62, v63 quad_perm:[1,0,3,2] row_mask:0xf bank_mask:0xf
    v_mfma_f32_16x16x32_bf16 v[60:63], v[224:227], v[32:35], 0
    v_mfma_f32_16x16x32_bf16 v[60:63], v[228:231], v[36:39], v[60:63]
    v_mfma_f32_16x16x32_bf16 v[60:63], v[232:235], v[40:43], v[60:63]
    v_mfma_f32_16x16x32_bf16 v[60:63], v[236:239], v[44:47], v[60:63]
    v_add_f32_dpp v52, v56, v57 quad_perm:[1,0,3,2] row_mask:0xf bank_mask:0xf
    v_add_f32_dpp v53, v58, v59 quad_perm:[1,0,3,2] row_mask:0xf bank_mask:0xf
    s_nop 5
    v_add_f32_dpp v54, v60, v61 quad_perm:[1,0,3,2] row_mask:0xf bank_mask:0xf
    v_add_f32_dpp v55, v62, v63 quad_perm:[1,0,3,2] row_mask:0xf bank_mask:0xf
    v_max3_f32 v72, v48, v49, v50
    v_max3_f32 v72, v72, v51, v52
    v_max3_f32 v72, v72, v53, v54
    v_max_f32 v72, v72, v55
    s_nop 1
    v_max_f32_dpp v72, v72, v72 row_bcast:15 row_mask:0xa bank_mask:0xf
    s_nop 1
    v_max_f32_dpp v72, v72, v72 row_bcast:31 row_mask:0xc bank_mask:0xf
    v_max_f32 v72, s60, v72
    s_nop 0
    v_readlane_b32 s60, v72, 63
    s_nop 1
    v_mul_f32 v73, s60, v9
    v_sub_f32 v74, v73, v21
    v_exp_f32 v74, v74
    v_mov_b32 v21, v73
    v_mul_f32 v20, v20, v74
    v_mul_f32 v12, v12, v74
    v_mul_f32 v13, v13, v74
    v_mul_f32 v14, v14, v74
    v_mul_f32 v15, v15, v74
    v_mul_f32 v16, v16, v74
    v_mul_f32 v17, v17, v74
    v_mul_f32 v18, v18, v74
    v_mul_f32 v19, v19, v74
    v_fma_f32 v48, v48, v8, v21
    v_fma_f32 v49, v49, v8, v21
    v_fma_f32 v50, v50, v8, v21
    v_fma_f32 v51, v51, v8, v21
    v_fma_f32 v52, v52, v8, v21
    v_fma_f32 v53, v53, v8, v21
    v_fma_f32 v54, v54, v8, v21
    v_fma_f32 v55, v55, v8, v21
    v_exp_f32 v48, v48
    v_exp_f32 v49, v49
    v_exp_f32 v50, v50
    v_exp_f32 v51, v51
    v_exp_f32 v52, v52
    v_exp_f32 v53, v53
    v_exp_f32 v54, v54
    v_exp_f32 v55, v55
    v_add_f32 v20, v20, v48
    v_cvt_pk_bf16_f32 v75, v48, v48
    v_and_b32 v64, v75, v4
    v_and_b32 v65, v75, v5
    v_and_b32 v66, v75, v6
    v_and_b32 v67, v75, v7
    s_nop 1
    v_mfma_f32_16x16x32_bf16 v[12:15], v[144:147], v[64:67], v[12:15]
    v_mfma_f32_16x16x32_bf16 v[16:19], v[148:151], v[64:67], v[16:19]
    v_add_f32 v20, v20, v49
    v_cvt_pk_bf16_f32 v75, v49, v49
    v_and_b32 v68, v75, v4
    v_and_b32 v69, v75, v5
    v_and_b32 v70, v75, v6
    v_and_b32 v71, v75, v7
    s_nop 1
    v_mfma_f32_16x16x32_bf16 v[12:15], v[152:155], v[68:71], v[12:15]
    v_mfma_f32_16x16x32_bf16 v[16:19], v[156:159], v[68:71], v[16:19]
    s_waitcnt vmcnt(15)
    s_add_u32 m0, s97, 0x6700
    s_nop 0
    buffer_load_dwordx4 v1, s[4:7], s56 offen offset:256 nt lds
    v_add_f32 v20, v20, v50
    v_cvt_pk_bf16_f32 v75, v50, v50
    v_and_b32 v64, v75, v4
    v_and_b32 v65, v75, v5
    v_and_b32 v66, v75, v6
    v_and_b32 v67, v75, v7
    s_nop 1
    v_mfma_f32_16x16x32_bf16 v[12:15], v[176:179], v[64:67], v[12:15]
    v_mfma_f32_16x16x32_bf16 v[16:19], v[180:183], v[64:67], v[16:19]
    v_add_f32 v20, v20, v51
    v_cvt_pk_bf16_f32 v75, v51, v51
    v_and_b32 v68, v75, v4
    v_and_b32 v69, v75, v5
    v_and_b32 v70, v75, v6
    v_and_b32 v71, v75, v7
    s_nop 1
    v_mfma_f32_16x16x32_bf16 v[12:15], v[184:187], v[68:71], v[12:15]
    v_mfma_f32_16x16x32_bf16 v[16:19], v[188:191], v[68:71], v[16:19]
    s_waitcnt vmcnt(15)
    s_add_u32 m0, s97, 0x6a80
    s_nop 0
    buffer_load_dwordx4 v1, s[4:7], s56 offen offset:384 nt lds
    v_add_f32 v20, v20, v52
    v_cvt_pk_bf16_f32 v75, v52, v52
    v_and_b32 v64, v75, v4
    v_and_b32 v65, v75, v5
    v_and_b32 v66, v75, v6
    v_and_b32 v67, v75, v7
    s_nop 1
    v_mfma_f32_16x16x32_bf16 v[12:15], v[208:211], v[64:67], v[12:15]
    v_mfma_f32_16x16x32_bf16 v[16:19], v[212:215], v[64:67], v[16:19]
    v_add_f32 v20, v20, v53
    v_cvt_pk_bf16_f32 v75, v53, v53
    v_and_b32 v68, v75, v4
    v_and_b32 v69, v75, v5
    v_and_b32 v70, v75, v6
    v_and_b32 v71, v75, v7
    s_nop 1
    v_mfma_f32_16x16x32_bf16 v[12:15], v[216:219], v[68:71], v[12:15]
    v_mfma_f32_16x16x32_bf16 v[16:19], v[220:223], v[68:71], v[16:19]
    v_add_f32 v20, v20, v54
    v_cvt_pk_bf16_f32 v75, v54, v54
    v_and_b32 v64, v75, v4
    v_and_b32 v65, v75, v5
    v_and_b32 v66, v75, v6
    v_and_b32 v67, v75, v7
    s_nop 1
    v_mfma_f32_16x16x32_bf16 v[12:15], v[240:243], v[64:67], v[12:15]
    v_mfma_f32_16x16x32_bf16 v[16:19], v[244:247], v[64:67], v[16:19]
    v_add_f32 v20, v20, v55
    v_cvt_pk_bf16_f32 v75, v55, v55
    v_and_b32 v68, v75, v4
    v_and_b32 v69, v75, v5
    v_and_b32 v70, v75, v6
    v_and_b32 v71, v75, v7
    s_nop 1
    v_mfma_f32_16x16x32_bf16 v[12:15], v[248:251], v[68:71], v[12:15]
    v_mfma_f32_16x16x32_bf16 v[16:19], v[252:255], v[68:71], v[16:19]
    s_waitcnt vmcnt(15)
    s_add_u32 m0, s97, 0x1000
    s_nop 0
    buffer_load_dwordx4 v2, s[8:11], s57 offen nt lds
    s_waitcnt vmcnt(13)
    ds_read_b128 v[112:115], v3
    ds_read_b128 v[116:119], v3 offset:1024
    ds_read_b128 v[120:123], v3 offset:2048
    ds_read_b128 v[124:127], v3 offset:3072
    s_waitcnt lgkmcnt(3)
    v_mfma_f32_16x16x32_bf16 v[56:59], v[112:115], v[32:35], 0
    s_waitcnt lgkmcnt(2)
    v_mfma_f32_16x16x32_bf16 v[56:59], v[116:119], v[36:39], v[56:59]
    s_waitcnt lgkmcnt(1)
    v_mfma_f32_16x16x32_bf16 v[56:59], v[120:123], v[40:43], v[56:59]
    s_waitcnt lgkmcnt(0)
    v_mfma_f32_16x16x32_bf16 v[56:59], v[124:127], v[44:47], v[56:59]
    s_add_u32 m0, s97, 0x1300
    s_nop 0
    buffer_load_dwordx4 v2, s[8:11], s57 offen offset:256 nt lds
    s_add_u32 m0, s97, 0x1600
    s_nop 0
    buffer_load_dwordx4 v2, s[8:11], s57 offen offset:512 nt lds
    s_add_u32 m0, s97, 0x1900
    s_nop 0
    buffer_load_dwordx4 v2, s[8:11], s57 offen offset:768 nt lds
    s_waitcnt vmcnt(12)
    ds_read_b128 v[80:83], v3 offset:8192
    ds_read_b128 v[84:87], v3 offset:9216
    ds_read_b128 v[88:91], v3 offset:10240
    ds_read_b128 v[92:95], v3 offset:11264
    s_waitcnt lgkmcnt(3)
    v_mfma_f32_16x16x32_bf16 v[60:63], v[80:83], v[32:35], 0
    s_waitcnt lgkmcnt(2)
    v_mfma_f32_16x16x32_bf16 v[60:63], v[84:87], v[36:39], v[60:63]
    s_waitcnt lgkmcnt(1)
    v_mfma_f32_16x16x32_bf16 v[60:63], v[88:91], v[40:43], v[60:63]
    s_waitcnt lgkmcnt(0)
    v_mfma_f32_16x16x32_bf16 v[60:63], v[92:95], v[44:47], v[60:63]
    s_add_u32 m0, s97, 0x3000
    s_nop 0
    buffer_load_dwordx4 v2, s[8:11], s58 offen nt lds
    s_add_u32 m0, s97, 0x3300
    s_nop 0
    buffer_load_dwordx4 v2, s[8:11], s58 offen offset:256 nt lds
    s_add_u32 m0, s97, 0x3600
    s_nop 0
    buffer_load_dwordx4 v2, s[8:11], s58 offen offset:512 nt lds
    s_add_u32 m0, s97, 0x3900
    s_nop 0
    buffer_load_dwordx4 v2, s[8:11], s58 offen offset:768 nt lds
    v_add_f32_dpp v48, v56, v57 quad_perm:[1,0,3,2] row_mask:0xf bank_mask:0xf
    v_add_f32_dpp v49, v58, v59 quad_perm:[1,0,3,2] row_mask:0xf bank_mask:0xf
    s_waitcnt vmcnt(12)
    ds_read_b128 v[96:99], v3 offset:16384
    ds_read_b128 v[100:103], v3 offset:17408
    ds_read_b128 v[104:107], v3 offset:18432
    ds_read_b128 v[108:111], v3 offset:19456
    s_waitcnt lgkmcnt(3)
    v_mfma_f32_16x16x32_bf16 v[56:59], v[96:99], v[32:35], 0
    s_waitcnt lgkmcnt(2)
    v_mfma_f32_16x16x32_bf16 v[56:59], v[100:103], v[36:39], v[56:59]
    s_waitcnt lgkmcnt(1)
    v_mfma_f32_16x16x32_bf16 v[56:59], v[104:107], v[40:43], v[56:59]
    s_waitcnt lgkmcnt(0)
    v_mfma_f32_16x16x32_bf16 v[56:59], v[108:111], v[44:47], v[56:59]
    s_add_u32 m0, s97, 0x5000
    s_nop 0
    buffer_load_dwordx4 v2, s[8:11], s59 offen nt lds
    s_add_u32 m0, s97, 0x5300
    s_nop 0
    buffer_load_dwordx4 v2, s[8:11], s59 offen offset:256 nt lds
    s_add_u32 m0, s97, 0x5600
    s_nop 0
    buffer_load_dwordx4 v2, s[8:11], s59 offen offset:512 nt lds
    s_add_u32 m0, s97, 0x5900
    s_nop 0
    buffer_load_dwordx4 v2, s[8:11], s59 offen offset:768 nt lds
    v_add_f32_dpp v50, v60, v61 quad_perm:[1,0,3,2] row_mask:0xf bank_mask:0xf
    v_add_f32_dpp v51, v62, v63 quad_perm:[1,0,3,2] row_mask:0xf bank_mask:0xf
    s_waitcnt vmcnt(12)
    ds_read_b128 v[112:115], v3 offset:24576
    ds_read_b128 v[116:119], v3 offset:25600
    ds_read_b128 v[120:123], v3 offset:26624
    ds_read_b128 v[124:127], v3 offset:27648
    s_waitcnt lgkmcnt(3)
    v_mfma_f32_16x16x32_bf16 v[60:63], v[112:115], v[32:35], 0
    s_waitcnt lgkmcnt(2)
    v_mfma_f32_16x16x32_bf16 v[60:63], v[116:119], v[36:39], v[60:63]
    s_waitcnt lgkmcnt(1)
    v_mfma_f32_16x16x32_bf16 v[60:63], v[120:123], v[40:43], v[60:63]
    s_waitcnt lgkmcnt(0)
    v_mfma_f32_16x16x32_bf16 v[60:63], v[124:127], v[44:47], v[60:63]
    s_add_u32 m0, s97, 0x7000
    s_nop 0
    buffer_load_dwordx4 v2, s[8:11], s56 offen nt lds
    s_add_u32 m0, s97, 0x7300
    s_nop 0
    buffer_load_dwordx4 v2, s[8:11], s56 offen offset:256 nt lds
    s_add_u32 m0, s97, 0x7600
    s_nop 0
    buffer_load_dwordx4 v2, s[8:11], s56 offen offset:512 nt lds
    s_add_u32 m0, s97, 0x7900
    s_nop 0
    buffer_load_dwordx4 v2, s[8:11], s56 offen offset:768 nt lds
    v_add_f32_dpp v52, v56, v57 quad_perm:[1,0,3,2] row_mask:0xf bank_mask:0xf
    v_add_f32_dpp v53, v58, v59 quad_perm:[1,0,3,2] row_mask:0xf bank_mask:0xf
    v_add_f32_dpp v54, v60, v61 quad_perm:[1,0,3,2] row_mask:0xf bank_mask:0xf
    v_add_f32_dpp v55, v62, v63 quad_perm:[1,0,3,2] row_mask:0xf bank_mask:0xf
    v_max3_f32 v72, v48, v49, v50
    v_max3_f32 v72, v72, v51, v52
    v_max3_f32 v72, v72, v53, v54
    v_max_f32 v72, v72, v55
    s_nop 1
    v_max_f32_dpp v72, v72, v72 row_bcast:15 row_mask:0xa bank_mask:0xf
    s_nop 1
    v_max_f32_dpp v72, v72, v72 row_bcast:31 row_mask:0xc bank_mask:0xf
    v_max_f32 v72, s60, v72
    s_nop 0
    v_readlane_b32 s60, v72, 63
    s_nop 1
    v_mul_f32 v73, s60, v9
    v_sub_f32 v74, v73, v21
    v_exp_f32 v74, v74
    v_mov_b32 v21, v73
    v_mul_f32 v20, v20, v74
    v_mul_f32 v12, v12, v74
    v_mul_f32 v13, v13, v74
    v_mul_f32 v14, v14, v74
    v_mul_f32 v15, v15, v74
    v_mul_f32 v16, v16, v74
    v_mul_f32 v17, v17, v74
    v_mul_f32 v18, v18, v74
    v_mul_f32 v19, v19, v74
    v_fma_f32 v48, v48, v8, v21
    v_fma_f32 v49, v49, v8, v21
    v_fma_f32 v50, v50, v8, v21
    v_fma_f32 v51, v51, v8, v21
    v_fma_f32 v52, v52, v8, v21
    v_fma_f32 v53, v53, v8, v21
    v_fma_f32 v54, v54, v8, v21
    v_fma_f32 v55, v55, v8, v21
    v_exp_f32 v48, v48
    v_exp_f32 v49, v49
    v_exp_f32 v50, v50
    v_exp_f32 v51, v51
    v_exp_f32 v52, v52
    v_exp_f32 v53, v53
    v_exp_f32 v54, v54
    v_exp_f32 v55, v55
    s_waitcnt vmcnt(12)
    ds_read_b128 v[80:83], v3 offset:4096
    ds_read_b128 v[84:87], v3 offset:5120
    ds_read_b128 v[88:91], v3 offset:6144
    ds_read_b128 v[92:95], v3 offset:7168
    v_add_f32 v20, v20, v48
    v_cvt_pk_bf16_f32 v75, v48, v48
    v_and_b32 v64, v75, v4
    v_and_b32 v65, v75, v5
    v_and_b32 v66, v75, v6
    v_and_b32 v67, v75, v7
    s_waitcnt lgkmcnt(3)
    s_nop 0
    v_mfma_f32_16x16x32_bf16 v[12:15], v[80:83], v[64:67], v[12:15]
    s_waitcnt lgkmcnt(2)
    v_mfma_f32_16x16x32_bf16 v[16:19], v[84:87], v[64:67], v[16:19]
    v_add_f32 v20, v20, v49
    v_cvt_pk_bf16_f32 v75, v49, v49
    v_and_b32 v68, v75, v4
    v_and_b32 v69, v75, v5
    v_and_b32 v70, v75, v6
    v_and_b32 v71, v75, v7
    s_waitcnt lgkmcnt(1)
    s_nop 0
    v_mfma_f32_16x16x32_bf16 v[12:15], v[88:91], v[68:71], v[12:15]
    s_waitcnt lgkmcnt(0)
    v_mfma_f32_16x16x32_bf16 v[16:19], v[92:95], v[68:71], v[16:19]
    s_add_u32 s57, s54, 0x11000
    buffer_load_dwordx4 v[96:99], v1, s[4:7], s57 offen
    buffer_load_dwordx4 v[100:103], v1, s[4:7], s57 offen offset:128
    buffer_load_dwordx4 v[104:107], v1, s[4:7], s57 offen offset:256
    buffer_load_dwordx4 v[108:111], v1, s[4:7], s57 offen offset:384
    s_waitcnt vmcnt(12)
    ds_read_b128 v[112:115], v3 offset:12288
    ds_read_b128 v[116:119], v3 offset:13312
    ds_read_b128 v[120:123], v3 offset:14336
    ds_read_b128 v[124:127], v3 offset:15360
    v_add_f32 v20, v20, v50
    v_cvt_pk_bf16_f32 v75, v50, v50
    v_and_b32 v64, v75, v4
    v_and_b32 v65, v75, v5
    v_and_b32 v66, v75, v6
    v_and_b32 v67, v75, v7
    s_waitcnt lgkmcnt(3)
    s_nop 0
    v_mfma_f32_16x16x32_bf16 v[12:15], v[112:115], v[64:67], v[12:15]
    s_waitcnt lgkmcnt(2)
    v_mfma_f32_16x16x32_bf16 v[16:19], v[116:119], v[64:67], v[16:19]
    v_add_f32 v20, v20, v51
    v_cvt_pk_bf16_f32 v75, v51, v51
    v_and_b32 v68, v75, v4
    v_and_b32 v69, v75, v5
    v_and_b32 v70, v75, v6
    v_and_b32 v71, v75, v7
    s_waitcnt lgkmcnt(1)
    s_nop 0
    v_mfma_f32_16x16x32_bf16 v[12:15], v[120:123], v[68:71], v[12:15]
    s_waitcnt lgkmcnt(0)
    v_mfma_f32_16x16x32_bf16 v[16:19], v[124:127], v[68:71], v[16:19]
    buffer_load_dwordx4 v[80:83], v1, s[4:7], s20 offen
    buffer_load_dwordx4 v[84:87], v1, s[4:7], s20 offen offset:128
    buffer_load_dwordx4 v[88:91], v1, s[4:7], s20 offen offset:256
    buffer_load_dwordx4 v[92:95], v1, s[4:7], s20 offen offset:384
    s_waitcnt vmcnt(12)
    ds_read_b128 v[112:115], v3 offset:20480
    ds_read_b128 v[116:119], v3 offset:21504
    ds_read_b128 v[120:123], v3 offset:22528
    ds_read_b128 v[124:127], v3 offset:23552
    v_add_f32 v20, v20, v52
    v_cvt_pk_bf16_f32 v75, v52, v52
    v_and_b32 v64, v75, v4
    v_and_b32 v65, v75, v5
    v_and_b32 v66, v75, v6
    v_and_b32 v67, v75, v7
    s_waitcnt lgkmcnt(3)
    s_nop 0
    v_mfma_f32_16x16x32_bf16 v[12:15], v[112:115], v[64:67], v[12:15]
    s_waitcnt lgkmcnt(2)
    v_mfma_f32_16x16x32_bf16 v[16:19], v[116:119], v[64:67], v[16:19]
    v_add_f32 v20, v20, v53
    v_cvt_pk_bf16_f32 v75, v53, v53
    v_and_b32 v68, v75, v4
    v_and_b32 v69, v75, v5
    v_and_b32 v70, v75, v6
    v_and_b32 v71, v75, v7
    s_waitcnt lgkmcnt(1)
    s_nop 0
    v_mfma_f32_16x16x32_bf16 v[12:15], v[120:123], v[68:71], v[12:15]
    s_waitcnt lgkmcnt(0)
    v_mfma_f32_16x16x32_bf16 v[16:19], v[124:127], v[68:71], v[16:19]
    s_waitcnt vmcnt(8)
    ds_read_b128 v[112:115], v3 offset:28672
    ds_read_b128 v[116:119], v3 offset:29696
    ds_read_b128 v[120:123], v3 offset:30720
    ds_read_b128 v[124:127], v3 offset:31744
    v_add_f32 v20, v20, v54
    v_cvt_pk_bf16_f32 v75, v54, v54
    v_and_b32 v64, v75, v4
    v_and_b32 v65, v75, v5
    v_and_b32 v66, v75, v6
    v_and_b32 v67, v75, v7
    s_waitcnt lgkmcnt(3)
    s_nop 0
    v_mfma_f32_16x16x32_bf16 v[12:15], v[112:115], v[64:67], v[12:15]
    s_waitcnt lgkmcnt(2)
    v_mfma_f32_16x16x32_bf16 v[16:19], v[116:119], v[64:67], v[16:19]
    v_add_f32 v20, v20, v55
    v_cvt_pk_bf16_f32 v75, v55, v55
    v_and_b32 v68, v75, v4
    v_and_b32 v69, v75, v5
    v_and_b32 v70, v75, v6
    v_and_b32 v71, v75, v7
    s_waitcnt lgkmcnt(1)
    s_nop 0
    v_mfma_f32_16x16x32_bf16 v[12:15], v[120:123], v[68:71], v[12:15]
    s_waitcnt lgkmcnt(0)
    v_mfma_f32_16x16x32_bf16 v[16:19], v[124:127], v[68:71], v[16:19]
    s_waitcnt vmcnt(7)
    v_mfma_f32_16x16x32_bf16 v[56:59], v[96:99], v[32:35], 0
    s_waitcnt vmcnt(6)
    v_mfma_f32_16x16x32_bf16 v[56:59], v[100:103], v[36:39], v[56:59]
    s_waitcnt vmcnt(5)
    v_mfma_f32_16x16x32_bf16 v[56:59], v[104:107], v[40:43], v[56:59]
    s_waitcnt vmcnt(4)
    v_mfma_f32_16x16x32_bf16 v[56:59], v[108:111], v[44:47], v[56:59]
    buffer_load_dwordx4 v[112:115], v2, s[8:11], s57 offen
    buffer_load_dwordx4 v[116:119], v2, s[8:11], s57 offen offset:256
    s_waitcnt vmcnt(5)
    v_mfma_f32_16x16x32_bf16 v[60:63], v[80:83], v[32:35], 0
    s_waitcnt vmcnt(4)
    v_mfma_f32_16x16x32_bf16 v[60:63], v[84:87], v[36:39], v[60:63]
    s_waitcnt vmcnt(3)
    v_mfma_f32_16x16x32_bf16 v[60:63], v[88:91], v[40:43], v[60:63]
    s_waitcnt vmcnt(2)
    v_mfma_f32_16x16x32_bf16 v[60:63], v[92:95], v[44:47], v[60:63]
    buffer_load_dwordx4 v[120:123], v2, s[8:11], s57 offen offset:512
    buffer_load_dwordx4 v[124:127], v2, s[8:11], s57 offen offset:768
    buffer_load_dwordx4 v[96:99], v2, s[8:11], s20 offen
    buffer_load_dwordx4 v[100:103], v2, s[8:11], s20 offen offset:256
    v_add_f32_dpp v48, v56, v57 quad_perm:[1,0,3,2] row_mask:0xf bank_mask:0xf
    v_add_f32_dpp v49, v58, v59 quad_perm:[1,0,3,2] row_mask:0xf bank_mask:0xf
    s_nop 1
    v_add_f32_dpp v50, v60, v61 quad_perm:[1,0,3,2] row_mask:0xf bank_mask:0xf
    v_add_f32 v50, s22, v50
    v_add_f32_dpp v51, v62, v63 quad_perm:[1,0,3,2] row_mask:0xf bank_mask:0xf
    v_add_f32 v51, s22, v51
    v_max3_f32 v72, v48, v49, v50
    v_max_f32 v72, v72, v51
    s_nop 1
    v_max_f32_dpp v72, v72, v72 row_bcast:15 row_mask:0xa bank_mask:0xf
    s_nop 1
    v_max_f32_dpp v72, v72, v72 row_bcast:31 row_mask:0xc bank_mask:0xf
    v_max_f32 v72, s60, v72
    s_nop 0
    v_readlane_b32 s60, v72, 63
    s_nop 1
    v_mul_f32 v73, s60, v9
    v_sub_f32 v74, v73, v21
    v_exp_f32 v74, v74
    v_mov_b32 v21, v73
    v_mul_f32 v20, v20, v74
    v_mul_f32 v12, v12, v74
    v_mul_f32 v13, v13, v74
    v_mul_f32 v14, v14, v74
    v_mul_f32 v15, v15, v74
    v_mul_f32 v16, v16, v74
    v_mul_f32 v17, v17, v74
    v_mul_f32 v18, v18, v74
    v_mul_f32 v19, v19, v74
    v_fma_f32 v48, v48, v8, v21
    v_fma_f32 v49, v49, v8, v21
    v_fma_f32 v50, v50, v8, v21
    v_fma_f32 v51, v51, v8, v21
    v_exp_f32 v48, v48
    v_exp_f32 v49, v49
    v_exp_f32 v50, v50
    v_exp_f32 v51, v51
    v_add_f32 v20, v20, v48
    v_cvt_pk_bf16_f32 v75, v48, v48
    v_and_b32 v64, v75, v4
    v_and_b32 v65, v75, v5
    v_and_b32 v66, v75, v6
    v_and_b32 v67, v75, v7
    s_waitcnt vmcnt(5)
    s_nop 0
    v_mfma_f32_16x16x32_bf16 v[12:15], v[112:115], v[64:67], v[12:15]
    s_waitcnt vmcnt(4)
    v_mfma_f32_16x16x32_bf16 v[16:19], v[116:119], v[64:67], v[16:19]
    v_add_f32 v20, v20, v49
    v_cvt_pk_bf16_f32 v75, v49, v49
    v_and_b32 v68, v75, v4
    v_and_b32 v69, v75, v5
    v_and_b32 v70, v75, v6
    v_and_b32 v71, v75, v7
    s_waitcnt vmcnt(3)
    s_nop 0
    v_mfma_f32_16x16x32_bf16 v[12:15], v[120:123], v[68:71], v[12:15]
    s_waitcnt vmcnt(2)
    v_mfma_f32_16x16x32_bf16 v[16:19], v[124:127], v[68:71], v[16:19]
    buffer_load_dwordx4 v[104:107], v2, s[8:11], s20 offen offset:512
    buffer_load_dwordx4 v[108:111], v2, s[8:11], s20 offen offset:768
    buffer_load_dwordx4 v[80:83], v1, s[4:7], s21 offen
    buffer_load_dwordx4 v[84:87], v1, s[4:7], s21 offen offset:128
    v_add_f32 v20, v20, v50
    v_cvt_pk_bf16_f32 v75, v50, v50
    v_and_b32 v64, v75, v4
    v_and_b32 v65, v75, v5
    v_and_b32 v66, v75, v6
    v_and_b32 v67, v75, v7
    s_waitcnt vmcnt(5)
    s_nop 0
    v_mfma_f32_16x16x32_bf16 v[12:15], v[96:99], v[64:67], v[12:15]
    s_waitcnt vmcnt(4)
    v_mfma_f32_16x16x32_bf16 v[16:19], v[100:103], v[64:67], v[16:19]
    v_add_f32 v20, v20, v51
    v_cvt_pk_bf16_f32 v75, v51, v51
    v_and_b32 v68, v75, v4
    v_and_b32 v69, v75, v5
    v_and_b32 v70, v75, v6
    v_and_b32 v71, v75, v7
    s_waitcnt vmcnt(3)
    s_nop 0
    v_mfma_f32_16x16x32_bf16 v[12:15], v[104:107], v[68:71], v[12:15]
    s_waitcnt vmcnt(2)
    v_mfma_f32_16x16x32_bf16 v[16:19], v[108:111], v[68:71], v[16:19]
    buffer_load_dwordx4 v[88:91], v1, s[4:7], s21 offen offset:256
    buffer_load_dwordx4 v[92:95], v1, s[4:7], s21 offen offset:384
    s_add_u32 s58, s55, 0
    buffer_load_dwordx4 v[112:115], v1, s[4:7], s58 offen
    buffer_load_dwordx4 v[116:119], v1, s[4:7], s58 offen offset:128
    v_add_f32_dpp v20, v20, v20 row_bcast:15 row_mask:0xa bank_mask:0xf
    s_nop 1
    v_add_f32_dpp v20, v20, v20 row_bcast:31 row_mask:0xc bank_mask:0xf
    s_nop 0
    v_readlane_b32 s63, v20, 63
    s_mov_b64 exec, s[64:65]
    ds_write_b32 v11, v12
    ds_write_b32 v11, v13 offset:32
    ds_write_b32 v11, v14 offset:64
    ds_write_b32 v11, v15 offset:96
    ds_write_b32 v11, v16 offset:512
    ds_write_b32 v11, v17 offset:544
    ds_write_b32 v11, v18 offset:576
    ds_write_b32 v11, v19 offset:608
    s_mov_b64 exec, -1
    v_mov_b32 v72, s60
    v_mov_b32 v73, s63
    ds_write_b64 v10, v[72:73] offset:1024
    s_waitcnt lgkmcnt(0)
    s_mov_b64 exec, 1
    v_mov_b32 v72, 1
    v_mov_b32 v73, 0x22080
    ds_add_rtn_u32 v74, v73, v72
    s_mov_b64 exec, -1
    s_waitcnt lgkmcnt(0)
    v_readfirstlane_b32 s63, v74
    s_cmp_lg_u32 s63, 3
    s_cbranch_scc1 L5
    v_lshlrev_b32 v77, 4, v0
    v_add_u32 v77, 0x20000, v77
    v_mov_b32 v76, 0x20000
    ds_read_b128 v[48:51], v77
    ds_read_b64 v[64:65], v76 offset:1024
    ds_read_b128 v[52:55], v77 offset:1040
    ds_read_b64 v[66:67], v76 offset:2064
    ds_read_b128 v[56:59], v77 offset:2080
    ds_read_b64 v[68:69], v76 offset:3104
    ds_read_b128 v[60:63], v77 offset:3120
    ds_read_b64 v[70:71], v76 offset:4144
    s_waitcnt lgkmcnt(0)
    v_max3_f32 v72, v64, v66, v68
    v_max_f32 v72, v72, v70
    v_sub_f32 v64, v64, v72
    v_mul_f32 v64, v64, v8
    v_exp_f32 v64, v64
    v_sub_f32 v66, v66, v72
    v_mul_f32 v66, v66, v8
    v_exp_f32 v66, v66
    v_sub_f32 v68, v68, v72
    v_mul_f32 v68, v68, v8
    v_exp_f32 v68, v68
    v_sub_f32 v70, v70, v72
    v_mul_f32 v70, v70, v8
    v_exp_f32 v70, v70
    v_mul_f32 v73, v64, v65
    v_fmac_f32 v73, v66, v67
    v_fmac_f32 v73, v68, v69
    v_fmac_f32 v73, v70, v71
    v_mul_f32 v48, v48, v64
    v_fmac_f32 v48, v52, v66
    v_fmac_f32 v48, v56, v68
    v_fmac_f32 v48, v60, v70
    v_mul_f32 v49, v49, v64
    v_fmac_f32 v49, v53, v66
    v_fmac_f32 v49, v57, v68
    v_fmac_f32 v49, v61, v70
    v_mul_f32 v50, v50, v64
    v_fmac_f32 v50, v54, v66
    v_fmac_f32 v50, v58, v68
    v_fmac_f32 v50, v62, v70
    v_mul_f32 v51, v51, v64
    v_fmac_f32 v51, v55, v66
    v_fmac_f32 v51, v59, v68
    v_fmac_f32 v51, v63, v70
    v_cvt_pk_bf16_f32 v74, v48, v49
    v_cvt_pk_bf16_f32 v75, v50, v51
    v_lshlrev_b32 v76, 3, v0
    s_lshl_b32 s63, s23, 9
    s_add_u32 s63, s63, 0x10000
    s_cmp_eq_u32 s3, 1
    s_cbranch_scc1 L6
    buffer_store_dwordx2 v[74:75], v76, s[12:15], s63 offen sc1
    s_branch L7
L6:
    s_nop 7
    buffer_store_dwordx2 v[74:75], v76, s[12:15], s63 offen
L7:
    s_nop 7
    s_lshl_b32 s63, s23, 3
    s_add_u32 s63, s63, 0x8000
    s_mov_b64 exec, 1
    s_cmp_eq_u32 s3, 1
    s_cbranch_scc1 L8
    buffer_store_dwordx2 v[72:73], v76, s[12:15], s63 offen sc1
    s_branch L9
L8:
    s_nop 7
    buffer_store_dwordx2 v[72:73], v76, s[12:15], s63 offen
L9:
    s_nop 7
    s_mov_b64 exec, -1
L5:
    s_nop 7
    v_and_b32 v73, 0x7f, v1
    v_add_u32 v73, 0x22300, v73
    ds_read_b128 v[32:35], v73
    ds_read_b128 v[36:39], v73 offset:128
    ds_read_b128 v[40:43], v73 offset:256
    ds_read_b128 v[44:47], v73 offset:384
    s_waitcnt lgkmcnt(0)
    v_mov_b32 v30, 0
    s_waitcnt vmcnt(5)
    v_mfma_f32_16x16x32_bf16 v[56:59], v[80:83], v[32:35], 0
    s_waitcnt vmcnt(4)
    v_mfma_f32_16x16x32_bf16 v[56:59], v[84:87], v[36:39], v[56:59]
    s_waitcnt vmcnt(3)
    v_mfma_f32_16x16x32_bf16 v[56:59], v[88:91], v[40:43], v[56:59]
    s_waitcnt vmcnt(2)
    v_mfma_f32_16x16x32_bf16 v[56:59], v[92:95], v[44:47], v[56:59]
    buffer_load_dwordx4 v[120:123], v1, s[4:7], s58 offen offset:256
    buffer_load_dwordx4 v[124:127], v1, s[4:7], s58 offen offset:384
    buffer_load_dwordx4 v[96:99], v2, s[8:11], s21 offen
    buffer_load_dwordx4 v[100:103], v2, s[8:11], s21 offen offset:256
    s_waitcnt vmcnt(5)
    v_mfma_f32_16x16x32_bf16 v[60:63], v[112:115], v[32:35], 0
    s_waitcnt vmcnt(4)
    v_mfma_f32_16x16x32_bf16 v[60:63], v[116:119], v[36:39], v[60:63]
    s_waitcnt vmcnt(3)
    v_mfma_f32_16x16x32_bf16 v[60:63], v[120:123], v[40:43], v[60:63]
    s_waitcnt vmcnt(2)
    v_mfma_f32_16x16x32_bf16 v[60:63], v[124:127], v[44:47], v[60:63]
    buffer_load_dwordx4 v[104:107], v2, s[8:11], s21 offen offset:512
    buffer_load_dwordx4 v[108:111], v2, s[8:11], s21 offen offset:768
    buffer_load_dwordx4 v[80:83], v2, s[8:11], s58 offen
    buffer_load_dwordx4 v[84:87], v2, s[8:11], s58 offen offset:256
    v_add_f32_dpp v48, v56, v57 quad_perm:[1,0,3,2] row_mask:0xf bank_mask:0xf
    v_add_f32 v48, s22, v48
    v_add_f32_dpp v49, v58, v59 quad_perm:[1,0,3,2] row_mask:0xf bank_mask:0xf
    v_add_f32 v49, s22, v49
    v_add_f32_dpp v50, v60, v61 quad_perm:[1,0,3,2] row_mask:0xf bank_mask:0xf
    v_add_f32_dpp v51, v62, v63 quad_perm:[1,0,3,2] row_mask:0xf bank_mask:0xf
    v_max3_f32 v72, v48, v49, v50
    v_max_f32 v72, v72, v51
    s_nop 1
    v_max_f32_dpp v72, v72, v72 row_bcast:15 row_mask:0xa bank_mask:0xf
    s_nop 1
    v_max_f32_dpp v72, v72, v72 row_bcast:31 row_mask:0xc bank_mask:0xf
    s_nop 0
    v_readlane_b32 s61, v72, 63
    s_nop 1
    v_mul_f32 v31, s61, v9
    v_fma_f32 v48, v48, v8, v31
    v_fma_f32 v49, v49, v8, v31
    v_fma_f32 v50, v50, v8, v31
    v_fma_f32 v51, v51, v8, v31
    v_exp_f32 v48, v48
    v_exp_f32 v49, v49
    v_exp_f32 v50, v50
    v_exp_f32 v51, v51
    v_add_f32 v30, v30, v48
    v_cvt_pk_bf16_f32 v75, v48, v48
    v_and_b32 v64, v75, v4
    v_and_b32 v65, v75, v5
    v_and_b32 v66, v75, v6
    v_and_b32 v67, v75, v7
    s_waitcnt vmcnt(5)
    s_nop 0
    v_mfma_f32_16x16x32_bf16 v[22:25], v[96:99], v[64:67], 0
    s_waitcnt vmcnt(4)
    v_mfma_f32_16x16x32_bf16 v[26:29], v[100:103], v[64:67], 0
    v_add_f32 v30, v30, v49
    v_cvt_pk_bf16_f32 v75, v49, v49
    v_and_b32 v68, v75, v4
    v_and_b32 v69, v75, v5
    v_and_b32 v70, v75, v6
    v_and_b32 v71, v75, v7
    s_waitcnt vmcnt(3)
    s_nop 0
    v_mfma_f32_16x16x32_bf16 v[22:25], v[104:107], v[68:71], v[22:25]
    s_waitcnt vmcnt(2)
    v_mfma_f32_16x16x32_bf16 v[26:29], v[108:111], v[68:71], v[26:29]
    buffer_load_dwordx4 v[88:91], v2, s[8:11], s58 offen offset:512
    buffer_load_dwordx4 v[92:95], v2, s[8:11], s58 offen offset:768
    s_add_u32 s59, s55, 0x1000
    buffer_load_dwordx4 v[112:115], v1, s[4:7], s59 offen
    buffer_load_dwordx4 v[116:119], v1, s[4:7], s59 offen offset:128
    v_add_f32 v30, v30, v50
    v_cvt_pk_bf16_f32 v75, v50, v50
    v_and_b32 v64, v75, v4
    v_and_b32 v65, v75, v5
    v_and_b32 v66, v75, v6
    v_and_b32 v67, v75, v7
    s_waitcnt vmcnt(5)
    s_nop 0
    v_mfma_f32_16x16x32_bf16 v[22:25], v[80:83], v[64:67], v[22:25]
    s_waitcnt vmcnt(4)
    v_mfma_f32_16x16x32_bf16 v[26:29], v[84:87], v[64:67], v[26:29]
    v_add_f32 v30, v30, v51
    v_cvt_pk_bf16_f32 v75, v51, v51
    v_and_b32 v68, v75, v4
    v_and_b32 v69, v75, v5
    v_and_b32 v70, v75, v6
    v_and_b32 v71, v75, v7
    s_waitcnt vmcnt(3)
    s_nop 0
    v_mfma_f32_16x16x32_bf16 v[22:25], v[88:91], v[68:71], v[22:25]
    s_waitcnt vmcnt(2)
    v_mfma_f32_16x16x32_bf16 v[26:29], v[92:95], v[68:71], v[26:29]
    buffer_load_dwordx4 v[120:123], v1, s[4:7], s59 offen offset:256
    buffer_load_dwordx4 v[124:127], v1, s[4:7], s59 offen offset:384
    s_add_u32 s56, s55, 0x2000
    buffer_load_dwordx4 v[96:99], v1, s[4:7], s56 offen
    buffer_load_dwordx4 v[100:103], v1, s[4:7], s56 offen offset:128
    s_waitcnt vmcnt(5)
    v_mfma_f32_16x16x32_bf16 v[56:59], v[112:115], v[32:35], 0
    s_waitcnt vmcnt(4)
    v_mfma_f32_16x16x32_bf16 v[56:59], v[116:119], v[36:39], v[56:59]
    s_waitcnt vmcnt(3)
    v_mfma_f32_16x16x32_bf16 v[56:59], v[120:123], v[40:43], v[56:59]
    s_waitcnt vmcnt(2)
    v_mfma_f32_16x16x32_bf16 v[56:59], v[124:127], v[44:47], v[56:59]
    buffer_load_dwordx4 v[104:107], v1, s[4:7], s56 offen offset:256
    buffer_load_dwordx4 v[108:111], v1, s[4:7], s56 offen offset:384
    buffer_load_dwordx4 v[80:83], v2, s[8:11], s59 offen
    buffer_load_dwordx4 v[84:87], v2, s[8:11], s59 offen offset:256
    buffer_load_dwordx4 v[88:91], v2, s[8:11], s59 offen offset:512
    buffer_load_dwordx4 v[92:95], v2, s[8:11], s59 offen offset:768
    buffer_load_dwordx4 v[112:115], v2, s[8:11], s56 offen
    buffer_load_dwordx4 v[116:119], v2, s[8:11], s56 offen offset:256
    buffer_load_dwordx4 v[120:123], v2, s[8:11], s56 offen offset:512
    buffer_load_dwordx4 v[124:127], v2, s[8:11], s56 offen offset:768
    s_waitcnt vmcnt(11)
    v_mfma_f32_16x16x32_bf16 v[60:63], v[96:99], v[32:35], 0
    s_waitcnt vmcnt(10)
    v_mfma_f32_16x16x32_bf16 v[60:63], v[100:103], v[36:39], v[60:63]
    s_waitcnt vmcnt(9)
    v_mfma_f32_16x16x32_bf16 v[60:63], v[104:107], v[40:43], v[60:63]
    s_waitcnt vmcnt(8)
    v_mfma_f32_16x16x32_bf16 v[60:63], v[108:111], v[44:47], v[60:63]
    s_add_u32 s57, s55, 0x3000
    buffer_load_dwordx4 v[96:99], v1, s[4:7], s57 offen
    buffer_load_dwordx4 v[100:103], v1, s[4:7], s57 offen offset:128
    buffer_load_dwordx4 v[104:107], v1, s[4:7], s57 offen offset:256
    buffer_load_dwordx4 v[108:111], v1, s[4:7], s57 offen offset:384
    v_add_f32_dpp v48, v56, v57 quad_perm:[1,0,3,2] row_mask:0xf bank_mask:0xf
    v_add_f32_dpp v49, v58, v59 quad_perm:[1,0,3,2] row_mask:0xf bank_mask:0xf
    s_nop 0
    v_add_f32_dpp v50, v60, v61 quad_perm:[1,0,3,2] row_mask:0xf bank_mask:0xf
    v_add_f32_dpp v51, v62, v63 quad_perm:[1,0,3,2] row_mask:0xf bank_mask:0xf
    v_max3_f32 v72, v48, v49, v50
    v_max_f32 v72, v72, v51
    s_nop 1
    v_max_f32_dpp v72, v72, v72 row_bcast:15 row_mask:0xa bank_mask:0xf
    s_nop 1
    v_max_f32_dpp v72, v72, v72 row_bcast:31 row_mask:0xc bank_mask:0xf
    v_max_f32 v72, s61, v72
    s_nop 0
    v_readlane_b32 s61, v72, 63
    s_nop 1
    v_mul_f32 v73, s61, v9
    v_sub_f32 v74, v73, v31
    v_exp_f32 v74, v74
    v_mov_b32 v31, v73
    v_mul_f32 v30, v30, v74
    v_mul_f32 v22, v22, v74
    v_mul_f32 v23, v23, v74
    v_mul_f32 v24, v24, v74
    v_mul_f32 v25, v25, v74
    v_mul_f32 v26, v26, v74
    v_mul_f32 v27, v27, v74
    v_mul_f32 v28, v28, v74
    v_mul_f32 v29, v29, v74
    v_fma_f32 v48, v48, v8, v31
    v_fma_f32 v49, v49, v8, v31
    v_fma_f32 v50, v50, v8, v31
    v_fma_f32 v51, v51, v8, v31
    v_exp_f32 v48, v48
    v_exp_f32 v49, v49
    v_exp_f32 v50, v50
    v_exp_f32 v51, v51
    v_add_f32 v30, v30, v48
    v_cvt_pk_bf16_f32 v75, v48, v48
    v_and_b32 v64, v75, v4
    v_and_b32 v65, v75, v5
    v_and_b32 v66, v75, v6
    v_and_b32 v67, v75, v7
    s_waitcnt vmcnt(11)
    s_nop 0
    v_mfma_f32_16x16x32_bf16 v[22:25], v[80:83], v[64:67], v[22:25]
    s_waitcnt vmcnt(10)
    v_mfma_f32_16x16x32_bf16 v[26:29], v[84:87], v[64:67], v[26:29]
    v_add_f32 v30, v30, v49
    v_cvt_pk_bf16_f32 v75, v49, v49
    v_and_b32 v68, v75, v4
    v_and_b32 v69, v75, v5
    v_and_b32 v70, v75, v6
    v_and_b32 v71, v75, v7
    s_waitcnt vmcnt(9)
    s_nop 0
    v_mfma_f32_16x16x32_bf16 v[22:25], v[88:91], v[68:71], v[22:25]
    s_waitcnt vmcnt(8)
    v_mfma_f32_16x16x32_bf16 v[26:29], v[92:95], v[68:71], v[26:29]
    s_add_u32 s58, s55, 0x4000
    buffer_load_dwordx4 v[80:83], v1, s[4:7], s58 offen
    buffer_load_dwordx4 v[84:87], v1, s[4:7], s58 offen offset:128
    buffer_load_dwordx4 v[88:91], v1, s[4:7], s58 offen offset:256
    buffer_load_dwordx4 v[92:95], v1, s[4:7], s58 offen offset:384
    v_add_f32 v30, v30, v50
    v_cvt_pk_bf16_f32 v75, v50, v50
    v_and_b32 v64, v75, v4
    v_and_b32 v65, v75, v5
    v_and_b32 v66, v75, v6
    v_and_b32 v67, v75, v7
    s_waitcnt vmcnt(11)
    s_nop 0
    v_mfma_f32_16x16x32_bf16 v[22:25], v[112:115], v[64:67], v[22:25]
    s_waitcnt vmcnt(10)
    v_mfma_f32_16x16x32_bf16 v[26:29], v[116:119], v[64:67], v[26:29]
    v_add_f32 v30, v30, v51
    v_cvt_pk_bf16_f32 v75, v51, v51
    v_and_b32 v68, v75, v4
    v_and_b32 v69, v75, v5
    v_and_b32 v70, v75, v6
    v_and_b32 v71, v75, v7
    s_waitcnt vmcnt(9)
    s_nop 0
    v_mfma_f32_16x16x32_bf16 v[22:25], v[120:123], v[68:71], v[22:25]
    s_waitcnt vmcnt(8)
    v_mfma_f32_16x16x32_bf16 v[26:29], v[124:127], v[68:71], v[26:29]
    buffer_load_dwordx4 v[112:115], v2, s[8:11], s57 offen
    buffer_load_dwordx4 v[116:119], v2, s[8:11], s57 offen offset:256
    buffer_load_dwordx4 v[120:123], v2, s[8:11], s57 offen offset:512
    buffer_load_dwordx4 v[124:127], v2, s[8:11], s57 offen offset:768
    s_waitcnt vmcnt(11)
    v_mfma_f32_16x16x32_bf16 v[56:59], v[96:99], v[32:35], 0
    s_waitcnt vmcnt(10)
    v_mfma_f32_16x16x32_bf16 v[56:59], v[100:103], v[36:39], v[56:59]
    s_waitcnt vmcnt(9)
    v_mfma_f32_16x16x32_bf16 v[56:59], v[104:107], v[40:43], v[56:59]
    s_waitcnt vmcnt(8)
    v_mfma_f32_16x16x32_bf16 v[56:59], v[108:111], v[44:47], v[56:59]
    buffer_load_dwordx4 v[96:99], v2, s[8:11], s58 offen
    buffer_load_dwordx4 v[100:103], v2, s[8:11], s58 offen offset:256
    buffer_load_dwordx4 v[104:107], v2, s[8:11], s58 offen offset:512
    buffer_load_dwordx4 v[108:111], v2, s[8:11], s58 offen offset:768
    s_waitcnt vmcnt(11)
    v_mfma_f32_16x16x32_bf16 v[60:63], v[80:83], v[32:35], 0
    s_waitcnt vmcnt(10)
    v_mfma_f32_16x16x32_bf16 v[60:63], v[84:87], v[36:39], v[60:63]
    s_waitcnt vmcnt(9)
    v_mfma_f32_16x16x32_bf16 v[60:63], v[88:91], v[40:43], v[60:63]
    s_waitcnt vmcnt(8)
    v_mfma_f32_16x16x32_bf16 v[60:63], v[92:95], v[44:47], v[60:63]
    s_add_u32 s59, s55, 0x5000
    buffer_load_dwordx4 v[80:83], v1, s[4:7], s59 offen
    buffer_load_dwordx4 v[84:87], v1, s[4:7], s59 offen offset:128
    buffer_load_dwordx4 v[88:91], v1, s[4:7], s59 offen offset:256
    buffer_load_dwordx4 v[92:95], v1, s[4:7], s59 offen offset:384
    v_add_f32_dpp v48, v56, v57 quad_perm:[1,0,3,2] row_mask:0xf bank_mask:0xf
    v_add_f32_dpp v49, v58, v59 quad_perm:[1,0,3,2] row_mask:0xf bank_mask:0xf
    s_nop 0
    v_add_f32_dpp v50, v60, v61 quad_perm:[1,0,3,2] row_mask:0xf bank_mask:0xf
    v_add_f32_dpp v51, v62, v63 quad_perm:[1,0,3,2] row_mask:0xf bank_mask:0xf
    v_max3_f32 v72, v48, v49, v50
    v_max_f32 v72, v72, v51
    s_nop 1
    v_max_f32_dpp v72, v72, v72 row_bcast:15 row_mask:0xa bank_mask:0xf
    s_nop 1
    v_max_f32_dpp v72, v72, v72 row_bcast:31 row_mask:0xc bank_mask:0xf
    v_max_f32 v72, s61, v72
    s_nop 0
    v_readlane_b32 s61, v72, 63
    s_nop 1
    v_mul_f32 v73, s61, v9
    v_sub_f32 v74, v73, v31
    v_exp_f32 v74, v74
    v_mov_b32 v31, v73
    v_mul_f32 v30, v30, v74
    v_mul_f32 v22, v22, v74
    v_mul_f32 v23, v23, v74
    v_mul_f32 v24, v24, v74
    v_mul_f32 v25, v25, v74
    v_mul_f32 v26, v26, v74
    v_mul_f32 v27, v27, v74
    v_mul_f32 v28, v28, v74
    v_mul_f32 v29, v29, v74
    v_fma_f32 v48, v48, v8, v31
    v_fma_f32 v49, v49, v8, v31
    v_fma_f32 v50, v50, v8, v31
    v_fma_f32 v51, v51, v8, v31
    v_exp_f32 v48, v48
    v_exp_f32 v49, v49
    v_exp_f32 v50, v50
    v_exp_f32 v51, v51
    v_add_f32 v30, v30, v48
    v_cvt_pk_bf16_f32 v75, v48, v48
    v_and_b32 v64, v75, v4
    v_and_b32 v65, v75, v5
    v_and_b32 v66, v75, v6
    v_and_b32 v67, v75, v7
    s_waitcnt vmcnt(11)
    s_nop 0
    v_mfma_f32_16x16x32_bf16 v[22:25], v[112:115], v[64:67], v[22:25]
    s_waitcnt vmcnt(10)
    v_mfma_f32_16x16x32_bf16 v[26:29], v[116:119], v[64:67], v[26:29]
    v_add_f32 v30, v30, v49
    v_cvt_pk_bf16_f32 v75, v49, v49
    v_and_b32 v68, v75, v4
    v_and_b32 v69, v75, v5
    v_and_b32 v70, v75, v6
    v_and_b32 v71, v75, v7
    s_waitcnt vmcnt(9)
    s_nop 0
    v_mfma_f32_16x16x32_bf16 v[22:25], v[120:123], v[68:71], v[22:25]
    s_waitcnt vmcnt(8)
    v_mfma_f32_16x16x32_bf16 v[26:29], v[124:127], v[68:71], v[26:29]
    s_add_u32 s56, s55, 0x6000
    buffer_load_dwordx4 v[112:115], v1, s[4:7], s56 offen
    buffer_load_dwordx4 v[116:119], v1, s[4:7], s56 offen offset:128
    buffer_load_dwordx4 v[120:123], v1, s[4:7], s56 offen offset:256
    buffer_load_dwordx4 v[124:127], v1, s[4:7], s56 offen offset:384
    v_add_f32 v30, v30, v50
    v_cvt_pk_bf16_f32 v75, v50, v50
    v_and_b32 v64, v75, v4
    v_and_b32 v65, v75, v5
    v_and_b32 v66, v75, v6
    v_and_b32 v67, v75, v7
    s_waitcnt vmcnt(11)
    s_nop 0
    v_mfma_f32_16x16x32_bf16 v[22:25], v[96:99], v[64:67], v[22:25]
    s_waitcnt vmcnt(10)
    v_mfma_f32_16x16x32_bf16 v[26:29], v[100:103], v[64:67], v[26:29]
    v_add_f32 v30, v30, v51
    v_cvt_pk_bf16_f32 v75, v51, v51
    v_and_b32 v68, v75, v4
    v_and_b32 v69, v75, v5
    v_and_b32 v70, v75, v6
    v_and_b32 v71, v75, v7
    s_waitcnt vmcnt(9)
    s_nop 0
    v_mfma_f32_16x16x32_bf16 v[22:25], v[104:107], v[68:71], v[22:25]
    s_waitcnt vmcnt(8)
    v_mfma_f32_16x16x32_bf16 v[26:29], v[108:111], v[68:71], v[26:29]
    buffer_load_dwordx4 v[96:99], v2, s[8:11], s59 offen
    buffer_load_dwordx4 v[100:103], v2, s[8:11], s59 offen offset:256
    buffer_load_dwordx4 v[104:107], v2, s[8:11], s59 offen offset:512
    buffer_load_dwordx4 v[108:111], v2, s[8:11], s59 offen offset:768
    s_waitcnt vmcnt(11)
    v_mfma_f32_16x16x32_bf16 v[56:59], v[80:83], v[32:35], 0
    s_waitcnt vmcnt(10)
    v_mfma_f32_16x16x32_bf16 v[56:59], v[84:87], v[36:39], v[56:59]
    s_waitcnt vmcnt(9)
    v_mfma_f32_16x16x32_bf16 v[56:59], v[88:91], v[40:43], v[56:59]
    s_waitcnt vmcnt(8)
    v_mfma_f32_16x16x32_bf16 v[56:59], v[92:95], v[44:47], v[56:59]
    buffer_load_dwordx4 v[80:83], v2, s[8:11], s56 offen
    buffer_load_dwordx4 v[84:87], v2, s[8:11], s56 offen offset:256
    buffer_load_dwordx4 v[88:91], v2, s[8:11], s56 offen offset:512
    buffer_load_dwordx4 v[92:95], v2, s[8:11], s56 offen offset:768
    s_waitcnt vmcnt(11)
    v_mfma_f32_16x16x32_bf16 v[60:63], v[112:115], v[32:35], 0
    s_waitcnt vmcnt(10)
    v_mfma_f32_16x16x32_bf16 v[60:63], v[116:119], v[36:39], v[60:63]
    s_waitcnt vmcnt(9)
    v_mfma_f32_16x16x32_bf16 v[60:63], v[120:123], v[40:43], v[60:63]
    s_waitcnt vmcnt(8)
    v_mfma_f32_16x16x32_bf16 v[60:63], v[124:127], v[44:47], v[60:63]
    s_add_u32 s57, s55, 0x7000
    buffer_load_dwordx4 v[112:115], v1, s[4:7], s57 offen
    buffer_load_dwordx4 v[116:119], v1, s[4:7], s57 offen offset:128
    buffer_load_dwordx4 v[120:123], v1, s[4:7], s57 offen offset:256
    buffer_load_dwordx4 v[124:127], v1, s[4:7], s57 offen offset:384
    v_add_f32_dpp v48, v56, v57 quad_perm:[1,0,3,2] row_mask:0xf bank_mask:0xf
    v_add_f32_dpp v49, v58, v59 quad_perm:[1,0,3,2] row_mask:0xf bank_mask:0xf
    s_nop 0
    v_add_f32_dpp v50, v60, v61 quad_perm:[1,0,3,2] row_mask:0xf bank_mask:0xf
    v_add_f32_dpp v51, v62, v63 quad_perm:[1,0,3,2] row_mask:0xf bank_mask:0xf
    v_max3_f32 v72, v48, v49, v50
    v_max_f32 v72, v72, v51
    s_nop 1
    v_max_f32_dpp v72, v72, v72 row_bcast:15 row_mask:0xa bank_mask:0xf
    s_nop 1
    v_max_f32_dpp v72, v72, v72 row_bcast:31 row_mask:0xc bank_mask:0xf
    v_max_f32 v72, s61, v72
    s_nop 0
    v_readlane_b32 s61, v72, 63
    s_nop 1
    v_mul_f32 v73, s61, v9
    v_sub_f32 v74, v73, v31
    v_exp_f32 v74, v74
    v_mov_b32 v31, v73
    v_mul_f32 v30, v30, v74
    v_mul_f32 v22, v22, v74
    v_mul_f32 v23, v23, v74
    v_mul_f32 v24, v24, v74
    v_mul_f32 v25, v25, v74
    v_mul_f32 v26, v26, v74
    v_mul_f32 v27, v27, v74
    v_mul_f32 v28, v28, v74
    v_mul_f32 v29, v29, v74
    v_fma_f32 v48, v48, v8, v31
    v_fma_f32 v49, v49, v8, v31
    v_fma_f32 v50, v50, v8, v31
    v_fma_f32 v51, v51, v8, v31
    v_exp_f32 v48, v48
    v_exp_f32 v49, v49
    v_exp_f32 v50, v50
    v_exp_f32 v51, v51
    v_add_f32 v30, v30, v48
    v_cvt_pk_bf16_f32 v75, v48, v48
    v_and_b32 v64, v75, v4
    v_and_b32 v65, v75, v5
    v_and_b32 v66, v75, v6
    v_and_b32 v67, v75, v7
    s_waitcnt vmcnt(11)
    s_nop 0
    v_mfma_f32_16x16x32_bf16 v[22:25], v[96:99], v[64:67], v[22:25]
    s_waitcnt vmcnt(10)
    v_mfma_f32_16x16x32_bf16 v[26:29], v[100:103], v[64:67], v[26:29]
    v_add_f32 v30, v30, v49
    v_cvt_pk_bf16_f32 v75, v49, v49
    v_and_b32 v68, v75, v4
    v_and_b32 v69, v75, v5
    v_and_b32 v70, v75, v6
    v_and_b32 v71, v75, v7
    s_waitcnt vmcnt(9)
    s_nop 0
    v_mfma_f32_16x16x32_bf16 v[22:25], v[104:107], v[68:71], v[22:25]
    s_waitcnt vmcnt(8)
    v_mfma_f32_16x16x32_bf16 v[26:29], v[108:111], v[68:71], v[26:29]
    s_add_u32 s58, s55, 0x8000
    buffer_load_dwordx4 v[96:99], v1, s[4:7], s58 offen
    buffer_load_dwordx4 v[100:103], v1, s[4:7], s58 offen offset:128
    buffer_load_dwordx4 v[104:107], v1, s[4:7], s58 offen offset:256
    buffer_load_dwordx4 v[108:111], v1, s[4:7], s58 offen offset:384
    v_add_f32 v30, v30, v50
    v_cvt_pk_bf16_f32 v75, v50, v50
    v_and_b32 v64, v75, v4
    v_and_b32 v65, v75, v5
    v_and_b32 v66, v75, v6
    v_and_b32 v67, v75, v7
    s_waitcnt vmcnt(11)
    s_nop 0
    v_mfma_f32_16x16x32_bf16 v[22:25], v[80:83], v[64:67], v[22:25]
    s_waitcnt vmcnt(10)
    v_mfma_f32_16x16x32_bf16 v[26:29], v[84:87], v[64:67], v[26:29]
    v_add_f32 v30, v30, v51
    v_cvt_pk_bf16_f32 v75, v51, v51
    v_and_b32 v68, v75, v4
    v_and_b32 v69, v75, v5
    v_and_b32 v70, v75, v6
    v_and_b32 v71, v75, v7
    s_waitcnt vmcnt(9)
    s_nop 0
    v_mfma_f32_16x16x32_bf16 v[22:25], v[88:91], v[68:71], v[22:25]
    s_waitcnt vmcnt(8)
    v_mfma_f32_16x16x32_bf16 v[26:29], v[92:95], v[68:71], v[26:29]
    buffer_load_dwordx4 v[80:83], v2, s[8:11], s57 offen
    buffer_load_dwordx4 v[84:87], v2, s[8:11], s57 offen offset:256
    buffer_load_dwordx4 v[88:91], v2, s[8:11], s57 offen offset:512
    buffer_load_dwordx4 v[92:95], v2, s[8:11], s57 offen offset:768
    s_waitcnt vmcnt(11)
    v_mfma_f32_16x16x32_bf16 v[56:59], v[112:115], v[32:35], 0
    s_waitcnt vmcnt(10)
    v_mfma_f32_16x16x32_bf16 v[56:59], v[116:119], v[36:39], v[56:59]
    s_waitcnt vmcnt(9)
    v_mfma_f32_16x16x32_bf16 v[56:59], v[120:123], v[40:43], v[56:59]
    s_waitcnt vmcnt(8)
    v_mfma_f32_16x16x32_bf16 v[56:59], v[124:127], v[44:47], v[56:59]
    buffer_load_dwordx4 v[112:115], v2, s[8:11], s58 offen
    buffer_load_dwordx4 v[116:119], v2, s[8:11], s58 offen offset:256
    buffer_load_dwordx4 v[120:123], v2, s[8:11], s58 offen offset:512
    buffer_load_dwordx4 v[124:127], v2, s[8:11], s58 offen offset:768
    s_waitcnt vmcnt(11)
    v_mfma_f32_16x16x32_bf16 v[60:63], v[96:99], v[32:35], 0
    s_waitcnt vmcnt(10)
    v_mfma_f32_16x16x32_bf16 v[60:63], v[100:103], v[36:39], v[60:63]
    s_waitcnt vmcnt(9)
    v_mfma_f32_16x16x32_bf16 v[60:63], v[104:107], v[40:43], v[60:63]
    s_waitcnt vmcnt(8)
    v_mfma_f32_16x16x32_bf16 v[60:63], v[108:111], v[44:47], v[60:63]
    s_add_u32 s59, s55, 0x9000
    buffer_load_dwordx4 v[96:99], v1, s[4:7], s59 offen
    buffer_load_dwordx4 v[100:103], v1, s[4:7], s59 offen offset:128
    buffer_load_dwordx4 v[104:107], v1, s[4:7], s59 offen offset:256
    buffer_load_dwordx4 v[108:111], v1, s[4:7], s59 offen offset:384
    v_add_f32_dpp v48, v56, v57 quad_perm:[1,0,3,2] row_mask:0xf bank_mask:0xf
    v_add_f32_dpp v49, v58, v59 quad_perm:[1,0,3,2] row_mask:0xf bank_mask:0xf
    s_nop 0
    v_add_f32_dpp v50, v60, v61 quad_perm:[1,0,3,2] row_mask:0xf bank_mask:0xf
    v_add_f32_dpp v51, v62, v63 quad_perm:[1,0,3,2] row_mask:0xf bank_mask:0xf
    v_max3_f32 v72, v48, v49, v50
    v_max_f32 v72, v72, v51
    s_nop 1
    v_max_f32_dpp v72, v72, v72 row_bcast:15 row_mask:0xa bank_mask:0xf
    s_nop 1
    v_max_f32_dpp v72, v72, v72 row_bcast:31 row_mask:0xc bank_mask:0xf
    v_max_f32 v72, s61, v72
    s_nop 0
    v_readlane_b32 s61, v72, 63
    s_nop 1
    v_mul_f32 v73, s61, v9
    v_sub_f32 v74, v73, v31
    v_exp_f32 v74, v74
    v_mov_b32 v31, v73
    v_mul_f32 v30, v30, v74
    v_mul_f32 v22, v22, v74
    v_mul_f32 v23, v23, v74
    v_mul_f32 v24, v24, v74
    v_mul_f32 v25, v25, v74
    v_mul_f32 v26, v26, v74
    v_mul_f32 v27, v27, v74
    v_mul_f32 v28, v28, v74
    v_mul_f32 v29, v29, v74
    v_fma_f32 v48, v48, v8, v31
    v_fma_f32 v49, v49, v8, v31
    v_fma_f32 v50, v50, v8, v31
    v_fma_f32 v51, v51, v8, v31
    v_exp_f32 v48, v48
    v_exp_f32 v49, v49
    v_exp_f32 v50, v50
    v_exp_f32 v51, v51
    v_add_f32 v30, v30, v48
    v_cvt_pk_bf16_f32 v75, v48, v48
    v_and_b32 v64, v75, v4
    v_and_b32 v65, v75, v5
    v_and_b32 v66, v75, v6
    v_and_b32 v67, v75, v7
    s_waitcnt vmcnt(11)
    s_nop 0
    v_mfma_f32_16x16x32_bf16 v[22:25], v[80:83], v[64:67], v[22:25]
    s_waitcnt vmcnt(10)
    v_mfma_f32_16x16x32_bf16 v[26:29], v[84:87], v[64:67], v[26:29]
    v_add_f32 v30, v30, v49
    v_cvt_pk_bf16_f32 v75, v49, v49
    v_and_b32 v68, v75, v4
    v_and_b32 v69, v75, v5
    v_and_b32 v70, v75, v6
    v_and_b32 v71, v75, v7
    s_waitcnt vmcnt(9)
    s_nop 0
    v_mfma_f32_16x16x32_bf16 v[22:25], v[88:91], v[68:71], v[22:25]
    s_waitcnt vmcnt(8)
    v_mfma_f32_16x16x32_bf16 v[26:29], v[92:95], v[68:71], v[26:29]
    s_add_u32 s56, s55, 0xa000
    buffer_load_dwordx4 v[80:83], v1, s[4:7], s56 offen
    buffer_load_dwordx4 v[84:87], v1, s[4:7], s56 offen offset:128
    buffer_load_dwordx4 v[88:91], v1, s[4:7], s56 offen offset:256
    buffer_load_dwordx4 v[92:95], v1, s[4:7], s56 offen offset:384
    v_add_f32 v30, v30, v50
    v_cvt_pk_bf16_f32 v75, v50, v50
    v_and_b32 v64, v75, v4
    v_and_b32 v65, v75, v5
    v_and_b32 v66, v75, v6
    v_and_b32 v67, v75, v7
    s_waitcnt vmcnt(11)
    s_nop 0
    v_mfma_f32_16x16x32_bf16 v[22:25], v[112:115], v[64:67], v[22:25]
    s_waitcnt vmcnt(10)
    v_mfma_f32_16x16x32_bf16 v[26:29], v[116:119], v[64:67], v[26:29]
    v_add_f32 v30, v30, v51
    v_cvt_pk_bf16_f32 v75, v51, v51
    v_and_b32 v68, v75, v4
    v_and_b32 v69, v75, v5
    v_and_b32 v70, v75, v6
    v_and_b32 v71, v75, v7
    s_waitcnt vmcnt(9)
    s_nop 0
    v_mfma_f32_16x16x32_bf16 v[22:25], v[120:123], v[68:71], v[22:25]
    s_waitcnt vmcnt(8)
    v_mfma_f32_16x16x32_bf16 v[26:29], v[124:127], v[68:71], v[26:29]
    buffer_load_dwordx4 v[112:115], v2, s[8:11], s59 offen
    buffer_load_dwordx4 v[116:119], v2, s[8:11], s59 offen offset:256
    buffer_load_dwordx4 v[120:123], v2, s[8:11], s59 offen offset:512
    buffer_load_dwordx4 v[124:127], v2, s[8:11], s59 offen offset:768
    s_waitcnt vmcnt(11)
    v_mfma_f32_16x16x32_bf16 v[56:59], v[96:99], v[32:35], 0
    s_waitcnt vmcnt(10)
    v_mfma_f32_16x16x32_bf16 v[56:59], v[100:103], v[36:39], v[56:59]
    s_waitcnt vmcnt(9)
    v_mfma_f32_16x16x32_bf16 v[56:59], v[104:107], v[40:43], v[56:59]
    s_waitcnt vmcnt(8)
    v_mfma_f32_16x16x32_bf16 v[56:59], v[108:111], v[44:47], v[56:59]
    buffer_load_dwordx4 v[96:99], v2, s[8:11], s56 offen
    buffer_load_dwordx4 v[100:103], v2, s[8:11], s56 offen offset:256
    buffer_load_dwordx4 v[104:107], v2, s[8:11], s56 offen offset:512
    buffer_load_dwordx4 v[108:111], v2, s[8:11], s56 offen offset:768
    s_waitcnt vmcnt(11)
    v_mfma_f32_16x16x32_bf16 v[60:63], v[80:83], v[32:35], 0
    s_waitcnt vmcnt(10)
    v_mfma_f32_16x16x32_bf16 v[60:63], v[84:87], v[36:39], v[60:63]
    s_waitcnt vmcnt(9)
    v_mfma_f32_16x16x32_bf16 v[60:63], v[88:91], v[40:43], v[60:63]
    s_waitcnt vmcnt(8)
    v_mfma_f32_16x16x32_bf16 v[60:63], v[92:95], v[44:47], v[60:63]
    s_add_u32 s57, s55, 0xb000
    buffer_load_dwordx4 v[80:83], v1, s[4:7], s57 offen
    buffer_load_dwordx4 v[84:87], v1, s[4:7], s57 offen offset:128
    buffer_load_dwordx4 v[88:91], v1, s[4:7], s57 offen offset:256
    buffer_load_dwordx4 v[92:95], v1, s[4:7], s57 offen offset:384
    v_add_f32_dpp v48, v56, v57 quad_perm:[1,0,3,2] row_mask:0xf bank_mask:0xf
    v_add_f32_dpp v49, v58, v59 quad_perm:[1,0,3,2] row_mask:0xf bank_mask:0xf
    s_nop 0
    v_add_f32_dpp v50, v60, v61 quad_perm:[1,0,3,2] row_mask:0xf bank_mask:0xf
    v_add_f32_dpp v51, v62, v63 quad_perm:[1,0,3,2] row_mask:0xf bank_mask:0xf
    v_max3_f32 v72, v48, v49, v50
    v_max_f32 v72, v72, v51
    s_nop 1
    v_max_f32_dpp v72, v72, v72 row_bcast:15 row_mask:0xa bank_mask:0xf
    s_nop 1
    v_max_f32_dpp v72, v72, v72 row_bcast:31 row_mask:0xc bank_mask:0xf
    v_max_f32 v72, s61, v72
    s_nop 0
    v_readlane_b32 s61, v72, 63
    s_nop 1
    v_mul_f32 v73, s61, v9
    v_sub_f32 v74, v73, v31
    v_exp_f32 v74, v74
    v_mov_b32 v31, v73
    v_mul_f32 v30, v30, v74
    v_mul_f32 v22, v22, v74
    v_mul_f32 v23, v23, v74
    v_mul_f32 v24, v24, v74
    v_mul_f32 v25, v25, v74
    v_mul_f32 v26, v26, v74
    v_mul_f32 v27, v27, v74
    v_mul_f32 v28, v28, v74
    v_mul_f32 v29, v29, v74
    v_fma_f32 v48, v48, v8, v31
    v_fma_f32 v49, v49, v8, v31
    v_fma_f32 v50, v50, v8, v31
    v_fma_f32 v51, v51, v8, v31
    v_exp_f32 v48, v48
    v_exp_f32 v49, v49
    v_exp_f32 v50, v50
    v_exp_f32 v51, v51
    v_add_f32 v30, v30, v48
    v_cvt_pk_bf16_f32 v75, v48, v48
    v_and_b32 v64, v75, v4
    v_and_b32 v65, v75, v5
    v_and_b32 v66, v75, v6
    v_and_b32 v67, v75, v7
    s_waitcnt vmcnt(11)
    s_nop 0
    v_mfma_f32_16x16x32_bf16 v[22:25], v[112:115], v[64:67], v[22:25]
    s_waitcnt vmcnt(10)
    v_mfma_f32_16x16x32_bf16 v[26:29], v[116:119], v[64:67], v[26:29]
    v_add_f32 v30, v30, v49
    v_cvt_pk_bf16_f32 v75, v49, v49
    v_and_b32 v68, v75, v4
    v_and_b32 v69, v75, v5
    v_and_b32 v70, v75, v6
    v_and_b32 v71, v75, v7
    s_waitcnt vmcnt(9)
    s_nop 0
    v_mfma_f32_16x16x32_bf16 v[22:25], v[120:123], v[68:71], v[22:25]
    s_waitcnt vmcnt(8)
    v_mfma_f32_16x16x32_bf16 v[26:29], v[124:127], v[68:71], v[26:29]
    buffer_load_dwordx4 v[112:115], v2, s[8:11], s57 offen
    buffer_load_dwordx4 v[116:119], v2, s[8:11], s57 offen offset:256
    buffer_load_dwordx4 v[120:123], v2, s[8:11], s57 offen offset:512
    buffer_load_dwordx4 v[124:127], v2, s[8:11], s57 offen offset:768
    v_add_f32 v30, v30, v50
    v_cvt_pk_bf16_f32 v75, v50, v50
    v_and_b32 v64, v75, v4
    v_and_b32 v65, v75, v5
    v_and_b32 v66, v75, v6
    v_and_b32 v67, v75, v7
    s_waitcnt vmcnt(11)
    s_nop 0
    v_mfma_f32_16x16x32_bf16 v[22:25], v[96:99], v[64:67], v[22:25]
    s_waitcnt vmcnt(10)
    v_mfma_f32_16x16x32_bf16 v[26:29], v[100:103], v[64:67], v[26:29]
    v_add_f32 v30, v30, v51
    v_cvt_pk_bf16_f32 v75, v51, v51
    v_and_b32 v68, v75, v4
    v_and_b32 v69, v75, v5
    v_and_b32 v70, v75, v6
    v_and_b32 v71, v75, v7
    s_waitcnt vmcnt(9)
    s_nop 0
    v_mfma_f32_16x16x32_bf16 v[22:25], v[104:107], v[68:71], v[22:25]
    s_waitcnt vmcnt(8)
    v_mfma_f32_16x16x32_bf16 v[26:29], v[108:111], v[68:71], v[26:29]
    s_add_u32 s58, s55, 0xc000
    buffer_load_dwordx4 v[96:99], v1, s[4:7], s58 offen
    buffer_load_dwordx4 v[100:103], v1, s[4:7], s58 offen offset:128
    buffer_load_dwordx4 v[104:107], v1, s[4:7], s58 offen offset:256
    buffer_load_dwordx4 v[108:111], v1, s[4:7], s58 offen offset:384
    s_waitcnt vmcnt(11)
    v_mfma_f32_16x16x32_bf16 v[56:59], v[80:83], v[32:35], 0
    s_waitcnt vmcnt(10)
    v_mfma_f32_16x16x32_bf16 v[56:59], v[84:87], v[36:39], v[56:59]
    s_waitcnt vmcnt(9)
    v_mfma_f32_16x16x32_bf16 v[56:59], v[88:91], v[40:43], v[56:59]
    s_waitcnt vmcnt(8)
    v_mfma_f32_16x16x32_bf16 v[56:59], v[92:95], v[44:47], v[56:59]
    buffer_load_dwordx4 v[80:83], v2, s[8:11], s58 offen
    buffer_load_dwordx4 v[84:87], v2, s[8:11], s58 offen offset:256
    buffer_load_dwordx4 v[88:91], v2, s[8:11], s58 offen offset:512
    buffer_load_dwordx4 v[92:95], v2, s[8:11], s58 offen offset:768
    s_nop 3
    v_add_f32_dpp v48, v56, v57 quad_perm:[1,0,3,2] row_mask:0xf bank_mask:0xf
    v_add_f32_dpp v49, v58, v59 quad_perm:[1,0,3,2] row_mask:0xf bank_mask:0xf
    v_max_f32 v72, v48, v49
    s_nop 1
    v_max_f32_dpp v72, v72, v72 row_bcast:15 row_mask:0xa bank_mask:0xf
    s_nop 1
    v_max_f32_dpp v72, v72, v72 row_bcast:31 row_mask:0xc bank_mask:0xf
    v_max_f32 v72, s61, v72
    s_nop 0
    v_readlane_b32 s61, v72, 63
    s_nop 1
    v_mul_f32 v73, s61, v9
    v_sub_f32 v74, v73, v31
    v_exp_f32 v74, v74
    v_mov_b32 v31, v73
    v_mul_f32 v30, v30, v74
    v_mul_f32 v22, v22, v74
    v_mul_f32 v23, v23, v74
    v_mul_f32 v24, v24, v74
    v_mul_f32 v25, v25, v74
    v_mul_f32 v26, v26, v74
    v_mul_f32 v27, v27, v74
    v_mul_f32 v28, v28, v74
    v_mul_f32 v29, v29, v74
    v_fma_f32 v48, v48, v8, v31
    v_fma_f32 v49, v49, v8, v31
    v_exp_f32 v48, v48
    v_exp_f32 v49, v49
    v_add_f32 v30, v30, v48
    v_cvt_pk_bf16_f32 v75, v48, v48
    v_and_b32 v64, v75, v4
    v_and_b32 v65, v75, v5
    v_and_b32 v66, v75, v6
    v_and_b32 v67, v75, v7
    s_waitcnt vmcnt(11)
    s_nop 0
    v_mfma_f32_16x16x32_bf16 v[22:25], v[112:115], v[64:67], v[22:25]
    s_waitcnt vmcnt(10)
    v_mfma_f32_16x16x32_bf16 v[26:29], v[116:119], v[64:67], v[26:29]
    v_add_f32 v30, v30, v49
    v_cvt_pk_bf16_f32 v75, v49, v49
    v_and_b32 v68, v75, v4
    v_and_b32 v69, v75, v5
    v_and_b32 v70, v75, v6
    v_and_b32 v71, v75, v7
    s_waitcnt vmcnt(9)
    s_nop 0
    v_mfma_f32_16x16x32_bf16 v[22:25], v[120:123], v[68:71], v[22:25]
    s_waitcnt vmcnt(8)
    v_mfma_f32_16x16x32_bf16 v[26:29], v[124:127], v[68:71], v[26:29]
    s_add_u32 s59, s55, 0xd000
    buffer_load_dwordx4 v[112:115], v1, s[4:7], s59 offen
    buffer_load_dwordx4 v[116:119], v1, s[4:7], s59 offen offset:128
    buffer_load_dwordx4 v[120:123], v1, s[4:7], s59 offen offset:256
    buffer_load_dwordx4 v[124:127], v1, s[4:7], s59 offen offset:384
    v_and_b32 v72, 0x7f, v1
    s_lshl_b32 s63, s50, 9
    s_add_u32 s63, s63, 0x4000
L10:
    s_nop 7
    buffer_load_dwordx4 v[32:35], v72, s[12:15], s63 offen sc1
    buffer_load_dwordx4 v[36:39], v72, s[12:15], s63 offen offset:128 sc1
    buffer_load_dwordx4 v[40:43], v72, s[12:15], s63 offen offset:256 sc1
    buffer_load_dwordx4 v[44:47], v72, s[12:15], s63 offen offset:384 sc1
    s_waitcnt vmcnt(0)
    v_max3_u32 v74, v32, v33, v34
    v_max3_u32 v74, v74, v35, v36
    v_max3_u32 v74, v74, v37, v38
    v_max3_u32 v74, v74, v39, v40
    v_max3_u32 v74, v74, v41, v42
    v_max3_u32 v74, v74, v43, v44
    v_max3_u32 v74, v74, v45, v46
    v_max_u32 v74, v74, v47
    v_cmp_eq_u32 vcc, -1, v74
    s_cbranch_vccz L11
    s_sleep 4
    s_sub_u32 s62, s62, 1
    s_cmp_eq_u32 s62, 0
    s_cbranch_scc1 L_end
    s_branch L10
L11:
    s_nop 7
    v_and_b32 v73, 0x7f, v1
    v_add_u32 v73, 0x22500, v73
    ds_write_b128 v73, v[32:35]
    ds_write_b128 v73, v[36:39] offset:128
    ds_write_b128 v73, v[40:43] offset:256
    ds_write_b128 v73, v[44:47] offset:384
    s_waitcnt lgkmcnt(0)
    v_mov_b32 v20, 0
    v_mfma_f32_16x16x32_bf16 v[56:59], a[0:3], v[32:35], 0
    v_mfma_f32_16x16x32_bf16 v[56:59], a[4:7], v[36:39], v[56:59]
    v_mfma_f32_16x16x32_bf16 v[56:59], a[8:11], v[40:43], v[56:59]
    v_mfma_f32_16x16x32_bf16 v[56:59], a[12:15], v[44:47], v[56:59]
    v_mfma_f32_16x16x32_bf16 v[60:63], a[32:35], v[32:35], 0
    v_mfma_f32_16x16x32_bf16 v[60:63], a[36:39], v[36:39], v[60:63]
    v_mfma_f32_16x16x32_bf16 v[60:63], a[40:43], v[40:43], v[60:63]
    v_mfma_f32_16x16x32_bf16 v[60:63], a[44:47], v[44:47], v[60:63]
    s_nop 3
    v_add_f32_dpp v48, v56, v57 quad_perm:[1,0,3,2] row_mask:0xf bank_mask:0xf
    v_add_f32_dpp v49, v58, v59 quad_perm:[1,0,3,2] row_mask:0xf bank_mask:0xf
    v_mfma_f32_16x16x32_bf16 v[56:59], a[64:67], v[32:35], 0
    v_mfma_f32_16x16x32_bf16 v[56:59], a[68:71], v[36:39], v[56:59]
    v_mfma_f32_16x16x32_bf16 v[56:59], a[72:75], v[40:43], v[56:59]
    v_mfma_f32_16x16x32_bf16 v[56:59], a[76:79], v[44:47], v[56:59]
    v_add_f32_dpp v50, v60, v61 quad_perm:[1,0,3,2] row_mask:0xf bank_mask:0xf
    v_add_f32_dpp v51, v62, v63 quad_perm:[1,0,3,2] row_mask:0xf bank_mask:0xf
    v_mfma_f32_16x16x32_bf16 v[60:63], a[96:99], v[32:35], 0
    v_mfma_f32_16x16x32_bf16 v[60:63], a[100:103], v[36:39], v[60:63]
    v_mfma_f32_16x16x32_bf16 v[60:63], a[104:107], v[40:43], v[60:63]
    v_mfma_f32_16x16x32_bf16 v[60:63], a[108:111], v[44:47], v[60:63]
    s_nop 1
    v_add_f32_dpp v52, v56, v57 quad_perm:[1,0,3,2] row_mask:0xf bank_mask:0xf
    v_add_f32_dpp v53, v58, v59 quad_perm:[1,0,3,2] row_mask:0xf bank_mask:0xf
    s_nop 3
    v_add_f32_dpp v54, v60, v61 quad_perm:[1,0,3,2] row_mask:0xf bank_mask:0xf
    v_add_f32_dpp v55, v62, v63 quad_perm:[1,0,3,2] row_mask:0xf bank_mask:0xf
    v_max3_f32 v72, v48, v49, v50
    v_max3_f32 v72, v72, v51, v52
    v_max3_f32 v72, v72, v53, v54
    v_max_f32 v72, v72, v55
    s_nop 1
    v_max_f32_dpp v72, v72, v72 row_bcast:15 row_mask:0xa bank_mask:0xf
    s_nop 1
    v_max_f32_dpp v72, v72, v72 row_bcast:31 row_mask:0xc bank_mask:0xf
    s_nop 0
    v_readlane_b32 s60, v72, 63
    s_nop 1
    v_mul_f32 v21, s60, v9
    v_fma_f32 v48, v48, v8, v21
    v_fma_f32 v49, v49, v8, v21
    v_fma_f32 v50, v50, v8, v21
    v_fma_f32 v51, v51, v8, v21
    v_fma_f32 v52, v52, v8, v21
    v_fma_f32 v53, v53, v8, v21
    v_fma_f32 v54, v54, v8, v21
    v_fma_f32 v55, v55, v8, v21
    v_exp_f32 v48, v48
    v_exp_f32 v49, v49
    v_exp_f32 v50, v50
    v_exp_f32 v51, v51
    v_exp_f32 v52, v52
    v_exp_f32 v53, v53
    v_exp_f32 v54, v54
    v_exp_f32 v55, v55
    v_add_f32 v20, v20, v48
    v_cvt_pk_bf16_f32 v75, v48, v48
    v_and_b32 v64, v75, v4
    v_and_b32 v65, v75, v5
    v_and_b32 v66, v75, v6
    v_and_b32 v67, v75, v7
    s_nop 1
    v_mfma_f32_16x16x32_bf16 v[12:15], a[16:19], v[64:67], 0
    v_mfma_f32_16x16x32_bf16 v[16:19], a[20:23], v[64:67], 0
    v_add_f32 v20, v20, v49
    v_cvt_pk_bf16_f32 v75, v49, v49
    v_and_b32 v68, v75, v4
    v_and_b32 v69, v75, v5
    v_and_b32 v70, v75, v6
    v_and_b32 v71, v75, v7
    s_nop 1
    v_mfma_f32_16x16x32_bf16 v[12:15], a[24:27], v[68:71], v[12:15]
    v_mfma_f32_16x16x32_bf16 v[16:19], a[28:31], v[68:71], v[16:19]
    v_add_f32 v20, v20, v50
    v_cvt_pk_bf16_f32 v75, v50, v50
    v_and_b32 v64, v75, v4
    v_and_b32 v65, v75, v5
    v_and_b32 v66, v75, v6
    v_and_b32 v67, v75, v7
    s_nop 1
    v_mfma_f32_16x16x32_bf16 v[12:15], a[48:51], v[64:67], v[12:15]
    v_mfma_f32_16x16x32_bf16 v[16:19], a[52:55], v[64:67], v[16:19]
    v_add_f32 v20, v20, v51
    v_cvt_pk_bf16_f32 v75, v51, v51
    v_and_b32 v68, v75, v4
    v_and_b32 v69, v75, v5
    v_and_b32 v70, v75, v6
    v_and_b32 v71, v75, v7
    s_nop 1
    v_mfma_f32_16x16x32_bf16 v[12:15], a[56:59], v[68:71], v[12:15]
    v_mfma_f32_16x16x32_bf16 v[16:19], a[60:63], v[68:71], v[16:19]
    v_add_f32 v20, v20, v52
    v_cvt_pk_bf16_f32 v75, v52, v52
    v_and_b32 v64, v75, v4
    v_and_b32 v65, v75, v5
    v_and_b32 v66, v75, v6
    v_and_b32 v67, v75, v7
    s_nop 1
    v_mfma_f32_16x16x32_bf16 v[12:15], a[80:83], v[64:67], v[12:15]
    v_mfma_f32_16x16x32_bf16 v[16:19], a[84:87], v[64:67], v[16:19]
    v_add_f32 v20, v20, v53
    v_cvt_pk_bf16_f32 v75, v53, v53
    v_and_b32 v68, v75, v4
    v_and_b32 v69, v75, v5
    v_and_b32 v70, v75, v6
    v_and_b32 v71, v75, v7
    s_nop 1
    v_mfma_f32_16x16x32_bf16 v[12:15], a[88:91], v[68:71], v[12:15]
    v_mfma_f32_16x16x32_bf16 v[16:19], a[92:95], v[68:71], v[16:19]
    v_add_f32 v20, v20, v54
    v_cvt_pk_bf16_f32 v75, v54, v54
    v_and_b32 v64, v75, v4
    v_and_b32 v65, v75, v5
    v_and_b32 v66, v75, v6
    v_and_b32 v67, v75, v7
    s_nop 1
    v_mfma_f32_16x16x32_bf16 v[12:15], a[112:115], v[64:67], v[12:15]
    v_mfma_f32_16x16x32_bf16 v[16:19], a[116:119], v[64:67], v[16:19]
    v_add_f32 v20, v20, v55
    v_cvt_pk_bf16_f32 v75, v55, v55
    v_and_b32 v68, v75, v4
    v_and_b32 v69, v75, v5
    v_and_b32 v70, v75, v6
    v_and_b32 v71, v75, v7
    s_nop 1
    v_mfma_f32_16x16x32_bf16 v[12:15], a[120:123], v[68:71], v[12:15]
    v_mfma_f32_16x16x32_bf16 v[16:19], a[124:127], v[68:71], v[16:19]
    v_and_b32 v73, 0x7f, v1
    v_add_u32 v73, 0x22300, v73
    ds_read_b128 v[32:35], v73
    ds_read_b128 v[36:39], v73 offset:128
    ds_read_b128 v[40:43], v73 offset:256
    ds_read_b128 v[44:47], v73 offset:384
    s_waitcnt lgkmcnt(0)
    v_mfma_f32_16x16x32_bf16 v[56:59], v[96:99], v[32:35], 0
    v_mfma_f32_16x16x32_bf16 v[56:59], v[100:103], v[36:39], v[56:59]
    v_mfma_f32_16x16x32_bf16 v[56:59], v[104:107], v[40:43], v[56:59]
    v_mfma_f32_16x16x32_bf16 v[56:59], v[108:111], v[44:47], v[56:59]
    buffer_load_dwordx4 v[96:99], v2, s[8:11], s59 offen
    buffer_load_dwordx4 v[100:103], v2, s[8:11], s59 offen offset:256
    buffer_load_dwordx4 v[104:107], v2, s[8:11], s59 offen offset:512
    buffer_load_dwordx4 v[108:111], v2, s[8:11], s59 offen offset:768
    s_add_u32 s56, s55, 0xe000
    buffer_load_dwordx4 a[0:3], v1, s[4:7], s56 offen nt
    buffer_load_dwordx4 a[4:7], v1, s[4:7], s56 offen offset:128 nt
    buffer_load_dwordx4 a[8:11], v1, s[4:7], s56 offen offset:256 nt
    buffer_load_dwordx4 a[12:15], v1, s[4:7], s56 offen offset:384 nt
    v_add_f32_dpp v48, v56, v57 quad_perm:[1,0,3,2] row_mask:0xf bank_mask:0xf
    v_add_f32_dpp v49, v58, v59 quad_perm:[1,0,3,2] row_mask:0xf bank_mask:0xf
    v_max_f32 v72, v48, v49
    s_nop 1
    v_max_f32_dpp v72, v72, v72 row_bcast:15 row_mask:0xa bank_mask:0xf
    s_nop 1
    v_max_f32_dpp v72, v72, v72 row_bcast:31 row_mask:0xc bank_mask:0xf
    v_max_f32 v72, s61, v72
    s_nop 0
    v_readlane_b32 s61, v72, 63
    s_nop 1
    v_mul_f32 v73, s61, v9
    v_sub_f32 v74, v73, v31
    v_exp_f32 v74, v74
    v_mov_b32 v31, v73
    v_mul_f32 v30, v30, v74
    v_mul_f32 v22, v22, v74
    v_mul_f32 v23, v23, v74
    v_mul_f32 v24, v24, v74
    v_mul_f32 v25, v25, v74
    v_mul_f32 v26, v26, v74
    v_mul_f32 v27, v27, v74
    v_mul_f32 v28, v28, v74
    v_mul_f32 v29, v29, v74
    v_fma_f32 v48, v48, v8, v31
    v_fma_f32 v49, v49, v8, v31
    v_exp_f32 v48, v48
    v_exp_f32 v49, v49
    v_add_f32 v30, v30, v48
    v_cvt_pk_bf16_f32 v75, v48, v48
    v_and_b32 v64, v75, v4
    v_and_b32 v65, v75, v5
    v_and_b32 v66, v75, v6
    v_and_b32 v67, v75, v7
    s_nop 1
    v_mfma_f32_16x16x32_bf16 v[22:25], v[80:83], v[64:67], v[22:25]
    v_mfma_f32_16x16x32_bf16 v[26:29], v[84:87], v[64:67], v[26:29]
    v_add_f32 v30, v30, v49
    v_cvt_pk_bf16_f32 v75, v49, v49
    v_and_b32 v68, v75, v4
    v_and_b32 v69, v75, v5
    v_and_b32 v70, v75, v6
    v_and_b32 v71, v75, v7
    s_nop 1
    v_mfma_f32_16x16x32_bf16 v[22:25], v[88:91], v[68:71], v[22:25]
    v_mfma_f32_16x16x32_bf16 v[26:29], v[92:95], v[68:71], v[26:29]
    s_add_u32 s57, s55, 0xf000
    buffer_load_dwordx4 a[32:35], v1, s[4:7], s57 offen nt
    buffer_load_dwordx4 a[36:39], v1, s[4:7], s57 offen offset:128 nt
    buffer_load_dwordx4 a[40:43], v1, s[4:7], s57 offen offset:256 nt
    buffer_load_dwordx4 a[44:47], v1, s[4:7], s57 offen offset:384 nt
    v_mfma_f32_16x16x32_bf16 v[56:59], v[112:115], v[32:35], 0
    v_mfma_f32_16x16x32_bf16 v[56:59], v[116:119], v[36:39], v[56:59]
    v_mfma_f32_16x16x32_bf16 v[56:59], v[120:123], v[40:43], v[56:59]
    v_mfma_f32_16x16x32_bf16 v[56:59], v[124:127], v[44:47], v[56:59]
    s_add_u32 s58, s55, 0x10000
    buffer_load_dwordx4 a[64:67], v1, s[4:7], s58 offen nt
    buffer_load_dwordx4 a[68:71], v1, s[4:7], s58 offen offset:128 nt
    buffer_load_dwordx4 a[72:75], v1, s[4:7], s58 offen offset:256 nt
    buffer_load_dwordx4 a[76:79], v1, s[4:7], s58 offen offset:384 nt
    s_nop 2
    v_add_f32_dpp v48, v56, v57 quad_perm:[1,0,3,2] row_mask:0xf bank_mask:0xf
    v_add_f32_dpp v49, v58, v59 quad_perm:[1,0,3,2] row_mask:0xf bank_mask:0xf
    v_max_f32 v72, v48, v49
    s_nop 1
    v_max_f32_dpp v72, v72, v72 row_bcast:15 row_mask:0xa bank_mask:0xf
    s_nop 1
    v_max_f32_dpp v72, v72, v72 row_bcast:31 row_mask:0xc bank_mask:0xf
    v_max_f32 v72, s61, v72
    s_nop 0
    v_readlane_b32 s61, v72, 63
    s_nop 1
    v_mul_f32 v73, s61, v9
    v_sub_f32 v74, v73, v31
    v_exp_f32 v74, v74
    v_mov_b32 v31, v73
    v_mul_f32 v30, v30, v74
    v_mul_f32 v22, v22, v74
    v_mul_f32 v23, v23, v74
    v_mul_f32 v24, v24, v74
    v_mul_f32 v25, v25, v74
    v_mul_f32 v26, v26, v74
    v_mul_f32 v27, v27, v74
    v_mul_f32 v28, v28, v74
    v_mul_f32 v29, v29, v74
    v_fma_f32 v48, v48, v8, v31
    v_fma_f32 v49, v49, v8, v31
    v_exp_f32 v48, v48
    v_exp_f32 v49, v49
    v_add_f32 v30, v30, v48
    v_cvt_pk_bf16_f32 v75, v48, v48
    v_and_b32 v64, v75, v4
    v_and_b32 v65, v75, v5
    v_and_b32 v66, v75, v6
    v_and_b32 v67, v75, v7
    s_waitcnt vmcnt(15)
    s_nop 0
    v_mfma_f32_16x16x32_bf16 v[22:25], v[96:99], v[64:67], v[22:25]
    s_waitcnt vmcnt(14)
    v_mfma_f32_16x16x32_bf16 v[26:29], v[100:103], v[64:67], v[26:29]
    v_add_f32 v30, v30, v49
    v_cvt_pk_bf16_f32 v75, v49, v49
    v_and_b32 v68, v75, v4
    v_and_b32 v69, v75, v5
    v_and_b32 v70, v75, v6
    v_and_b32 v71, v75, v7
    s_waitcnt vmcnt(13)
    s_nop 0
    v_mfma_f32_16x16x32_bf16 v[22:25], v[104:107], v[68:71], v[22:25]
    s_waitcnt vmcnt(12)
    v_mfma_f32_16x16x32_bf16 v[26:29], v[108:111], v[68:71], v[26:29]
    s_add_u32 s59, s55, 0x11000
    buffer_load_dwordx4 a[96:99], v1, s[4:7], s59 offen nt
    buffer_load_dwordx4 a[100:103], v1, s[4:7], s59 offen offset:128 nt
    buffer_load_dwordx4 a[104:107], v1, s[4:7], s59 offen offset:256 nt
    buffer_load_dwordx4 a[108:111], v1, s[4:7], s59 offen offset:384 nt
    s_waitcnt vmcnt(15)
    v_mfma_f32_16x16x32_bf16 v[56:59], a[0:3], v[32:35], 0
    s_waitcnt vmcnt(14)
    v_mfma_f32_16x16x32_bf16 v[56:59], a[4:7], v[36:39], v[56:59]
    s_waitcnt vmcnt(13)
    v_mfma_f32_16x16x32_bf16 v[56:59], a[8:11], v[40:43], v[56:59]
    s_waitcnt vmcnt(12)
    v_mfma_f32_16x16x32_bf16 v[56:59], a[12:15], v[44:47], v[56:59]
    buffer_load_dwordx4 a[16:19], v2, s[8:11], s56 offen nt
    buffer_load_dwordx4 a[20:23], v2, s[8:11], s56 offen offset:256 nt
    buffer_load_dwordx4 a[24:27], v2, s[8:11], s56 offen offset:512 nt
    buffer_load_dwordx4 a[28:31], v2, s[8:11], s56 offen offset:768 nt
    s_waitcnt vmcnt(15)
    v_mfma_f32_16x16x32_bf16 v[60:63], a[32:35], v[32:35], 0
    s_waitcnt vmcnt(14)
    v_mfma_f32_16x16x32_bf16 v[60:63], a[36:39], v[36:39], v[60:63]
    s_waitcnt vmcnt(13)
    v_mfma_f32_16x16x32_bf16 v[60:63], a[40:43], v[40:43], v[60:63]
    s_waitcnt vmcnt(12)
    v_mfma_f32_16x16x32_bf16 v[60:63], a[44:47], v[44:47], v[60:63]
    buffer_load_dwordx4 a[48:51], v2, s[8:11], s57 offen nt
    buffer_load_dwordx4 a[52:55], v2, s[8:11], s57 offen offset:256 nt
    buffer_load_dwordx4 a[56:59], v2, s[8:11], s57 offen offset:512 nt
    buffer_load_dwordx4 a[60:63], v2, s[8:11], s57 offen offset:768 nt
    v_add_f32_dpp v48, v56, v57 quad_perm:[1,0,3,2] row_mask:0xf bank_mask:0xf
    v_add_f32_dpp v49, v58, v59 quad_perm:[1,0,3,2] row_mask:0xf bank_mask:0xf
    s_waitcnt vmcnt(15)
    v_mfma_f32_16x16x32_bf16 v[56:59], a[64:67], v[32:35], 0
    s_waitcnt vmcnt(14)
    v_mfma_f32_16x16x32_bf16 v[56:59], a[68:71], v[36:39], v[56:59]
    s_waitcnt vmcnt(13)
    v_mfma_f32_16x16x32_bf16 v[56:59], a[72:75], v[40:43], v[56:59]
    s_waitcnt vmcnt(12)
    v_mfma_f32_16x16x32_bf16 v[56:59], a[76:79], v[44:47], v[56:59]
    buffer_load_dwordx4 a[80:83], v2, s[8:11], s58 offen nt
    buffer_load_dwordx4 a[84:87], v2, s[8:11], s58 offen offset:256 nt
    buffer_load_dwordx4 a[88:91], v2, s[8:11], s58 offen offset:512 nt
    buffer_load_dwordx4 a[92:95], v2, s[8:11], s58 offen offset:768 nt
    v_add_f32_dpp v50, v60, v61 quad_perm:[1,0,3,2] row_mask:0xf bank_mask:0xf
    v_add_f32_dpp v51, v62, v63 quad_perm:[1,0,3,2] row_mask:0xf bank_mask:0xf
    s_waitcnt vmcnt(15)
    v_mfma_f32_16x16x32_bf16 v[60:63], a[96:99], v[32:35], 0
    s_waitcnt vmcnt(14)
    v_mfma_f32_16x16x32_bf16 v[60:63], a[100:103], v[36:39], v[60:63]
    s_waitcnt vmcnt(13)
    v_mfma_f32_16x16x32_bf16 v[60:63], a[104:107], v[40:43], v[60:63]
    s_waitcnt vmcnt(12)
    v_mfma_f32_16x16x32_bf16 v[60:63], a[108:111], v[44:47], v[60:63]
    buffer_load_dwordx4 a[112:115], v2, s[8:11], s59 offen nt
    buffer_load_dwordx4 a[116:119], v2, s[8:11], s59 offen offset:256 nt
    buffer_load_dwordx4 a[120:123], v2, s[8:11], s59 offen offset:512 nt
    buffer_load_dwordx4 a[124:127], v2, s[8:11], s59 offen offset:768 nt
    v_add_f32_dpp v52, v56, v57 quad_perm:[1,0,3,2] row_mask:0xf bank_mask:0xf
    v_add_f32_dpp v53, v58, v59 quad_perm:[1,0,3,2] row_mask:0xf bank_mask:0xf
    s_nop 1
    v_add_f32_dpp v54, v60, v61 quad_perm:[1,0,3,2] row_mask:0xf bank_mask:0xf
    v_add_f32_dpp v55, v62, v63 quad_perm:[1,0,3,2] row_mask:0xf bank_mask:0xf
    v_max3_f32 v72, v48, v49, v50
    v_max3_f32 v72, v72, v51, v52
    v_max3_f32 v72, v72, v53, v54
    v_max_f32 v72, v72, v55
    s_nop 1
    v_max_f32_dpp v72, v72, v72 row_bcast:15 row_mask:0xa bank_mask:0xf
    s_nop 1
    v_max_f32_dpp v72, v72, v72 row_bcast:31 row_mask:0xc bank_mask:0xf
    v_max_f32 v72, s61, v72
    s_nop 0
    v_readlane_b32 s61, v72, 63
    s_nop 1
    v_mul_f32 v73, s61, v9
    v_sub_f32 v74, v73, v31
    v_exp_f32 v74, v74
    v_mov_b32 v31, v73
    v_mul_f32 v30, v30, v74
    v_mul_f32 v22, v22, v74
    v_mul_f32 v23, v23, v74
    v_mul_f32 v24, v24, v74
    v_mul_f32 v25, v25, v74
    v_mul_f32 v26, v26, v74
    v_mul_f32 v27, v27, v74
    v_mul_f32 v28, v28, v74
    v_mul_f32 v29, v29, v74
    v_fma_f32 v48, v48, v8, v31
    v_fma_f32 v49, v49, v8, v31
    v_fma_f32 v50, v50, v8, v31
    v_fma_f32 v51, v51, v8, v31
    v_fma_f32 v52, v52, v8, v31
    v_fma_f32 v53, v53, v8, v31
    v_fma_f32 v54, v54, v8, v31
    v_fma_f32 v55, v55, v8, v31
    v_exp_f32 v48, v48
    v_exp_f32 v49, v49
    v_exp_f32 v50, v50
    v_exp_f32 v51, v51
    v_exp_f32 v52, v52
    v_exp_f32 v53, v53
    v_exp_f32 v54, v54
    v_exp_f32 v55, v55
    v_add_f32 v30, v30, v48
    v_cvt_pk_bf16_f32 v75, v48, v48
    v_and_b32 v64, v75, v4
    v_and_b32 v65, v75, v5
    v_and_b32 v66, v75, v6
    v_and_b32 v67, v75, v7
    s_waitcnt vmcnt(15)
    s_nop 0
    v_mfma_f32_16x16x32_bf16 v[22:25], a[16:19], v[64:67], v[22:25]
    s_waitcnt vmcnt(14)
    v_mfma_f32_16x16x32_bf16 v[26:29], a[20:23], v[64:67], v[26:29]
    v_add_f32 v30, v30, v49
    v_cvt_pk_bf16_f32 v75, v49, v49
    v_and_b32 v68, v75, v4
    v_and_b32 v69, v75, v5
    v_and_b32 v70, v75, v6
    v_and_b32 v71, v75, v7
    s_waitcnt vmcnt(13)
    s_nop 0
    v_mfma_f32_16x16x32_bf16 v[22:25], a[24:27], v[68:71], v[22:25]
    s_waitcnt vmcnt(12)
    v_mfma_f32_16x16x32_bf16 v[26:29], a[28:31], v[68:71], v[26:29]
    s_add_u32 s56, s54, 0x10000
    buffer_load_dwordx4 v[80:83], v1, s[4:7], s56 offen nt
    buffer_load_dwordx4 v[84:87], v1, s[4:7], s56 offen offset:128 nt
    buffer_load_dwordx4 v[88:91], v1, s[4:7], s56 offen offset:256 nt
    buffer_load_dwordx4 v[92:95], v1, s[4:7], s56 offen offset:384 nt
    v_add_f32 v30, v30, v50
    v_cvt_pk_bf16_f32 v75, v50, v50
    v_and_b32 v64, v75, v4
    v_and_b32 v65, v75, v5
    v_and_b32 v66, v75, v6
    v_and_b32 v67, v75, v7
    s_waitcnt vmcnt(15)
    s_nop 0
    v_mfma_f32_16x16x32_bf16 v[22:25], a[48:51], v[64:67], v[22:25]
    s_waitcnt vmcnt(14)
    v_mfma_f32_16x16x32_bf16 v[26:29], a[52:55], v[64:67], v[26:29]
    v_add_f32 v30, v30, v51
    v_cvt_pk_bf16_f32 v75, v51, v51
    v_and_b32 v68, v75, v4
    v_and_b32 v69, v75, v5
    v_and_b32 v70, v75, v6
    v_and_b32 v71, v75, v7
    s_waitcnt vmcnt(13)
    s_nop 0
    v_mfma_f32_16x16x32_bf16 v[22:25], a[56:59], v[68:71], v[22:25]
    s_waitcnt vmcnt(12)
    v_mfma_f32_16x16x32_bf16 v[26:29], a[60:63], v[68:71], v[26:29]
    s_add_u32 s57, s54, 0x11000
    buffer_load_dwordx4 v[112:115], v1, s[4:7], s57 offen nt
    buffer_load_dwordx4 v[116:119], v1, s[4:7], s57 offen offset:128 nt
    buffer_load_dwordx4 v[120:123], v1, s[4:7], s57 offen offset:256 nt
    buffer_load_dwordx4 v[124:127], v1, s[4:7], s57 offen offset:384 nt
    v_add_f32 v30, v30, v52
    v_cvt_pk_bf16_f32 v75, v52, v52
    v_and_b32 v64, v75, v4
    v_and_b32 v65, v75, v5
    v_and_b32 v66, v75, v6
    v_and_b32 v67, v75, v7
    s_waitcnt vmcnt(15)
    s_nop 0
    v_mfma_f32_16x16x32_bf16 v[22:25], a[80:83], v[64:67], v[22:25]
    s_waitcnt vmcnt(14)
    v_mfma_f32_16x16x32_bf16 v[26:29], a[84:87], v[64:67], v[26:29]
    v_add_f32 v30, v30, v53
    v_cvt_pk_bf16_f32 v75, v53, v53
    v_and_b32 v68, v75, v4
    v_and_b32 v69, v75, v5
    v_and_b32 v70, v75, v6
    v_and_b32 v71, v75, v7
    s_waitcnt vmcnt(13)
    s_nop 0
    v_mfma_f32_16x16x32_bf16 v[22:25], a[88:91], v[68:71], v[22:25]
    s_waitcnt vmcnt(12)
    v_mfma_f32_16x16x32_bf16 v[26:29], a[92:95], v[68:71], v[26:29]
    v_add_f32 v30, v30, v54
    v_cvt_pk_bf16_f32 v75, v54, v54
    v_and_b32 v64, v75, v4
    v_and_b32 v65, v75, v5
    v_and_b32 v66, v75, v6
    v_and_b32 v67, v75, v7
    s_waitcnt vmcnt(11)
    s_nop 0
    v_mfma_f32_16x16x32_bf16 v[22:25], a[112:115], v[64:67], v[22:25]
    s_waitcnt vmcnt(10)
    v_mfma_f32_16x16x32_bf16 v[26:29], a[116:119], v[64:67], v[26:29]
    v_add_f32 v30, v30, v55
    v_cvt_pk_bf16_f32 v75, v55, v55
    v_and_b32 v68, v75, v4
    v_and_b32 v69, v75, v5
    v_and_b32 v70, v75, v6
    v_and_b32 v71, v75, v7
    s_waitcnt vmcnt(9)
    s_nop 0
    v_mfma_f32_16x16x32_bf16 v[22:25], a[120:123], v[68:71], v[22:25]
    s_waitcnt vmcnt(8)
    v_mfma_f32_16x16x32_bf16 v[26:29], a[124:127], v[68:71], v[26:29]
    v_add_f32_dpp v30, v30, v30 row_bcast:15 row_mask:0xa bank_mask:0xf
    s_nop 1
    v_add_f32_dpp v30, v30, v30 row_bcast:31 row_mask:0xc bank_mask:0xf
    s_nop 0
    v_readlane_b32 s63, v30, 63
    s_mov_b64 exec, s[64:65]
    ds_write_b32 v11, v22 offset:4160
    ds_write_b32 v11, v23 offset:4192
    ds_write_b32 v11, v24 offset:4224
    ds_write_b32 v11, v25 offset:4256
    ds_write_b32 v11, v26 offset:4672
    ds_write_b32 v11, v27 offset:4704
    ds_write_b32 v11, v28 offset:4736
    ds_write_b32 v11, v29 offset:4768
    s_mov_b64 exec, -1
    v_mov_b32 v72, s61
    v_mov_b32 v73, s63
    ds_write_b64 v10, v[72:73] offset:5184
    s_waitcnt lgkmcnt(0)
    s_mov_b64 exec, 1
    v_mov_b32 v72, 1
    v_mov_b32 v73, 0x22084
    ds_add_rtn_u32 v74, v73, v72
    s_mov_b64 exec, -1
    s_waitcnt lgkmcnt(0)
    v_readfirstlane_b32 s63, v74
    s_cmp_lg_u32 s63, 3
    s_cbranch_scc1 L12
    v_lshlrev_b32 v77, 4, v0
    v_add_u32 v77, 0x20000, v77
    v_mov_b32 v76, 0x20000
    ds_read_b128 v[48:51], v77 offset:4160
    ds_read_b64 v[64:65], v76 offset:5184
    ds_read_b128 v[52:55], v77 offset:5200
    ds_read_b64 v[66:67], v76 offset:6224
    ds_read_b128 v[56:59], v77 offset:6240
    ds_read_b64 v[68:69], v76 offset:7264
    ds_read_b128 v[60:63], v77 offset:7280
    ds_read_b64 v[70:71], v76 offset:8304
    s_waitcnt lgkmcnt(0)
    v_max3_f32 v72, v64, v66, v68
    v_max_f32 v72, v72, v70
    v_sub_f32 v64, v64, v72
    v_mul_f32 v64, v64, v8
    v_exp_f32 v64, v64
    v_sub_f32 v66, v66, v72
    v_mul_f32 v66, v66, v8
    v_exp_f32 v66, v66
    v_sub_f32 v68, v68, v72
    v_mul_f32 v68, v68, v8
    v_exp_f32 v68, v68
    v_sub_f32 v70, v70, v72
    v_mul_f32 v70, v70, v8
    v_exp_f32 v70, v70
    v_mul_f32 v73, v64, v65
    v_fmac_f32 v73, v66, v67
    v_fmac_f32 v73, v68, v69
    v_fmac_f32 v73, v70, v71
    v_mul_f32 v48, v48, v64
    v_fmac_f32 v48, v52, v66
    v_fmac_f32 v48, v56, v68
    v_fmac_f32 v48, v60, v70
    v_mul_f32 v49, v49, v64
    v_fmac_f32 v49, v53, v66
    v_fmac_f32 v49, v57, v68
    v_fmac_f32 v49, v61, v70
    v_mul_f32 v50, v50, v64
    v_fmac_f32 v50, v54, v66
    v_fmac_f32 v50, v58, v68
    v_fmac_f32 v50, v62, v70
    v_mul_f32 v51, v51, v64
    v_fmac_f32 v51, v55, v66
    v_fmac_f32 v51, v59, v68
    v_fmac_f32 v51, v63, v70
    v_cvt_pk_bf16_f32 v74, v48, v49
    v_cvt_pk_bf16_f32 v75, v50, v51
    v_lshlrev_b32 v76, 3, v0
    s_lshl_b32 s63, s23, 9
    s_add_u32 s63, s63, 0x30000
    s_cmp_eq_u32 s3, 1
    s_cbranch_scc1 L13
    buffer_store_dwordx2 v[74:75], v76, s[12:15], s63 offen sc1
    s_branch L14
L13:
    s_nop 7
    buffer_store_dwordx2 v[74:75], v76, s[12:15], s63 offen
L14:
    s_nop 7
    s_lshl_b32 s63, s23, 3
    s_add_u32 s63, s63, 0x8800
    s_mov_b64 exec, 1
    s_cmp_eq_u32 s3, 1
    s_cbranch_scc1 L15
    buffer_store_dwordx2 v[72:73], v76, s[12:15], s63 offen sc1
    s_branch L16
L15:
    s_nop 7
    buffer_store_dwordx2 v[72:73], v76, s[12:15], s63 offen
L16:
    s_nop 7
    s_mov_b64 exec, -1
L12:
    s_nop 7
    v_and_b32 v73, 0x7f, v1
    v_add_u32 v73, 0x22500, v73
    ds_read_b128 v[32:35], v73
    ds_read_b128 v[36:39], v73 offset:128
    ds_read_b128 v[40:43], v73 offset:256
    ds_read_b128 v[44:47], v73 offset:384
    s_waitcnt lgkmcnt(0)
    v_mfma_f32_16x16x32_bf16 v[56:59], a[128:131], v[32:35], 0
    v_mfma_f32_16x16x32_bf16 v[56:59], a[132:135], v[36:39], v[56:59]
    v_mfma_f32_16x16x32_bf16 v[56:59], a[136:139], v[40:43], v[56:59]
    v_mfma_f32_16x16x32_bf16 v[56:59], a[140:143], v[44:47], v[56:59]
    v_mfma_f32_16x16x32_bf16 v[60:63], a[160:163], v[32:35], 0
    v_mfma_f32_16x16x32_bf16 v[60:63], a[164:167], v[36:39], v[60:63]
    v_mfma_f32_16x16x32_bf16 v[60:63], a[168:171], v[40:43], v[60:63]
    v_mfma_f32_16x16x32_bf16 v[60:63], a[172:175], v[44:47], v[60:63]
    s_nop 3
    v_add_f32_dpp v48, v56, v57 quad_perm:[1,0,3,2] row_mask:0xf bank_mask:0xf
    v_add_f32_dpp v49, v58, v59 quad_perm:[1,0,3,2] row_mask:0xf bank_mask:0xf
    v_mfma_f32_16x16x32_bf16 v[56:59], a[192:195], v[32:35], 0
    v_mfma_f32_16x16x32_bf16 v[56:59], a[196:199], v[36:39], v[56:59]
    v_mfma_f32_16x16x32_bf16 v[56:59], a[200:203], v[40:43], v[56:59]
    v_mfma_f32_16x16x32_bf16 v[56:59], a[204:207], v[44:47], v[56:59]
    v_add_f32_dpp v50, v60, v61 quad_perm:[1,0,3,2] row_mask:0xf bank_mask:0xf
    v_add_f32_dpp v51, v62, v63 quad_perm:[1,0,3,2] row_mask:0xf bank_mask:0xf
    v_mfma_f32_16x16x32_bf16 v[60:63], a[224:227], v[32:35], 0
    v_mfma_f32_16x16x32_bf16 v[60:63], a[228:231], v[36:39], v[60:63]
    v_mfma_f32_16x16x32_bf16 v[60:63], a[232:235], v[40:43], v[60:63]
    v_mfma_f32_16x16x32_bf16 v[60:63], a[236:239], v[44:47], v[60:63]
    s_nop 1
    v_add_f32_dpp v52, v56, v57 quad_perm:[1,0,3,2] row_mask:0xf bank_mask:0xf
    v_add_f32_dpp v53, v58, v59 quad_perm:[1,0,3,2] row_mask:0xf bank_mask:0xf
    s_nop 3
    v_add_f32_dpp v54, v60, v61 quad_perm:[1,0,3,2] row_mask:0xf bank_mask:0xf
    v_add_f32_dpp v55, v62, v63 quad_perm:[1,0,3,2] row_mask:0xf bank_mask:0xf
    v_max3_f32 v72, v48, v49, v50
    v_max3_f32 v72, v72, v51, v52
    v_max3_f32 v72, v72, v53, v54
    v_max_f32 v72, v72, v55
    s_nop 1
    v_max_f32_dpp v72, v72, v72 row_bcast:15 row_mask:0xa bank_mask:0xf
    s_nop 1
    v_max_f32_dpp v72, v72, v72 row_bcast:31 row_mask:0xc bank_mask:0xf
    v_max_f32 v72, s60, v72
    s_nop 0
    v_readlane_b32 s60, v72, 63
    s_nop 1
    v_mul_f32 v73, s60, v9
    v_sub_f32 v74, v73, v21
    v_exp_f32 v74, v74
    v_mov_b32 v21, v73
    v_mul_f32 v20, v20, v74
    v_mul_f32 v12, v12, v74
    v_mul_f32 v13, v13, v74
    v_mul_f32 v14, v14, v74
    v_mul_f32 v15, v15, v74
    v_mul_f32 v16, v16, v74
    v_mul_f32 v17, v17, v74
    v_mul_f32 v18, v18, v74
    v_mul_f32 v19, v19, v74
    v_fma_f32 v48, v48, v8, v21
    v_fma_f32 v49, v49, v8, v21
    v_fma_f32 v50, v50, v8, v21
    v_fma_f32 v51, v51, v8, v21
    v_fma_f32 v52, v52, v8, v21
    v_fma_f32 v53, v53, v8, v21
    v_fma_f32 v54, v54, v8, v21
    v_fma_f32 v55, v55, v8, v21
    v_exp_f32 v48, v48
    v_exp_f32 v49, v49
    v_exp_f32 v50, v50
    v_exp_f32 v51, v51
    v_exp_f32 v52, v52
    v_exp_f32 v53, v53
    v_exp_f32 v54, v54
    v_exp_f32 v55, v55
    v_add_f32 v20, v20, v48
    v_cvt_pk_bf16_f32 v75, v48, v48
    v_and_b32 v64, v75, v4
    v_and_b32 v65, v75, v5
    v_and_b32 v66, v75, v6
    v_and_b32 v67, v75, v7
    s_nop 1
    v_mfma_f32_16x16x32_bf16 v[12:15], a[144:147], v[64:67], v[12:15]
    v_mfma_f32_16x16x32_bf16 v[16:19], a[148:151], v[64:67], v[16:19]
    v_add_f32 v20, v20, v49
    v_cvt_pk_bf16_f32 v75, v49, v49
    v_and_b32 v68, v75, v4
    v_and_b32 v69, v75, v5
    v_and_b32 v70, v75, v6
    v_and_b32 v71, v75, v7
    s_nop 1
    v_mfma_f32_16x16x32_bf16 v[12:15], a[152:155], v[68:71], v[12:15]
    v_mfma_f32_16x16x32_bf16 v[16:19], a[156:159], v[68:71], v[16:19]
    v_add_f32 v20, v20, v50
    v_cvt_pk_bf16_f32 v75, v50, v50
    v_and_b32 v64, v75, v4
    v_and_b32 v65, v75, v5
    v_and_b32 v66, v75, v6
    v_and_b32 v67, v75, v7
    s_nop 1
    v_mfma_f32_16x16x32_bf16 v[12:15], a[176:179], v[64:67], v[12:15]
    v_mfma_f32_16x16x32_bf16 v[16:19], a[180:183], v[64:67], v[16:19]
    v_add_f32 v20, v20, v51
    v_cvt_pk_bf16_f32 v75, v51, v51
    v_and_b32 v68, v75, v4
    v_and_b32 v69, v75, v5
    v_and_b32 v70, v75, v6
    v_and_b32 v71, v75, v7
    s_nop 1
    v_mfma_f32_16x16x32_bf16 v[12:15], a[184:187], v[68:71], v[12:15]
    v_mfma_f32_16x16x32_bf16 v[16:19], a[188:191], v[68:71], v[16:19]
    v_add_f32 v20, v20, v52
    v_cvt_pk_bf16_f32 v75, v52, v52
    v_and_b32 v64, v75, v4
    v_and_b32 v65, v75, v5
    v_and_b32 v66, v75, v6
    v_and_b32 v67, v75, v7
    s_nop 1
    v_mfma_f32_16x16x32_bf16 v[12:15], a[208:211], v[64:67], v[12:15]
    v_mfma_f32_16x16x32_bf16 v[16:19], a[212:215], v[64:67], v[16:19]
    v_add_f32 v20, v20, v53
    v_cvt_pk_bf16_f32 v75, v53, v53
    v_and_b32 v68, v75, v4
    v_and_b32 v69, v75, v5
    v_and_b32 v70, v75, v6
    v_and_b32 v71, v75, v7
    s_nop 1
    v_mfma_f32_16x16x32_bf16 v[12:15], a[216:219], v[68:71], v[12:15]
    v_mfma_f32_16x16x32_bf16 v[16:19], a[220:223], v[68:71], v[16:19]
    v_add_f32 v20, v20, v54
    v_cvt_pk_bf16_f32 v75, v54, v54
    v_and_b32 v64, v75, v4
    v_and_b32 v65, v75, v5
    v_and_b32 v66, v75, v6
    v_and_b32 v67, v75, v7
    s_nop 1
    v_mfma_f32_16x16x32_bf16 v[12:15], a[240:243], v[64:67], v[12:15]
    v_mfma_f32_16x16x32_bf16 v[16:19], a[244:247], v[64:67], v[16:19]
    v_add_f32 v20, v20, v55
    v_cvt_pk_bf16_f32 v75, v55, v55
    v_and_b32 v68, v75, v4
    v_and_b32 v69, v75, v5
    v_and_b32 v70, v75, v6
    v_and_b32 v71, v75, v7
    s_nop 1
    v_mfma_f32_16x16x32_bf16 v[12:15], a[248:251], v[68:71], v[12:15]
    v_mfma_f32_16x16x32_bf16 v[16:19], a[252:255], v[68:71], v[16:19]
    v_mfma_f32_16x16x32_bf16 v[56:59], v[128:131], v[32:35], 0
    v_mfma_f32_16x16x32_bf16 v[56:59], v[132:135], v[36:39], v[56:59]
    v_mfma_f32_16x16x32_bf16 v[56:59], v[136:139], v[40:43], v[56:59]
    v_mfma_f32_16x16x32_bf16 v[56:59], v[140:143], v[44:47], v[56:59]
    v_mfma_f32_16x16x32_bf16 v[60:63], v[160:163], v[32:35], 0
    v_mfma_f32_16x16x32_bf16 v[60:63], v[164:167], v[36:39], v[60:63]
    v_mfma_f32_16x16x32_bf16 v[60:63], v[168:171], v[40:43], v[60:63]
    v_mfma_f32_16x16x32_bf16 v[60:63], v[172:175], v[44:47], v[60:63]
    s_nop 3
    v_add_f32_dpp v48, v56, v57 quad_perm:[1,0,3,2] row_mask:0xf bank_mask:0xf
    v_add_f32_dpp v49, v58, v59 quad_perm:[1,0,3,2] row_mask:0xf bank_mask:0xf
    v_mfma_f32_16x16x32_bf16 v[56:59], v[192:195], v[32:35], 0
    v_mfma_f32_16x16x32_bf16 v[56:59], v[196:199], v[36:39], v[56:59]
    v_mfma_f32_16x16x32_bf16 v[56:59], v[200:203], v[40:43], v[56:59]
    v_mfma_f32_16x16x32_bf16 v[56:59], v[204:207], v[44:47], v[56:59]
    v_add_f32_dpp v50, v60, v61 quad_perm:[1,0,3,2] row_mask:0xf bank_mask:0xf
    v_add_f32_dpp v51, v62, v63 quad_perm:[1,0,3,2] row_mask:0xf bank_mask:0xf
    v_mfma_f32_16x16x32_bf16 v[60:63], v[224:227], v[32:35], 0
    v_mfma_f32_16x16x32_bf16 v[60:63], v[228:231], v[36:39], v[60:63]
    v_mfma_f32_16x16x32_bf16 v[60:63], v[232:235], v[40:43], v[60:63]
    v_mfma_f32_16x16x32_bf16 v[60:63], v[236:239], v[44:47], v[60:63]
    s_nop 1
    v_add_f32_dpp v52, v56, v57 quad_perm:[1,0,3,2] row_mask:0xf bank_mask:0xf
    v_add_f32_dpp v53, v58, v59 quad_perm:[1,0,3,2] row_mask:0xf bank_mask:0xf
    s_nop 3
    v_add_f32_dpp v54, v60, v61 quad_perm:[1,0,3,2] row_mask:0xf bank_mask:0xf
    v_add_f32_dpp v55, v62, v63 quad_perm:[1,0,3,2] row_mask:0xf bank_mask:0xf
    v_max3_f32 v72, v48, v49, v50
    v_max3_f32 v72, v72, v51, v52
    v_max3_f32 v72, v72, v53, v54
    v_max_f32 v72, v72, v55
    s_nop 1
    v_max_f32_dpp v72, v72, v72 row_bcast:15 row_mask:0xa bank_mask:0xf
    s_nop 1
    v_max_f32_dpp v72, v72, v72 row_bcast:31 row_mask:0xc bank_mask:0xf
    v_max_f32 v72, s60, v72
    s_nop 0
    v_readlane_b32 s60, v72, 63
    s_nop 1
    v_mul_f32 v73, s60, v9
    v_sub_f32 v74, v73, v21
    v_exp_f32 v74, v74
    v_mov_b32 v21, v73
    v_mul_f32 v20, v20, v74
    v_mul_f32 v12, v12, v74
    v_mul_f32 v13, v13, v74
    v_mul_f32 v14, v14, v74
    v_mul_f32 v15, v15, v74
    v_mul_f32 v16, v16, v74
    v_mul_f32 v17, v17, v74
    v_mul_f32 v18, v18, v74
    v_mul_f32 v19, v19, v74
    v_fma_f32 v48, v48, v8, v21
    v_fma_f32 v49, v49, v8, v21
    v_fma_f32 v50, v50, v8, v21
    v_fma_f32 v51, v51, v8, v21
    v_fma_f32 v52, v52, v8, v21
    v_fma_f32 v53, v53, v8, v21
    v_fma_f32 v54, v54, v8, v21
    v_fma_f32 v55, v55, v8, v21
    v_exp_f32 v48, v48
    v_exp_f32 v49, v49
    v_exp_f32 v50, v50
    v_exp_f32 v51, v51
    v_exp_f32 v52, v52
    v_exp_f32 v53, v53
    v_exp_f32 v54, v54
    v_exp_f32 v55, v55
    v_add_f32 v20, v20, v48
    v_cvt_pk_bf16_f32 v75, v48, v48
    v_and_b32 v64, v75, v4
    v_and_b32 v65, v75, v5
    v_and_b32 v66, v75, v6
    v_and_b32 v67, v75, v7
    s_nop 1
    v_mfma_f32_16x16x32_bf16 v[12:15], v[144:147], v[64:67], v[12:15]
    v_mfma_f32_16x16x32_bf16 v[16:19], v[148:151], v[64:67], v[16:19]
    v_add_f32 v20, v20, v49
    v_cvt_pk_bf16_f32 v75, v49, v49
    v_and_b32 v68, v75, v4
    v_and_b32 v69, v75, v5
    v_and_b32 v70, v75, v6
    v_and_b32 v71, v75, v7
    s_nop 1
    v_mfma_f32_16x16x32_bf16 v[12:15], v[152:155], v[68:71], v[12:15]
    v_mfma_f32_16x16x32_bf16 v[16:19], v[156:159], v[68:71], v[16:19]
    v_add_f32 v20, v20, v50
    v_cvt_pk_bf16_f32 v75, v50, v50
    v_and_b32 v64, v75, v4
    v_and_b32 v65, v75, v5
    v_and_b32 v66, v75, v6
    v_and_b32 v67, v75, v7
    s_nop 1
    v_mfma_f32_16x16x32_bf16 v[12:15], v[176:179], v[64:67], v[12:15]
    v_mfma_f32_16x16x32_bf16 v[16:19], v[180:183], v[64:67], v[16:19]
    v_add_f32 v20, v20, v51
    v_cvt_pk_bf16_f32 v75, v51, v51
    v_and_b32 v68, v75, v4
    v_and_b32 v69, v75, v5
    v_and_b32 v70, v75, v6
    v_and_b32 v71, v75, v7
    s_nop 1
    v_mfma_f32_16x16x32_bf16 v[12:15], v[184:187], v[68:71], v[12:15]
    v_mfma_f32_16x16x32_bf16 v[16:19], v[188:191], v[68:71], v[16:19]
    v_add_f32 v20, v20, v52
    v_cvt_pk_bf16_f32 v75, v52, v52
    v_and_b32 v64, v75, v4
    v_and_b32 v65, v75, v5
    v_and_b32 v66, v75, v6
    v_and_b32 v67, v75, v7
    s_nop 1
    v_mfma_f32_16x16x32_bf16 v[12:15], v[208:211], v[64:67], v[12:15]
    v_mfma_f32_16x16x32_bf16 v[16:19], v[212:215], v[64:67], v[16:19]
    v_add_f32 v20, v20, v53
    v_cvt_pk_bf16_f32 v75, v53, v53
    v_and_b32 v68, v75, v4
    v_and_b32 v69, v75, v5
    v_and_b32 v70, v75, v6
    v_and_b32 v71, v75, v7
    s_nop 1
    v_mfma_f32_16x16x32_bf16 v[12:15], v[216:219], v[68:71], v[12:15]
    v_mfma_f32_16x16x32_bf16 v[16:19], v[220:223], v[68:71], v[16:19]
    v_add_f32 v20, v20, v54
    v_cvt_pk_bf16_f32 v75, v54, v54
    v_and_b32 v64, v75, v4
    v_and_b32 v65, v75, v5
    v_and_b32 v66, v75, v6
    v_and_b32 v67, v75, v7
    s_nop 1
    v_mfma_f32_16x16x32_bf16 v[12:15], v[240:243], v[64:67], v[12:15]
    v_mfma_f32_16x16x32_bf16 v[16:19], v[244:247], v[64:67], v[16:19]
    v_add_f32 v20, v20, v55
    v_cvt_pk_bf16_f32 v75, v55, v55
    v_and_b32 v68, v75, v4
    v_and_b32 v69, v75, v5
    v_and_b32 v70, v75, v6
    v_and_b32 v71, v75, v7
    s_nop 1
    v_mfma_f32_16x16x32_bf16 v[12:15], v[248:251], v[68:71], v[12:15]
    v_mfma_f32_16x16x32_bf16 v[16:19], v[252:255], v[68:71], v[16:19]
    ds_read_b128 v[96:99], v3
    ds_read_b128 v[100:103], v3 offset:1024
    ds_read_b128 v[104:107], v3 offset:2048
    ds_read_b128 v[108:111], v3 offset:3072
    s_waitcnt lgkmcnt(3)
    v_mfma_f32_16x16x32_bf16 v[56:59], v[96:99], v[32:35], 0
    s_waitcnt lgkmcnt(2)
    v_mfma_f32_16x16x32_bf16 v[56:59], v[100:103], v[36:39], v[56:59]
    s_waitcnt lgkmcnt(1)
    v_mfma_f32_16x16x32_bf16 v[56:59], v[104:107], v[40:43], v[56:59]
    s_waitcnt lgkmcnt(0)
    v_mfma_f32_16x16x32_bf16 v[56:59], v[108:111], v[44:47], v[56:59]
    ds_read_b128 v[96:99], v3 offset:8192
    ds_read_b128 v[100:103], v3 offset:9216
    ds_read_b128 v[104:107], v3 offset:10240
    ds_read_b128 v[108:111], v3 offset:11264
    s_waitcnt lgkmcnt(3)
    v_mfma_f32_16x16x32_bf16 v[60:63], v[96:99], v[32:35], 0
    s_waitcnt lgkmcnt(2)
    v_mfma_f32_16x16x32_bf16 v[60:63], v[100:103], v[36:39], v[60:63]
    s_waitcnt lgkmcnt(1)
    v_mfma_f32_16x16x32_bf16 v[60:63], v[104:107], v[40:43], v[60:63]
    s_waitcnt lgkmcnt(0)
    v_mfma_f32_16x16x32_bf16 v[60:63], v[108:111], v[44:47], v[60:63]
    v_add_f32_dpp v48, v56, v57 quad_perm:[1,0,3,2] row_mask:0xf bank_mask:0xf
    v_add_f32_dpp v49, v58, v59 quad_perm:[1,0,3,2] row_mask:0xf bank_mask:0xf
    ds_read_b128 v[96:99], v3 offset:16384
    ds_read_b128 v[100:103], v3 offset:17408
    ds_read_b128 v[104:107], v3 offset:18432
    ds_read_b128 v[108:111], v3 offset:19456
    s_waitcnt lgkmcnt(3)
    v_mfma_f32_16x16x32_bf16 v[56:59], v[96:99], v[32:35], 0
    s_waitcnt lgkmcnt(2)
    v_mfma_f32_16x16x32_bf16 v[56:59], v[100:103], v[36:39], v[56:59]
    s_waitcnt lgkmcnt(1)
    v_mfma_f32_16x16x32_bf16 v[56:59], v[104:107], v[40:43], v[56:59]
    s_waitcnt lgkmcnt(0)
    v_mfma_f32_16x16x32_bf16 v[56:59], v[108:111], v[44:47], v[56:59]
    v_add_f32_dpp v50, v60, v61 quad_perm:[1,0,3,2] row_mask:0xf bank_mask:0xf
    v_add_f32_dpp v51, v62, v63 quad_perm:[1,0,3,2] row_mask:0xf bank_mask:0xf
    ds_read_b128 v[96:99], v3 offset:24576
    ds_read_b128 v[100:103], v3 offset:25600
    ds_read_b128 v[104:107], v3 offset:26624
    ds_read_b128 v[108:111], v3 offset:27648
    s_waitcnt lgkmcnt(3)
    v_mfma_f32_16x16x32_bf16 v[60:63], v[96:99], v[32:35], 0
    s_waitcnt lgkmcnt(2)
    v_mfma_f32_16x16x32_bf16 v[60:63], v[100:103], v[36:39], v[60:63]
    s_waitcnt lgkmcnt(1)
    v_mfma_f32_16x16x32_bf16 v[60:63], v[104:107], v[40:43], v[60:63]
    s_waitcnt lgkmcnt(0)
    v_mfma_f32_16x16x32_bf16 v[60:63], v[108:111], v[44:47], v[60:63]
    v_add_f32_dpp v52, v56, v57 quad_perm:[1,0,3,2] row_mask:0xf bank_mask:0xf
    v_add_f32_dpp v53, v58, v59 quad_perm:[1,0,3,2] row_mask:0xf bank_mask:0xf
    s_nop 5
    v_add_f32_dpp v54, v60, v61 quad_perm:[1,0,3,2] row_mask:0xf bank_mask:0xf
    v_add_f32_dpp v55, v62, v63 quad_perm:[1,0,3,2] row_mask:0xf bank_mask:0xf
    v_max3_f32 v72, v48, v49, v50
    v_max3_f32 v72, v72, v51, v52
    v_max3_f32 v72, v72, v53, v54
    v_max_f32 v72, v72, v55
    s_nop 1
    v_max_f32_dpp v72, v72, v72 row_bcast:15 row_mask:0xa bank_mask:0xf
    s_nop 1
    v_max_f32_dpp v72, v72, v72 row_bcast:31 row_mask:0xc bank_mask:0xf
    v_max_f32 v72, s60, v72
    s_nop 0
    v_readlane_b32 s60, v72, 63
    s_nop 1
    v_mul_f32 v73, s60, v9
    v_sub_f32 v74, v73, v21
    v_exp_f32 v74, v74
    v_mov_b32 v21, v73
    v_mul_f32 v20, v20, v74
    v_mul_f32 v12, v12, v74
    v_mul_f32 v13, v13, v74
    v_mul_f32 v14, v14, v74
    v_mul_f32 v15, v15, v74
    v_mul_f32 v16, v16, v74
    v_mul_f32 v17, v17, v74
    v_mul_f32 v18, v18, v74
    v_mul_f32 v19, v19, v74
    v_fma_f32 v48, v48, v8, v21
    v_fma_f32 v49, v49, v8, v21
    v_fma_f32 v50, v50, v8, v21
    v_fma_f32 v51, v51, v8, v21
    v_fma_f32 v52, v52, v8, v21
    v_fma_f32 v53, v53, v8, v21
    v_fma_f32 v54, v54, v8, v21
    v_fma_f32 v55, v55, v8, v21
    v_exp_f32 v48, v48
    v_exp_f32 v49, v49
    v_exp_f32 v50, v50
    v_exp_f32 v51, v51
    v_exp_f32 v52, v52
    v_exp_f32 v53, v53
    v_exp_f32 v54, v54
    v_exp_f32 v55, v55
    ds_read_b128 v[96:99], v3 offset:4096
    ds_read_b128 v[100:103], v3 offset:5120
    ds_read_b128 v[104:107], v3 offset:6144
    ds_read_b128 v[108:111], v3 offset:7168
    v_add_f32 v20, v20, v48
    v_cvt_pk_bf16_f32 v75, v48, v48
    v_and_b32 v64, v75, v4
    v_and_b32 v65, v75, v5
    v_and_b32 v66, v75, v6
    v_and_b32 v67, v75, v7
    s_waitcnt lgkmcnt(3)
    s_nop 0
    v_mfma_f32_16x16x32_bf16 v[12:15], v[96:99], v[64:67], v[12:15]
    s_waitcnt lgkmcnt(2)
    v_mfma_f32_16x16x32_bf16 v[16:19], v[100:103], v[64:67], v[16:19]
    v_add_f32 v20, v20, v49
    v_cvt_pk_bf16_f32 v75, v49, v49
    v_and_b32 v68, v75, v4
    v_and_b32 v69, v75, v5
    v_and_b32 v70, v75, v6
    v_and_b32 v71, v75, v7
    s_waitcnt lgkmcnt(1)
    s_nop 0
    v_mfma_f32_16x16x32_bf16 v[12:15], v[104:107], v[68:71], v[12:15]
    s_waitcnt lgkmcnt(0)
    v_mfma_f32_16x16x32_bf16 v[16:19], v[108:111], v[68:71], v[16:19]
    ds_read_b128 v[96:99], v3 offset:12288
    ds_read_b128 v[100:103], v3 offset:13312
    ds_read_b128 v[104:107], v3 offset:14336
    ds_read_b128 v[108:111], v3 offset:15360
    v_add_f32 v20, v20, v50
    v_cvt_pk_bf16_f32 v75, v50, v50
    v_and_b32 v64, v75, v4
    v_and_b32 v65, v75, v5
    v_and_b32 v66, v75, v6
    v_and_b32 v67, v75, v7
    s_waitcnt lgkmcnt(3)
    s_nop 0
    v_mfma_f32_16x16x32_bf16 v[12:15], v[96:99], v[64:67], v[12:15]
    s_waitcnt lgkmcnt(2)
    v_mfma_f32_16x16x32_bf16 v[16:19], v[100:103], v[64:67], v[16:19]
    v_add_f32 v20, v20, v51
    v_cvt_pk_bf16_f32 v75, v51, v51
    v_and_b32 v68, v75, v4
    v_and_b32 v69, v75, v5
    v_and_b32 v70, v75, v6
    v_and_b32 v71, v75, v7
    s_waitcnt lgkmcnt(1)
    s_nop 0
    v_mfma_f32_16x16x32_bf16 v[12:15], v[104:107], v[68:71], v[12:15]
    s_waitcnt lgkmcnt(0)
    v_mfma_f32_16x16x32_bf16 v[16:19], v[108:111], v[68:71], v[16:19]
    ds_read_b128 v[96:99], v3 offset:20480
    ds_read_b128 v[100:103], v3 offset:21504
    ds_read_b128 v[104:107], v3 offset:22528
    ds_read_b128 v[108:111], v3 offset:23552
    v_add_f32 v20, v20, v52
    v_cvt_pk_bf16_f32 v75, v52, v52
    v_and_b32 v64, v75, v4
    v_and_b32 v65, v75, v5
    v_and_b32 v66, v75, v6
    v_and_b32 v67, v75, v7
    s_waitcnt lgkmcnt(3)
    s_nop 0
    v_mfma_f32_16x16x32_bf16 v[12:15], v[96:99], v[64:67], v[12:15]
    s_waitcnt lgkmcnt(2)
    v_mfma_f32_16x16x32_bf16 v[16:19], v[100:103], v[64:67], v[16:19]
    v_add_f32 v20, v20, v53
    v_cvt_pk_bf16_f32 v75, v53, v53
    v_and_b32 v68, v75, v4
    v_and_b32 v69, v75, v5
    v_and_b32 v70, v75, v6
    v_and_b32 v71, v75, v7
    s_waitcnt lgkmcnt(1)
    s_nop 0
    v_mfma_f32_16x16x32_bf16 v[12:15], v[104:107], v[68:71], v[12:15]
    s_waitcnt lgkmcnt(0)
    v_mfma_f32_16x16x32_bf16 v[16:19], v[108:111], v[68:71], v[16:19]
    ds_read_b128 v[96:99], v3 offset:28672
    ds_read_b128 v[100:103], v3 offset:29696
    ds_read_b128 v[104:107], v3 offset:30720
    ds_read_b128 v[108:111], v3 offset:31744
    v_add_f32 v20, v20, v54
    v_cvt_pk_bf16_f32 v75, v54, v54
    v_and_b32 v64, v75, v4
    v_and_b32 v65, v75, v5
    v_and_b32 v66, v75, v6
    v_and_b32 v67, v75, v7
    s_waitcnt lgkmcnt(3)
    s_nop 0
    v_mfma_f32_16x16x32_bf16 v[12:15], v[96:99], v[64:67], v[12:15]
    s_waitcnt lgkmcnt(2)
    v_mfma_f32_16x16x32_bf16 v[16:19], v[100:103], v[64:67], v[16:19]
    v_add_f32 v20, v20, v55
    v_cvt_pk_bf16_f32 v75, v55, v55
    v_and_b32 v68, v75, v4
    v_and_b32 v69, v75, v5
    v_and_b32 v70, v75, v6
    v_and_b32 v71, v75, v7
    s_waitcnt lgkmcnt(1)
    s_nop 0
    v_mfma_f32_16x16x32_bf16 v[12:15], v[104:107], v[68:71], v[12:15]
    s_waitcnt lgkmcnt(0)
    v_mfma_f32_16x16x32_bf16 v[16:19], v[108:111], v[68:71], v[16:19]
    s_waitcnt vmcnt(7)
    v_mfma_f32_16x16x32_bf16 v[56:59], v[80:83], v[32:35], 0
    s_waitcnt vmcnt(6)
    v_mfma_f32_16x16x32_bf16 v[56:59], v[84:87], v[36:39], v[56:59]
    s_waitcnt vmcnt(5)
    v_mfma_f32_16x16x32_bf16 v[56:59], v[88:91], v[40:43], v[56:59]
    s_waitcnt vmcnt(4)
    v_mfma_f32_16x16x32_bf16 v[56:59], v[92:95], v[44:47], v[56:59]
    buffer_load_dwordx4 v[96:99], v2, s[8:11], s56 offen nt
    buffer_load_dwordx4 v[100:103], v2, s[8:11], s56 offen offset:256 nt
    buffer_load_dwordx4 v[104:107], v2, s[8:11], s56 offen offset:512 nt
    buffer_load_dwordx4 v[108:111], v2, s[8:11], s56 offen offset:768 nt
    s_waitcnt vmcnt(7)
    v_mfma_f32_16x16x32_bf16 v[60:63], v[112:115], v[32:35], 0
    s_waitcnt vmcnt(6)
    v_mfma_f32_16x16x32_bf16 v[60:63], v[116:119], v[36:39], v[60:63]
    s_waitcnt vmcnt(5)
    v_mfma_f32_16x16x32_bf16 v[60:63], v[120:123], v[40:43], v[60:63]
    s_waitcnt vmcnt(4)
    v_mfma_f32_16x16x32_bf16 v[60:63], v[124:127], v[44:47], v[60:63]
    buffer_load_dwordx4 v[80:83], v2, s[8:11], s57 offen nt
    buffer_load_dwordx4 v[84:87], v2, s[8:11], s57 offen offset:256 nt
    buffer_load_dwordx4 v[88:91], v2, s[8:11], s57 offen offset:512 nt
    buffer_load_dwordx4 v[92:95], v2, s[8:11], s57 offen offset:768 nt
    v_add_f32_dpp v48, v56, v57 quad_perm:[1,0,3,2] row_mask:0xf bank_mask:0xf
    v_add_f32_dpp v49, v58, v59 quad_perm:[1,0,3,2] row_mask:0xf bank_mask:0xf
    s_nop 1
    v_add_f32_dpp v50, v60, v61 quad_perm:[1,0,3,2] row_mask:0xf bank_mask:0xf
    v_add_f32_dpp v51, v62, v63 quad_perm:[1,0,3,2] row_mask:0xf bank_mask:0xf
    v_max3_f32 v72, v48, v49, v50
    v_max_f32 v72, v72, v51
    s_nop 1
    v_max_f32_dpp v72, v72, v72 row_bcast:15 row_mask:0xa bank_mask:0xf
    s_nop 1
    v_max_f32_dpp v72, v72, v72 row_bcast:31 row_mask:0xc bank_mask:0xf
    v_max_f32 v72, s60, v72
    s_nop 0
    v_readlane_b32 s60, v72, 63
    s_nop 1
    v_mul_f32 v73, s60, v9
    v_sub_f32 v74, v73, v21
    v_exp_f32 v74, v74
    v_mov_b32 v21, v73
    v_mul_f32 v20, v20, v74
    v_mul_f32 v12, v12, v74
    v_mul_f32 v13, v13, v74
    v_mul_f32 v14, v14, v74
    v_mul_f32 v15, v15, v74
    v_mul_f32 v16, v16, v74
    v_mul_f32 v17, v17, v74
    v_mul_f32 v18, v18, v74
    v_mul_f32 v19, v19, v74
    v_fma_f32 v48, v48, v8, v21
    v_fma_f32 v49, v49, v8, v21
    v_fma_f32 v50, v50, v8, v21
    v_fma_f32 v51, v51, v8, v21
    v_exp_f32 v48, v48
    v_exp_f32 v49, v49
    v_exp_f32 v50, v50
    v_exp_f32 v51, v51
    v_add_f32 v20, v20, v48
    v_cvt_pk_bf16_f32 v75, v48, v48
    v_and_b32 v64, v75, v4
    v_and_b32 v65, v75, v5
    v_and_b32 v66, v75, v6
    v_and_b32 v67, v75, v7
    s_waitcnt vmcnt(7)
    s_nop 0
    v_mfma_f32_16x16x32_bf16 v[12:15], v[96:99], v[64:67], v[12:15]
    s_waitcnt vmcnt(6)
    v_mfma_f32_16x16x32_bf16 v[16:19], v[100:103], v[64:67], v[16:19]
    v_add_f32 v20, v20, v49
    v_cvt_pk_bf16_f32 v75, v49, v49
    v_and_b32 v68, v75, v4
    v_and_b32 v69, v75, v5
    v_and_b32 v70, v75, v6
    v_and_b32 v71, v75, v7
    s_waitcnt vmcnt(5)
    s_nop 0
    v_mfma_f32_16x16x32_bf16 v[12:15], v[104:107], v[68:71], v[12:15]
    s_waitcnt vmcnt(4)
    v_mfma_f32_16x16x32_bf16 v[16:19], v[108:111], v[68:71], v[16:19]
    buffer_load_dwordx4 v[112:115], v1, s[4:7], s20 offen nt
    buffer_load_dwordx4 v[116:119], v1, s[4:7], s20 offen offset:128 nt
    buffer_load_dwordx4 v[120:123], v1, s[4:7], s20 offen offset:256 nt
    buffer_load_dwordx4 v[124:127], v1, s[4:7], s20 offen offset:384 nt
    v_add_f32 v20, v20, v50
    v_cvt_pk_bf16_f32 v75, v50, v50
    v_and_b32 v64, v75, v4
    v_and_b32 v65, v75, v5
    v_and_b32 v66, v75, v6
    v_and_b32 v67, v75, v7
    s_waitcnt vmcnt(7)
    s_nop 0
    v_mfma_f32_16x16x32_bf16 v[12:15], v[80:83], v[64:67], v[12:15]
    s_waitcnt vmcnt(6)
    v_mfma_f32_16x16x32_bf16 v[16:19], v[84:87], v[64:67], v[16:19]
    v_add_f32 v20, v20, v51
    v_cvt_pk_bf16_f32 v75, v51, v51
    v_and_b32 v68, v75, v4
    v_and_b32 v69, v75, v5
    v_and_b32 v70, v75, v6
    v_and_b32 v71, v75, v7
    s_waitcnt vmcnt(5)
    s_nop 0
    v_mfma_f32_16x16x32_bf16 v[12:15], v[88:91], v[68:71], v[12:15]
    s_waitcnt vmcnt(4)
    v_mfma_f32_16x16x32_bf16 v[16:19], v[92:95], v[68:71], v[16:19]
    buffer_load_dwordx4 v[96:99], v2, s[8:11], s20 offen nt
    buffer_load_dwordx4 v[100:103], v2, s[8:11], s20 offen offset:256 nt
    buffer_load_dwordx4 v[104:107], v2, s[8:11], s20 offen offset:512 nt
    buffer_load_dwordx4 v[108:111], v2, s[8:11], s20 offen offset:768 nt
    s_add_u32 s58, s55, 0
    buffer_load_dwordx4 a[128:131], v1, s[4:7], s58 offen nt
    buffer_load_dwordx4 a[132:135], v1, s[4:7], s58 offen offset:128 nt
    buffer_load_dwordx4 a[136:139], v1, s[4:7], s58 offen offset:256 nt
    buffer_load_dwordx4 a[140:143], v1, s[4:7], s58 offen offset:384 nt
    s_add_u32 s59, s55, 0x1000
    buffer_load_dwordx4 a[160:163], v1, s[4:7], s59 offen nt
    buffer_load_dwordx4 a[164:167], v1, s[4:7], s59 offen offset:128 nt
    buffer_load_dwordx4 a[168:171], v1, s[4:7], s59 offen offset:256 nt
    buffer_load_dwordx4 a[172:175], v1, s[4:7], s59 offen offset:384 nt
    s_waitcnt vmcnt(15)
    v_mfma_f32_16x16x32_bf16 v[56:59], v[112:115], v[32:35], 0
    s_waitcnt vmcnt(14)
    v_mfma_f32_16x16x32_bf16 v[56:59], v[116:119], v[36:39], v[56:59]
    s_waitcnt vmcnt(13)
    v_mfma_f32_16x16x32_bf16 v[56:59], v[120:123], v[40:43], v[56:59]
    s_waitcnt vmcnt(12)
    v_mfma_f32_16x16x32_bf16 v[56:59], v[124:127], v[44:47], v[56:59]
    s_add_u32 s56, s55, 0x2000
    buffer_load_dwordx4 a[192:195], v1, s[4:7], s56 offen nt
    buffer_load_dwordx4 a[196:199], v1, s[4:7], s56 offen offset:128 nt
    buffer_load_dwordx4 a[200:203], v1, s[4:7], s56 offen offset:256 nt
    buffer_load_dwordx4 a[204:207], v1, s[4:7], s56 offen offset:384 nt
    s_nop 2
    v_add_f32_dpp v48, v56, v57 quad_perm:[1,0,3,2] row_mask:0xf bank_mask:0xf
    v_add_f32 v48, s22, v48
    v_add_f32_dpp v49, v58, v59 quad_perm:[1,0,3,2] row_mask:0xf bank_mask:0xf
    v_add_f32 v49, s22, v49
    v_max_f32 v72, v48, v49
    s_nop 1
    v_max_f32_dpp v72, v72, v72 row_bcast:15 row_mask:0xa bank_mask:0xf
    s_nop 1
    v_max_f32_dpp v72, v72, v72 row_bcast:31 row_mask:0xc bank_mask:0xf
    v_max_f32 v72, s60, v72
    s_nop 0
    v_readlane_b32 s60, v72, 63
    s_nop 1
    v_mul_f32 v73, s60, v9
    v_sub_f32 v74, v73, v21
    v_exp_f32 v74, v74
    v_mov_b32 v21, v73
    v_mul_f32 v20, v20, v74
    v_mul_f32 v12, v12, v74
    v_mul_f32 v13, v13, v74
    v_mul_f32 v14, v14, v74
    v_mul_f32 v15, v15, v74
    v_mul_f32 v16, v16, v74
    v_mul_f32 v17, v17, v74
    v_mul_f32 v18, v18, v74
    v_mul_f32 v19, v19, v74
    v_fma_f32 v48, v48, v8, v21
    v_fma_f32 v49, v49, v8, v21
    v_exp_f32 v48, v48
    v_exp_f32 v49, v49
    v_add_f32 v20, v20, v48
    v_cvt_pk_bf16_f32 v75, v48, v48
    v_and_b32 v64, v75, v4
    v_and_b32 v65, v75, v5
    v_and_b32 v66, v75, v6
    v_and_b32 v67, v75, v7
    s_waitcnt vmcnt(15)
    s_nop 0
    v_mfma_f32_16x16x32_bf16 v[12:15], v[96:99], v[64:67], v[12:15]
    s_waitcnt vmcnt(14)
    v_mfma_f32_16x16x32_bf16 v[16:19], v[100:103], v[64:67], v[16:19]
    v_add_f32 v20, v20, v49
    v_cvt_pk_bf16_f32 v75, v49, v49
    v_and_b32 v68, v75, v4
    v_and_b32 v69, v75, v5
    v_and_b32 v70, v75, v6
    v_and_b32 v71, v75, v7
    s_waitcnt vmcnt(13)
    s_nop 0
    v_mfma_f32_16x16x32_bf16 v[12:15], v[104:107], v[68:71], v[12:15]
    s_waitcnt vmcnt(12)
    v_mfma_f32_16x16x32_bf16 v[16:19], v[108:111], v[68:71], v[16:19]
    s_add_u32 s57, s55, 0x3000
    buffer_load_dwordx4 a[224:227], v1, s[4:7], s57 offen nt
    buffer_load_dwordx4 a[228:231], v1, s[4:7], s57 offen offset:128 nt
    buffer_load_dwordx4 a[232:235], v1, s[4:7], s57 offen offset:256 nt
    buffer_load_dwordx4 a[236:239], v1, s[4:7], s57 offen offset:384 nt
    v_add_f32_dpp v20, v20, v20 row_bcast:15 row_mask:0xa bank_mask:0xf
    s_nop 1
    v_add_f32_dpp v20, v20, v20 row_bcast:31 row_mask:0xc bank_mask:0xf
    s_nop 0
    v_readlane_b32 s63, v20, 63
    s_mov_b64 exec, s[64:65]
    ds_write_b32 v11, v12
    ds_write_b32 v11, v13 offset:32
    ds_write_b32 v11, v14 offset:64
    ds_write_b32 v11, v15 offset:96
    ds_write_b32 v11, v16 offset:512
    ds_write_b32 v11, v17 offset:544
    ds_write_b32 v11, v18 offset:576
    ds_write_b32 v11, v19 offset:608
    s_mov_b64 exec, -1
    v_mov_b32 v72, s60
    v_mov_b32 v73, s63
    ds_write_b64 v10, v[72:73] offset:1024
    s_waitcnt lgkmcnt(0)
    s_mov_b64 exec, 1
    v_mov_b32 v72, 1
    v_mov_b32 v73, 0x22088
    ds_add_rtn_u32 v74, v73, v72
    s_mov_b64 exec, -1
    s_waitcnt lgkmcnt(0)
    v_readfirstlane_b32 s63, v74
    s_cmp_lg_u32 s63, 3
    s_cbranch_scc1 L17
    v_lshlrev_b32 v77, 4, v0
    v_add_u32 v77, 0x20000, v77
    v_mov_b32 v76, 0x20000
    ds_read_b128 v[48:51], v77
    ds_read_b64 v[64:65], v76 offset:1024
    ds_read_b128 v[52:55], v77 offset:1040
    ds_read_b64 v[66:67], v76 offset:2064
    ds_read_b128 v[56:59], v77 offset:2080
    ds_read_b64 v[68:69], v76 offset:3104
    ds_read_b128 v[60:63], v77 offset:3120
    ds_read_b64 v[70:71], v76 offset:4144
    s_waitcnt lgkmcnt(0)
    v_max3_f32 v72, v64, v66, v68
    v_max_f32 v72, v72, v70
    v_sub_f32 v64, v64, v72
    v_mul_f32 v64, v64, v8
    v_exp_f32 v64, v64
    v_sub_f32 v66, v66, v72
    v_mul_f32 v66, v66, v8
    v_exp_f32 v66, v66
    v_sub_f32 v68, v68, v72
    v_mul_f32 v68, v68, v8
    v_exp_f32 v68, v68
    v_sub_f32 v70, v70, v72
    v_mul_f32 v70, v70, v8
    v_exp_f32 v70, v70
    v_mul_f32 v73, v64, v65
    v_fmac_f32 v73, v66, v67
    v_fmac_f32 v73, v68, v69
    v_fmac_f32 v73, v70, v71
    v_mul_f32 v48, v48, v64
    v_fmac_f32 v48, v52, v66
    v_fmac_f32 v48, v56, v68
    v_fmac_f32 v48, v60, v70
    v_mul_f32 v49, v49, v64
    v_fmac_f32 v49, v53, v66
    v_fmac_f32 v49, v57, v68
    v_fmac_f32 v49, v61, v70
    v_mul_f32 v50, v50, v64
    v_fmac_f32 v50, v54, v66
    v_fmac_f32 v50, v58, v68
    v_fmac_f32 v50, v62, v70
    v_mul_f32 v51, v51, v64
    v_fmac_f32 v51, v55, v66
    v_fmac_f32 v51, v59, v68
    v_fmac_f32 v51, v63, v70
    v_cvt_pk_bf16_f32 v74, v48, v49
    v_cvt_pk_bf16_f32 v75, v50, v51
    v_lshlrev_b32 v76, 3, v0
    s_lshl_b32 s63, s23, 9
    s_add_u32 s63, s63, 0x50000
    s_cmp_eq_u32 s3, 1
    s_cbranch_scc1 L18
    buffer_store_dwordx2 v[74:75], v76, s[12:15], s63 offen sc1
    s_branch L19
L18:
    s_nop 7
    buffer_store_dwordx2 v[74:75], v76, s[12:15], s63 offen
L19:
    s_nop 7
    s_lshl_b32 s63, s23, 3
    s_add_u32 s63, s63, 0x9000
    s_mov_b64 exec, 1
    s_cmp_eq_u32 s3, 1
    s_cbranch_scc1 L20
    buffer_store_dwordx2 v[72:73], v76, s[12:15], s63 offen sc1
    s_branch L21
L20:
    s_nop 7
    buffer_store_dwordx2 v[72:73], v76, s[12:15], s63 offen
L21:
    s_nop 7
    s_mov_b64 exec, -1
L17:
    s_nop 7
    s_waitcnt vmcnt(15)
    buffer_load_dwordx4 a[144:147], v2, s[8:11], s58 offen nt
    s_waitcnt vmcnt(15)
    buffer_load_dwordx4 a[148:151], v2, s[8:11], s58 offen offset:256 nt
    s_waitcnt vmcnt(15)
    buffer_load_dwordx4 a[152:155], v2, s[8:11], s58 offen offset:512 nt
    s_waitcnt vmcnt(15)
    buffer_load_dwordx4 a[156:159], v2, s[8:11], s58 offen offset:768 nt
    s_waitcnt vmcnt(15)
    buffer_load_dwordx4 a[176:179], v2, s[8:11], s59 offen nt
    s_waitcnt vmcnt(15)
    buffer_load_dwordx4 a[180:183], v2, s[8:11], s59 offen offset:256 nt
    s_waitcnt vmcnt(15)
    buffer_load_dwordx4 a[184:187], v2, s[8:11], s59 offen offset:512 nt
    s_waitcnt vmcnt(15)
    buffer_load_dwordx4 a[188:191], v2, s[8:11], s59 offen offset:768 nt
    s_waitcnt vmcnt(15)
    buffer_load_dwordx4 a[208:211], v2, s[8:11], s56 offen nt
    s_waitcnt vmcnt(15)
    buffer_load_dwordx4 a[212:215], v2, s[8:11], s56 offen offset:256 nt
    s_waitcnt vmcnt(15)
    buffer_load_dwordx4 a[216:219], v2, s[8:11], s56 offen offset:512 nt
    s_waitcnt vmcnt(15)
    buffer_load_dwordx4 a[220:223], v2, s[8:11], s56 offen offset:768 nt
    s_waitcnt vmcnt(15)
    buffer_load_dwordx4 a[240:243], v2, s[8:11], s57 offen nt
    s_waitcnt vmcnt(15)
    buffer_load_dwordx4 a[244:247], v2, s[8:11], s57 offen offset:256 nt
    s_waitcnt vmcnt(15)
    buffer_load_dwordx4 a[248:251], v2, s[8:11], s57 offen offset:512 nt
    s_waitcnt vmcnt(15)
    buffer_load_dwordx4 a[252:255], v2, s[8:11], s57 offen offset:768 nt
    s_waitcnt vmcnt(15)
    s_add_u32 s58, s55, 0x4000
    buffer_load_dwordx4 v[128:131], v1, s[4:7], s58 offen nt
    s_waitcnt vmcnt(15)
    buffer_load_dwordx4 v[132:135], v1, s[4:7], s58 offen offset:128 nt
    s_waitcnt vmcnt(15)
    buffer_load_dwordx4 v[136:139], v1, s[4:7], s58 offen offset:256 nt
    s_waitcnt vmcnt(15)
    buffer_load_dwordx4 v[140:143], v1, s[4:7], s58 offen offset:384 nt
    s_waitcnt vmcnt(15)
    s_add_u32 s59, s55, 0x5000
    buffer_load_dwordx4 v[160:163], v1, s[4:7], s59 offen nt
    s_waitcnt vmcnt(15)
    buffer_load_dwordx4 v[164:167], v1, s[4:7], s59 offen offset:128 nt
    s_waitcnt vmcnt(15)
    buffer_load_dwordx4 v[168:171], v1, s[4:7], s59 offen offset:256 nt
    s_waitcnt vmcnt(15)
    buffer_load_dwordx4 v[172:175], v1, s[4:7], s59 offen offset:384 nt
    s_waitcnt vmcnt(15)
    s_add_u32 s56, s55, 0x6000
    buffer_load_dwordx4 v[192:195], v1, s[4:7], s56 offen nt
    s_waitcnt vmcnt(15)
    buffer_load_dwordx4 v[196:199], v1, s[4:7], s56 offen offset:128 nt
    s_waitcnt vmcnt(15)
    buffer_load_dwordx4 v[200:203], v1, s[4:7], s56 offen offset:256 nt
    s_waitcnt vmcnt(15)
    buffer_load_dwordx4 v[204:207], v1, s[4:7], s56 offen offset:384 nt
    s_waitcnt vmcnt(15)
    s_add_u32 s57, s55, 0x7000
    buffer_load_dwordx4 v[224:227], v1, s[4:7], s57 offen nt
    s_waitcnt vmcnt(15)
    buffer_load_dwordx4 v[228:231], v1, s[4:7], s57 offen offset:128 nt
    s_waitcnt vmcnt(15)
    buffer_load_dwordx4 v[232:235], v1, s[4:7], s57 offen offset:256 nt
    s_waitcnt vmcnt(15)
    buffer_load_dwordx4 v[236:239], v1, s[4:7], s57 offen offset:384 nt
    s_waitcnt vmcnt(15)
    buffer_load_dwordx4 v[144:147], v2, s[8:11], s58 offen nt
    s_waitcnt vmcnt(15)
    buffer_load_dwordx4 v[148:151], v2, s[8:11], s58 offen offset:256 nt
    s_waitcnt vmcnt(15)
    buffer_load_dwordx4 v[152:155], v2, s[8:11], s58 offen offset:512 nt
    s_waitcnt vmcnt(15)
    buffer_load_dwordx4 v[156:159], v2, s[8:11], s58 offen offset:768 nt
    s_waitcnt vmcnt(15)
    buffer_load_dwordx4 v[176:179], v2, s[8:11], s59 offen nt
    s_waitcnt vmcnt(15)
    buffer_load_dwordx4 v[180:183], v2, s[8:11], s59 offen offset:256 nt
    s_waitcnt vmcnt(15)
    buffer_load_dwordx4 v[184:187], v2, s[8:11], s59 offen offset:512 nt
    s_waitcnt vmcnt(15)
    buffer_load_dwordx4 v[188:191], v2, s[8:11], s59 offen offset:768 nt
    s_waitcnt vmcnt(15)
    buffer_load_dwordx4 v[208:211], v2, s[8:11], s56 offen nt
    s_waitcnt vmcnt(15)
    buffer_load_dwordx4 v[212:215], v2, s[8:11], s56 offen offset:256 nt
    s_waitcnt vmcnt(15)
    buffer_load_dwordx4 v[216:219], v2, s[8:11], s56 offen offset:512 nt
    s_waitcnt vmcnt(15)
    buffer_load_dwordx4 v[220:223], v2, s[8:11], s56 offen offset:768 nt
    s_waitcnt vmcnt(15)
    buffer_load_dwordx4 v[240:243], v2, s[8:11], s57 offen nt
    s_waitcnt vmcnt(15)
    buffer_load_dwordx4 v[244:247], v2, s[8:11], s57 offen offset:256 nt
    s_waitcnt vmcnt(15)
    buffer_load_dwordx4 v[248:251], v2, s[8:11], s57 offen offset:512 nt
    s_waitcnt vmcnt(15)
    buffer_load_dwordx4 v[252:255], v2, s[8:11], s57 offen offset:768 nt
    s_waitcnt vmcnt(15)
    s_add_u32 s58, s55, 0x8000
    s_add_u32 m0, s97, 0
    s_nop 0
    buffer_load_dwordx4 v1, s[4:7], s58 offen nt lds
    s_waitcnt vmcnt(15)
    s_add_u32 m0, s97, 0x380
    s_nop 0
    buffer_load_dwordx4 v1, s[4:7], s58 offen offset:128 nt lds
    s_waitcnt vmcnt(15)
    s_add_u32 m0, s97, 0x700
    s_nop 0
    buffer_load_dwordx4 v1, s[4:7], s58 offen offset:256 nt lds
    s_waitcnt vmcnt(15)
    s_add_u32 m0, s97, 0xa80
    s_nop 0
    buffer_load_dwordx4 v1, s[4:7], s58 offen offset:384 nt lds
    s_waitcnt vmcnt(15)
    s_add_u32 s59, s55, 0x9000
    s_add_u32 m0, s97, 0x2000
    s_nop 0
    buffer_load_dwordx4 v1, s[4:7], s59 offen nt lds
    s_waitcnt vmcnt(15)
    s_add_u32 m0, s97, 0x2380
    s_nop 0
    buffer_load_dwordx4 v1, s[4:7], s59 offen offset:128 nt lds
    s_waitcnt vmcnt(15)
    s_add_u32 m0, s97, 0x2700
    s_nop 0
    buffer_load_dwordx4 v1, s[4:7], s59 offen offset:256 nt lds
    s_waitcnt vmcnt(15)
    s_add_u32 m0, s97, 0x2a80
    s_nop 0
    buffer_load_dwordx4 v1, s[4:7], s59 offen offset:384 nt lds
    s_waitcnt vmcnt(15)
    s_add_u32 s56, s55, 0xa000
    s_add_u32 m0, s97, 0x4000
    s_nop 0
    buffer_load_dwordx4 v1, s[4:7], s56 offen nt lds
    s_waitcnt vmcnt(15)
    s_add_u32 m0, s97, 0x4380
    s_nop 0
    buffer_load_dwordx4 v1, s[4:7], s56 offen offset:128 nt lds
    s_waitcnt vmcnt(15)
    s_add_u32 m0, s97, 0x4700
    s_nop 0
    buffer_load_dwordx4 v1, s[4:7], s56 offen offset:256 nt lds
    s_waitcnt vmcnt(15)
    s_add_u32 m0, s97, 0x4a80
    s_nop 0
    buffer_load_dwordx4 v1, s[4:7], s56 offen offset:384 nt lds
    s_waitcnt vmcnt(15)
    s_add_u32 s57, s55, 0xb000
    s_add_u32 m0, s97, 0x6000
    s_nop 0
    buffer_load_dwordx4 v1, s[4:7], s57 offen nt lds
    s_waitcnt vmcnt(15)
    s_add_u32 m0, s97, 0x6380
    s_nop 0
    buffer_load_dwordx4 v1, s[4:7], s57 offen offset:128 nt lds
    s_waitcnt vmcnt(15)
    s_add_u32 m0, s97, 0x6700
    s_nop 0
    buffer_load_dwordx4 v1, s[4:7], s57 offen offset:256 nt lds
    s_waitcnt vmcnt(15)
    s_add_u32 m0, s97, 0x6a80
    s_nop 0
    buffer_load_dwordx4 v1, s[4:7], s57 offen offset:384 nt lds
    s_waitcnt vmcnt(15)
    s_add_u32 m0, s97, 0x1000
    s_nop 0
    buffer_load_dwordx4 v2, s[8:11], s58 offen nt lds
    s_waitcnt vmcnt(15)
    s_add_u32 m0, s97, 0x1300
    s_nop 0
    buffer_load_dwordx4 v2, s[8:11], s58 offen offset:256 nt lds
    s_waitcnt vmcnt(15)
    s_add_u32 m0, s97, 0x1600
    s_nop 0
    buffer_load_dwordx4 v2, s[8:11], s58 offen offset:512 nt lds
    s_waitcnt vmcnt(15)
    s_add_u32 m0, s97, 0x1900
    s_nop 0
    buffer_load_dwordx4 v2, s[8:11], s58 offen offset:768 nt lds
    s_waitcnt vmcnt(15)
    s_add_u32 m0, s97, 0x3000
    s_nop 0
    buffer_load_dwordx4 v2, s[8:11], s59 offen nt lds
    s_waitcnt vmcnt(15)
    s_add_u32 m0, s97, 0x3300
    s_nop 0
    buffer_load_dwordx4 v2, s[8:11], s59 offen offset:256 nt lds
    s_waitcnt vmcnt(15)
    s_add_u32 m0, s97, 0x3600
    s_nop 0
    buffer_load_dwordx4 v2, s[8:11], s59 offen offset:512 nt lds
    s_waitcnt vmcnt(15)
    s_add_u32 m0, s97, 0x3900
    s_nop 0
    buffer_load_dwordx4 v2, s[8:11], s59 offen offset:768 nt lds
    s_waitcnt vmcnt(15)
    s_add_u32 m0, s97, 0x5000
    s_nop 0
    buffer_load_dwordx4 v2, s[8:11], s56 offen nt lds
    s_waitcnt vmcnt(15)
    s_add_u32 m0, s97, 0x5300
    s_nop 0
    buffer_load_dwordx4 v2, s[8:11], s56 offen offset:256 nt lds
    s_waitcnt vmcnt(15)
    s_add_u32 m0, s97, 0x5600
    s_nop 0
    buffer_load_dwordx4 v2, s[8:11], s56 offen offset:512 nt lds
    s_waitcnt vmcnt(15)
    s_add_u32 m0, s97, 0x5900
    s_nop 0
    buffer_load_dwordx4 v2, s[8:11], s56 offen offset:768 nt lds
    s_waitcnt vmcnt(15)
    s_add_u32 m0, s97, 0x7000
    s_nop 0
    buffer_load_dwordx4 v2, s[8:11], s57 offen nt lds
    s_waitcnt vmcnt(15)
    s_add_u32 m0, s97, 0x7300
    s_nop 0
    buffer_load_dwordx4 v2, s[8:11], s57 offen offset:256 nt lds
    s_waitcnt vmcnt(15)
    s_add_u32 m0, s97, 0x7600
    s_nop 0
    buffer_load_dwordx4 v2, s[8:11], s57 offen offset:512 nt lds
    s_waitcnt vmcnt(15)
    s_add_u32 m0, s97, 0x7900
    s_nop 0
    buffer_load_dwordx4 v2, s[8:11], s57 offen offset:768 nt lds
    v_and_b32 v72, 0x7f, v1
    s_lshl_b32 s63, s50, 9
    s_add_u32 s63, s63, 0x6000
L22:
    s_nop 7
    buffer_load_dwordx4 v[32:35], v72, s[12:15], s63 offen sc1
    buffer_load_dwordx4 v[36:39], v72, s[12:15], s63 offen offset:128 sc1
    buffer_load_dwordx4 v[40:43], v72, s[12:15], s63 offen offset:256 sc1
    buffer_load_dwordx4 v[44:47], v72, s[12:15], s63 offen offset:384 sc1
    s_waitcnt vmcnt(0)
    v_max3_u32 v74, v32, v33, v34
    v_max3_u32 v74, v74, v35, v36
    v_max3_u32 v74, v74, v37, v38
    v_max3_u32 v74, v74, v39, v40
    v_max3_u32 v74, v74, v41, v42
    v_max3_u32 v74, v74, v43, v44
    v_max3_u32 v74, v74, v45, v46
    v_max_u32 v74, v74, v47
    v_cmp_eq_u32 vcc, -1, v74
    s_cbranch_vccz L23
    s_sleep 2
    s_sub_u32 s62, s62, 1
    s_cmp_eq_u32 s62, 0
    s_cbranch_scc1 L_end
    s_branch L22
L23:
    s_nop 7
    v_mov_b32 v30, 0
    v_mfma_f32_16x16x32_bf16 v[56:59], a[0:3], v[32:35], 0
    v_mfma_f32_16x16x32_bf16 v[56:59], a[4:7], v[36:39], v[56:59]
    v_mfma_f32_16x16x32_bf16 v[56:59], a[8:11], v[40:43], v[56:59]
    v_mfma_f32_16x16x32_bf16 v[56:59], a[12:15], v[44:47], v[56:59]
    v_mfma_f32_16x16x32_bf16 v[60:63], a[32:35], v[32:35], 0
    v_mfma_f32_16x16x32_bf16 v[60:63], a[36:39], v[36:39], v[60:63]
    v_mfma_f32_16x16x32_bf16 v[60:63], a[40:43], v[40:43], v[60:63]
    v_mfma_f32_16x16x32_bf16 v[60:63], a[44:47], v[44:47], v[60:63]
    s_nop 3
    v_add_f32_dpp v48, v56, v57 quad_perm:[1,0,3,2] row_mask:0xf bank_mask:0xf
    v_add_f32_dpp v49, v58, v59 quad_perm:[1,0,3,2] row_mask:0xf bank_mask:0xf
    v_mfma_f32_16x16x32_bf16 v[56:59], a[64:67], v[32:35], 0
    v_mfma_f32_16x16x32_bf16 v[56:59], a[68:71], v[36:39], v[56:59]
    v_mfma_f32_16x16x32_bf16 v[56:59], a[72:75], v[40:43], v[56:59]
    v_mfma_f32_16x16x32_bf16 v[56:59], a[76:79], v[44:47], v[56:59]
    v_add_f32_dpp v50, v60, v61 quad_perm:[1,0,3,2] row_mask:0xf bank_mask:0xf
    v_add_f32_dpp v51, v62, v63 quad_perm:[1,0,3,2] row_mask:0xf bank_mask:0xf
    v_mfma_f32_16x16x32_bf16 v[60:63], a[96:99], v[32:35], 0
    v_mfma_f32_16x16x32_bf16 v[60:63], a[100:103], v[36:39], v[60:63]
    v_mfma_f32_16x16x32_bf16 v[60:63], a[104:107], v[40:43], v[60:63]
    v_mfma_f32_16x16x32_bf16 v[60:63], a[108:111], v[44:47], v[60:63]
    s_nop 1
    v_add_f32_dpp v52, v56, v57 quad_perm:[1,0,3,2] row_mask:0xf bank_mask:0xf
    v_add_f32_dpp v53, v58, v59 quad_perm:[1,0,3,2] row_mask:0xf bank_mask:0xf
    s_nop 3
    v_add_f32_dpp v54, v60, v61 quad_perm:[1,0,3,2] row_mask:0xf bank_mask:0xf
    v_add_f32_dpp v55, v62, v63 quad_perm:[1,0,3,2] row_mask:0xf bank_mask:0xf
    v_max3_f32 v72, v48, v49, v50
    v_max3_f32 v72, v72, v51, v52
    v_max3_f32 v72, v72, v53, v54
    v_max_f32 v72, v72, v55
    s_nop 1
    v_max_f32_dpp v72, v72, v72 row_bcast:15 row_mask:0xa bank_mask:0xf
    s_nop 1
    v_max_f32_dpp v72, v72, v72 row_bcast:31 row_mask:0xc bank_mask:0xf
    s_nop 0
    v_readlane_b32 s61, v72, 63
    s_nop 1
    v_mul_f32 v31, s61, v9
    v_fma_f32 v48, v48, v8, v31
    v_fma_f32 v49, v49, v8, v31
    v_fma_f32 v50, v50, v8, v31
    v_fma_f32 v51, v51, v8, v31
    v_fma_f32 v52, v52, v8, v31
    v_fma_f32 v53, v53, v8, v31
    v_fma_f32 v54, v54, v8, v31
    v_fma_f32 v55, v55, v8, v31
    v_exp_f32 v48, v48
    v_exp_f32 v49, v49
    v_exp_f32 v50, v50
    v_exp_f32 v51, v51
    v_exp_f32 v52, v52
    v_exp_f32 v53, v53
    v_exp_f32 v54, v54
    v_exp_f32 v55, v55
    v_add_f32 v30, v30, v48
    v_cvt_pk_bf16_f32 v75, v48, v48
    v_and_b32 v64, v75, v4
    v_and_b32 v65, v75, v5
    v_and_b32 v66, v75, v6
    v_and_b32 v67, v75, v7
    s_nop 1
    v_mfma_f32_16x16x32_bf16 v[22:25], a[16:19], v[64:67], 0
    v_mfma_f32_16x16x32_bf16 v[26:29], a[20:23], v[64:67], 0
    v_add_f32 v30, v30, v49
    v_cvt_pk_bf16_f32 v75, v49, v49
    v_and_b32 v68, v75, v4
    v_and_b32 v69, v75, v5
    v_and_b32 v70, v75, v6
    v_and_b32 v71, v75, v7
    s_nop 1
    v_mfma_f32_16x16x32_bf16 v[22:25], a[24:27], v[68:71], v[22:25]
    v_mfma_f32_16x16x32_bf16 v[26:29], a[28:31], v[68:71], v[26:29]
    v_add_f32 v30, v30, v50
    v_cvt_pk_bf16_f32 v75, v50, v50
    v_and_b32 v64, v75, v4
    v_and_b32 v65, v75, v5
    v_and_b32 v66, v75, v6
    v_and_b32 v67, v75, v7
    s_nop 1
    v_mfma_f32_16x16x32_bf16 v[22:25], a[48:51], v[64:67], v[22:25]
    v_mfma_f32_16x16x32_bf16 v[26:29], a[52:55], v[64:67], v[26:29]
    v_add_f32 v30, v30, v51
    v_cvt_pk_bf16_f32 v75, v51, v51
    v_and_b32 v68, v75, v4
    v_and_b32 v69, v75, v5
    v_and_b32 v70, v75, v6
    v_and_b32 v71, v75, v7
    s_nop 1
    v_mfma_f32_16x16x32_bf16 v[22:25], a[56:59], v[68:71], v[22:25]
    v_mfma_f32_16x16x32_bf16 v[26:29], a[60:63], v[68:71], v[26:29]
    v_add_f32 v30, v30, v52
    v_cvt_pk_bf16_f32 v75, v52, v52
    v_and_b32 v64, v75, v4
    v_and_b32 v65, v75, v5
    v_and_b32 v66, v75, v6
    v_and_b32 v67, v75, v7
    s_nop 1
    v_mfma_f32_16x16x32_bf16 v[22:25], a[80:83], v[64:67], v[22:25]
    v_mfma_f32_16x16x32_bf16 v[26:29], a[84:87], v[64:67], v[26:29]
    v_add_f32 v30, v30, v53
    v_cvt_pk_bf16_f32 v75, v53, v53
    v_and_b32 v68, v75, v4
    v_and_b32 v69, v75, v5
    v_and_b32 v70, v75, v6
    v_and_b32 v71, v75, v7
    s_nop 1
    v_mfma_f32_16x16x32_bf16 v[22:25], a[88:91], v[68:71], v[22:25]
    v_mfma_f32_16x16x32_bf16 v[26:29], a[92:95], v[68:71], v[26:29]
    v_add_f32 v30, v30, v54
    v_cvt_pk_bf16_f32 v75, v54, v54
    v_and_b32 v64, v75, v4
    v_and_b32 v65, v75, v5
    v_and_b32 v66, v75, v6
    v_and_b32 v67, v75, v7
    s_nop 1
    v_mfma_f32_16x16x32_bf16 v[22:25], a[112:115], v[64:67], v[22:25]
    v_mfma_f32_16x16x32_bf16 v[26:29], a[116:119], v[64:67], v[26:29]
    v_add_f32 v30, v30, v55
    v_cvt_pk_bf16_f32 v75, v55, v55
    v_and_b32 v68, v75, v4
    v_and_b32 v69, v75, v5
    v_and_b32 v70, v75, v6
    v_and_b32 v71, v75, v7
    s_nop 1
    v_mfma_f32_16x16x32_bf16 v[22:25], a[120:123], v[68:71], v[22:25]
    v_mfma_f32_16x16x32_bf16 v[26:29], a[124:127], v[68:71], v[26:29]
    v_mfma_f32_16x16x32_bf16 v[56:59], a[128:131], v[32:35], 0
    v_mfma_f32_16x16x32_bf16 v[56:59], a[132:135], v[36:39], v[56:59]
    v_mfma_f32_16x16x32_bf16 v[56:59], a[136:139], v[40:43], v[56:59]
    v_mfma_f32_16x16x32_bf16 v[56:59], a[140:143], v[44:47], v[56:59]
    v_mfma_f32_16x16x32_bf16 v[60:63], a[160:163], v[32:35], 0
    v_mfma_f32_16x16x32_bf16 v[60:63], a[164:167], v[36:39], v[60:63]
    v_mfma_f32_16x16x32_bf16 v[60:63], a[168:171], v[40:43], v[60:63]
    v_mfma_f32_16x16x32_bf16 v[60:63], a[172:175], v[44:47], v[60:63]
    s_add_u32 s58, s55, 0xc000
    buffer_load_dwordx4 v[80:83], v1, s[4:7], s58 offen nt
    s_nop 1
    v_add_f32_dpp v48, v56, v57 quad_perm:[1,0,3,2] row_mask:0xf bank_mask:0xf
    v_add_f32_dpp v49, v58, v59 quad_perm:[1,0,3,2] row_mask:0xf bank_mask:0xf
    v_mfma_f32_16x16x32_bf16 v[56:59], a[192:195], v[32:35], 0
    v_mfma_f32_16x16x32_bf16 v[56:59], a[196:199], v[36:39], v[56:59]
    v_mfma_f32_16x16x32_bf16 v[56:59], a[200:203], v[40:43], v[56:59]
    v_mfma_f32_16x16x32_bf16 v[56:59], a[204:207], v[44:47], v[56:59]
    buffer_load_dwordx4 v[84:87], v1, s[4:7], s58 offen offset:128 nt
    v_add_f32_dpp v50, v60, v61 quad_perm:[1,0,3,2] row_mask:0xf bank_mask:0xf
    v_add_f32_dpp v51, v62, v63 quad_perm:[1,0,3,2] row_mask:0xf bank_mask:0xf
    v_mfma_f32_16x16x32_bf16 v[60:63], a[224:227], v[32:35], 0
    v_mfma_f32_16x16x32_bf16 v[60:63], a[228:231], v[36:39], v[60:63]
    v_mfma_f32_16x16x32_bf16 v[60:63], a[232:235], v[40:43], v[60:63]
    v_mfma_f32_16x16x32_bf16 v[60:63], a[236:239], v[44:47], v[60:63]
    s_nop 0
    v_add_f32_dpp v52, v56, v57 quad_perm:[1,0,3,2] row_mask:0xf bank_mask:0xf
    v_add_f32_dpp v53, v58, v59 quad_perm:[1,0,3,2] row_mask:0xf bank_mask:0xf
    s_nop 4
    v_add_f32_dpp v54, v60, v61 quad_perm:[1,0,3,2] row_mask:0xf bank_mask:0xf
    v_add_f32_dpp v55, v62, v63 quad_perm:[1,0,3,2] row_mask:0xf bank_mask:0xf
    v_max3_f32 v72, v48, v49, v50
    v_max3_f32 v72, v72, v51, v52
    v_max3_f32 v72, v72, v53, v54
    v_max_f32 v72, v72, v55
    s_nop 1
    v_max_f32_dpp v72, v72, v72 row_bcast:15 row_mask:0xa bank_mask:0xf
    s_nop 1
    v_max_f32_dpp v72, v72, v72 row_bcast:31 row_mask:0xc bank_mask:0xf
    v_max_f32 v72, s61, v72
    s_nop 0
    v_readlane_b32 s61, v72, 63
    s_nop 1
    v_mul_f32 v73, s61, v9
    v_sub_f32 v74, v73, v31
    v_exp_f32 v74, v74
    v_mov_b32 v31, v73
    v_mul_f32 v30, v30, v74
    v_mul_f32 v22, v22, v74
    v_mul_f32 v23, v23, v74
    v_mul_f32 v24, v24, v74
    v_mul_f32 v25, v25, v74
    v_mul_f32 v26, v26, v74
    v_mul_f32 v27, v27, v74
    v_mul_f32 v28, v28, v74
    v_mul_f32 v29, v29, v74
    v_fma_f32 v48, v48, v8, v31
    v_fma_f32 v49, v49, v8, v31
    v_fma_f32 v50, v50, v8, v31
    v_fma_f32 v51, v51, v8, v31
    v_fma_f32 v52, v52, v8, v31
    v_fma_f32 v53, v53, v8, v31
    v_fma_f32 v54, v54, v8, v31
    v_fma_f32 v55, v55, v8, v31
    v_exp_f32 v48, v48
    v_exp_f32 v49, v49
    v_exp_f32 v50, v50
    v_exp_f32 v51, v51
    v_exp_f32 v52, v52
    v_exp_f32 v53, v53
    v_exp_f32 v54, v54
    v_exp_f32 v55, v55
    v_add_f32 v30, v30, v48
    v_cvt_pk_bf16_f32 v75, v48, v48
    v_and_b32 v64, v75, v4
    v_and_b32 v65, v75, v5
    v_and_b32 v66, v75, v6
    v_and_b32 v67, v75, v7
    s_nop 1
    v_mfma_f32_16x16x32_bf16 v[22:25], a[144:147], v[64:67], v[22:25]
    v_mfma_f32_16x16x32_bf16 v[26:29], a[148:151], v[64:67], v[26:29]
    v_add_f32 v30, v30, v49
    v_cvt_pk_bf16_f32 v75, v49, v49
    v_and_b32 v68, v75, v4
    v_and_b32 v69, v75, v5
    v_and_b32 v70, v75, v6
    v_and_b32 v71, v75, v7
    s_nop 1
    v_mfma_f32_16x16x32_bf16 v[22:25], a[152:155], v[68:71], v[22:25]
    v_mfma_f32_16x16x32_bf16 v[26:29], a[156:159], v[68:71], v[26:29]
    buffer_load_dwordx4 v[88:91], v1, s[4:7], s58 offen offset:256 nt
    v_add_f32 v30, v30, v50
    v_cvt_pk_bf16_f32 v75, v50, v50
    v_and_b32 v64, v75, v4
    v_and_b32 v65, v75, v5
    v_and_b32 v66, v75, v6
    v_and_b32 v67, v75, v7
    s_nop 1
    v_mfma_f32_16x16x32_bf16 v[22:25], a[176:179], v[64:67], v[22:25]
    v_mfma_f32_16x16x32_bf16 v[26:29], a[180:183], v[64:67], v[26:29]
    v_add_f32 v30, v30, v51
    v_cvt_pk_bf16_f32 v75, v51, v51
    v_and_b32 v68, v75, v4
    v_and_b32 v69, v75, v5
    v_and_b32 v70, v75, v6
    v_and_b32 v71, v75, v7
    s_nop 1
    v_mfma_f32_16x16x32_bf16 v[22:25], a[184:187], v[68:71], v[22:25]
    v_mfma_f32_16x16x32_bf16 v[26:29], a[188:191], v[68:71], v[26:29]
    buffer_load_dwordx4 v[92:95], v1, s[4:7], s58 offen offset:384 nt
    v_add_f32 v30, v30, v52
    v_cvt_pk_bf16_f32 v75, v52, v52
    v_and_b32 v64, v75, v4
    v_and_b32 v65, v75, v5
    v_and_b32 v66, v75, v6
    v_and_b32 v67, v75, v7
    s_nop 1
    v_mfma_f32_16x16x32_bf16 v[22:25], a[208:211], v[64:67], v[22:25]
    v_mfma_f32_16x16x32_bf16 v[26:29], a[212:215], v[64:67], v[26:29]
    v_add_f32 v30, v30, v53
    v_cvt_pk_bf16_f32 v75, v53, v53
    v_and_b32 v68, v75, v4
    v_and_b32 v69, v75, v5
    v_and_b32 v70, v75, v6
    v_and_b32 v71, v75, v7
    s_nop 1
    v_mfma_f32_16x16x32_bf16 v[22:25], a[216:219], v[68:71], v[22:25]
    v_mfma_f32_16x16x32_bf16 v[26:29], a[220:223], v[68:71], v[26:29]
    v_add_f32 v30, v30, v54
    v_cvt_pk_bf16_f32 v75, v54, v54
    v_and_b32 v64, v75, v4
    v_and_b32 v65, v75, v5
    v_and_b32 v66, v75, v6
    v_and_b32 v67, v75, v7
    s_nop 1
    v_mfma_f32_16x16x32_bf16 v[22:25], a[240:243], v[64:67], v[22:25]
    v_mfma_f32_16x16x32_bf16 v[26:29], a[244:247], v[64:67], v[26:29]
    v_add_f32 v30, v30, v55
    v_cvt_pk_bf16_f32 v75, v55, v55
    v_and_b32 v68, v75, v4
    v_and_b32 v69, v75, v5
    v_and_b32 v70, v75, v6
    v_and_b32 v71, v75, v7
    s_nop 1
    v_mfma_f32_16x16x32_bf16 v[22:25], a[248:251], v[68:71], v[22:25]
    v_mfma_f32_16x16x32_bf16 v[26:29], a[252:255], v[68:71], v[26:29]
    s_add_u32 s59, s55, 0xd000
    buffer_load_dwordx4 v[112:115], v1, s[4:7], s59 offen nt
    v_mfma_f32_16x16x32_bf16 v[56:59], v[128:131], v[32:35], 0
    v_mfma_f32_16x16x32_bf16 v[56:59], v[132:135], v[36:39], v[56:59]
    v_mfma_f32_16x16x32_bf16 v[56:59], v[136:139], v[40:43], v[56:59]
    v_mfma_f32_16x16x32_bf16 v[56:59], v[140:143], v[44:47], v[56:59]
    buffer_load_dwordx4 v[116:119], v1, s[4:7], s59 offen offset:128 nt
    v_mfma_f32_16x16x32_bf16 v[60:63], v[160:163], v[32:35], 0
    v_mfma_f32_16x16x32_bf16 v[60:63], v[164:167], v[36:39], v[60:63]
    v_mfma_f32_16x16x32_bf16 v[60:63], v[168:171], v[40:43], v[60:63]
    v_mfma_f32_16x16x32_bf16 v[60:63], v[172:175], v[44:47], v[60:63]
    s_nop 2
    v_add_f32_dpp v48, v56, v57 quad_perm:[1,0,3,2] row_mask:0xf bank_mask:0xf
    v_add_f32_dpp v49, v58, v59 quad_perm:[1,0,3,2] row_mask:0xf bank_mask:0xf
    v_mfma_f32_16x16x32_bf16 v[56:59], v[192:195], v[32:35], 0
    v_mfma_f32_16x16x32_bf16 v[56:59], v[196:199], v[36:39], v[56:59]
    v_mfma_f32_16x16x32_bf16 v[56:59], v[200:203], v[40:43], v[56:59]
    v_mfma_f32_16x16x32_bf16 v[56:59], v[204:207], v[44:47], v[56:59]
    buffer_load_dwordx4 v[120:123], v1, s[4:7], s59 offen offset:256 nt
    v_add_f32_dpp v50, v60, v61 quad_perm:[1,0,3,2] row_mask:0xf bank_mask:0xf
    v_add_f32_dpp v51, v62, v63 quad_perm:[1,0,3,2] row_mask:0xf bank_mask:0xf
    v_mfma_f32_16x16x32_bf16 v[60:63], v[224:227], v[32:35], 0
    v_mfma_f32_16x16x32_bf16 v[60:63], v[228:231], v[36:39], v[60:63]
    v_mfma_f32_16x16x32_bf16 v[60:63], v[232:235], v[40:43], v[60:63]
    v_mfma_f32_16x16x32_bf16 v[60:63], v[236:239], v[44:47], v[60:63]
    buffer_load_dwordx4 v[124:127], v1, s[4:7], s59 offen offset:384 nt
    v_add_f32_dpp v52, v56, v57 quad_perm:[1,0,3,2] row_mask:0xf bank_mask:0xf
    v_add_f32_dpp v53, v58, v59 quad_perm:[1,0,3,2] row_mask:0xf bank_mask:0xf
    s_nop 4
    v_add_f32_dpp v54, v60, v61 quad_perm:[1,0,3,2] row_mask:0xf bank_mask:0xf
    v_add_f32_dpp v55, v62, v63 quad_perm:[1,0,3,2] row_mask:0xf bank_mask:0xf
    v_max3_f32 v72, v48, v49, v50
    v_max3_f32 v72, v72, v51, v52
    v_max3_f32 v72, v72, v53, v54
    v_max_f32 v72, v72, v55
    s_nop 1
    v_max_f32_dpp v72, v72, v72 row_bcast:15 row_mask:0xa bank_mask:0xf
    s_nop 1
    v_max_f32_dpp v72, v72, v72 row_bcast:31 row_mask:0xc bank_mask:0xf
    v_max_f32 v72, s61, v72
    s_nop 0
    v_readlane_b32 s61, v72, 63
    s_nop 1
    v_mul_f32 v73, s61, v9
    v_sub_f32 v74, v73, v31
    v_exp_f32 v74, v74
    v_mov_b32 v31, v73
    v_mul_f32 v30, v30, v74
    v_mul_f32 v22, v22, v74
    v_mul_f32 v23, v23, v74
    v_mul_f32 v24, v24, v74
    v_mul_f32 v25, v25, v74
    v_mul_f32 v26, v26, v74
    v_mul_f32 v27, v27, v74
    v_mul_f32 v28, v28, v74
    v_mul_f32 v29, v29, v74
    v_fma_f32 v48, v48, v8, v31
    v_fma_f32 v49, v49, v8, v31
    v_fma_f32 v50, v50, v8, v31
    v_fma_f32 v51, v51, v8, v31
    v_fma_f32 v52, v52, v8, v31
    v_fma_f32 v53, v53, v8, v31
    v_fma_f32 v54, v54, v8, v31
    v_fma_f32 v55, v55, v8, v31
    v_exp_f32 v48, v48
    v_exp_f32 v49, v49
    v_exp_f32 v50, v50
    v_exp_f32 v51, v51
    v_exp_f32 v52, v52
    v_exp_f32 v53, v53
    v_exp_f32 v54, v54
    v_exp_f32 v55, v55
    v_add_f32 v30, v30, v48
    v_cvt_pk_bf16_f32 v75, v48, v48
    v_and_b32 v64, v75, v4
    v_and_b32 v65, v75, v5
    v_and_b32 v66, v75, v6
    v_and_b32 v67, v75, v7
    s_nop 1
    v_mfma_f32_16x16x32_bf16 v[22:25], v[144:147], v[64:67], v[22:25]
    v_mfma_f32_16x16x32_bf16 v[26:29], v[148:151], v[64:67], v[26:29]
    v_add_f32 v30, v30, v49
    v_cvt_pk_bf16_f32 v75, v49, v49
    v_and_b32 v68, v75, v4
    v_and_b32 v69, v75, v5
    v_and_b32 v70, v75, v6
    v_and_b32 v71, v75, v7
    s_nop 1
    v_mfma_f32_16x16x32_bf16 v[22:25], v[152:155], v[68:71], v[22:25]
    v_mfma_f32_16x16x32_bf16 v[26:29], v[156:159], v[68:71], v[26:29]
    v_add_f32 v30, v30, v50
    v_cvt_pk_bf16_f32 v75, v50, v50
    v_and_b32 v64, v75, v4
    v_and_b32 v65, v75, v5
    v_and_b32 v66, v75, v6
    v_and_b32 v67, v75, v7
    s_nop 1
    v_mfma_f32_16x16x32_bf16 v[22:25], v[176:179], v[64:67], v[22:25]
    v_mfma_f32_16x16x32_bf16 v[26:29], v[180:183], v[64:67], v[26:29]
    v_add_f32 v30, v30, v51
    v_cvt_pk_bf16_f32 v75, v51, v51
    v_and_b32 v68, v75, v4
    v_and_b32 v69, v75, v5
    v_and_b32 v70, v75, v6
    v_and_b32 v71, v75, v7
    s_nop 1
    v_mfma_f32_16x16x32_bf16 v[22:25], v[184:187], v[68:71], v[22:25]
    v_mfma_f32_16x16x32_bf16 v[26:29], v[188:191], v[68:71], v[26:29]
    v_add_f32 v30, v30, v52
    v_cvt_pk_bf16_f32 v75, v52, v52
    v_and_b32 v64, v75, v4
    v_and_b32 v65, v75, v5
    v_and_b32 v66, v75, v6
    v_and_b32 v67, v75, v7
    s_nop 1
    v_mfma_f32_16x16x32_bf16 v[22:25], v[208:211], v[64:67], v[22:25]
    v_mfma_f32_16x16x32_bf16 v[26:29], v[212:215], v[64:67], v[26:29]
    v_add_f32 v30, v30, v53
    v_cvt_pk_bf16_f32 v75, v53, v53
    v_and_b32 v68, v75, v4
    v_and_b32 v69, v75, v5
    v_and_b32 v70, v75, v6
    v_and_b32 v71, v75, v7
    s_nop 1
    v_mfma_f32_16x16x32_bf16 v[22:25], v[216:219], v[68:71], v[22:25]
    v_mfma_f32_16x16x32_bf16 v[26:29], v[220:223], v[68:71], v[26:29]
    v_add_f32 v30, v30, v54
    v_cvt_pk_bf16_f32 v75, v54, v54
    v_and_b32 v64, v75, v4
    v_and_b32 v65, v75, v5
    v_and_b32 v66, v75, v6
    v_and_b32 v67, v75, v7
    s_nop 1
    v_mfma_f32_16x16x32_bf16 v[22:25], v[240:243], v[64:67], v[22:25]
    v_mfma_f32_16x16x32_bf16 v[26:29], v[244:247], v[64:67], v[26:29]
    v_add_f32 v30, v30, v55
    v_cvt_pk_bf16_f32 v75, v55, v55
    v_and_b32 v68, v75, v4
    v_and_b32 v69, v75, v5
    v_and_b32 v70, v75, v6
    v_and_b32 v71, v75, v7
    s_nop 1
    v_mfma_f32_16x16x32_bf16 v[22:25], v[248:251], v[68:71], v[22:25]
    v_mfma_f32_16x16x32_bf16 v[26:29], v[252:255], v[68:71], v[26:29]
    ds_read_b128 v[96:99], v3
    ds_read_b128 v[100:103], v3 offset:1024
    ds_read_b128 v[104:107], v3 offset:2048
    ds_read_b128 v[108:111], v3 offset:3072
    s_waitcnt lgkmcnt(3)
    v_mfma_f32_16x16x32_bf16 v[56:59], v[96:99], v[32:35], 0
    s_waitcnt lgkmcnt(2)
    v_mfma_f32_16x16x32_bf16 v[56:59], v[100:103], v[36:39], v[56:59]
    s_waitcnt lgkmcnt(1)
    v_mfma_f32_16x16x32_bf16 v[56:59], v[104:107], v[40:43], v[56:59]
    s_waitcnt lgkmcnt(0)
    v_mfma_f32_16x16x32_bf16 v[56:59], v[108:111], v[44:47], v[56:59]
    ds_read_b128 v[96:99], v3 offset:8192
    ds_read_b128 v[100:103], v3 offset:9216
    ds_read_b128 v[104:107], v3 offset:10240
    ds_read_b128 v[108:111], v3 offset:11264
    s_waitcnt lgkmcnt(3)
    v_mfma_f32_16x16x32_bf16 v[60:63], v[96:99], v[32:35], 0
    s_waitcnt lgkmcnt(2)
    v_mfma_f32_16x16x32_bf16 v[60:63], v[100:103], v[36:39], v[60:63]
    s_waitcnt lgkmcnt(1)
    v_mfma_f32_16x16x32_bf16 v[60:63], v[104:107], v[40:43], v[60:63]
    s_waitcnt lgkmcnt(0)
    v_mfma_f32_16x16x32_bf16 v[60:63], v[108:111], v[44:47], v[60:63]
    v_add_f32_dpp v48, v56, v57 quad_perm:[1,0,3,2] row_mask:0xf bank_mask:0xf
    v_add_f32_dpp v49, v58, v59 quad_perm:[1,0,3,2] row_mask:0xf bank_mask:0xf
    ds_read_b128 v[96:99], v3 offset:16384
    ds_read_b128 v[100:103], v3 offset:17408
    ds_read_b128 v[104:107], v3 offset:18432
    ds_read_b128 v[108:111], v3 offset:19456
    s_waitcnt lgkmcnt(3)
    v_mfma_f32_16x16x32_bf16 v[56:59], v[96:99], v[32:35], 0
    s_waitcnt lgkmcnt(2)
    v_mfma_f32_16x16x32_bf16 v[56:59], v[100:103], v[36:39], v[56:59]
    s_waitcnt lgkmcnt(1)
    v_mfma_f32_16x16x32_bf16 v[56:59], v[104:107], v[40:43], v[56:59]
    s_waitcnt lgkmcnt(0)
    v_mfma_f32_16x16x32_bf16 v[56:59], v[108:111], v[44:47], v[56:59]
    v_add_f32_dpp v50, v60, v61 quad_perm:[1,0,3,2] row_mask:0xf bank_mask:0xf
    v_add_f32_dpp v51, v62, v63 quad_perm:[1,0,3,2] row_mask:0xf bank_mask:0xf
    ds_read_b128 v[96:99], v3 offset:24576
    ds_read_b128 v[100:103], v3 offset:25600
    ds_read_b128 v[104:107], v3 offset:26624
    ds_read_b128 v[108:111], v3 offset:27648
    s_waitcnt lgkmcnt(3)
    v_mfma_f32_16x16x32_bf16 v[60:63], v[96:99], v[32:35], 0
    s_waitcnt lgkmcnt(2)
    v_mfma_f32_16x16x32_bf16 v[60:63], v[100:103], v[36:39], v[60:63]
    s_waitcnt lgkmcnt(1)
    v_mfma_f32_16x16x32_bf16 v[60:63], v[104:107], v[40:43], v[60:63]
    s_waitcnt lgkmcnt(0)
    v_mfma_f32_16x16x32_bf16 v[60:63], v[108:111], v[44:47], v[60:63]
    v_add_f32_dpp v52, v56, v57 quad_perm:[1,0,3,2] row_mask:0xf bank_mask:0xf
    v_add_f32_dpp v53, v58, v59 quad_perm:[1,0,3,2] row_mask:0xf bank_mask:0xf
    s_nop 5
    v_add_f32_dpp v54, v60, v61 quad_perm:[1,0,3,2] row_mask:0xf bank_mask:0xf
    v_add_f32_dpp v55, v62, v63 quad_perm:[1,0,3,2] row_mask:0xf bank_mask:0xf
    v_max3_f32 v72, v48, v49, v50
    v_max3_f32 v72, v72, v51, v52
    v_max3_f32 v72, v72, v53, v54
    v_max_f32 v72, v72, v55
    s_nop 1
    v_max_f32_dpp v72, v72, v72 row_bcast:15 row_mask:0xa bank_mask:0xf
    s_nop 1
    v_max_f32_dpp v72, v72, v72 row_bcast:31 row_mask:0xc bank_mask:0xf
    v_max_f32 v72, s61, v72
    s_nop 0
    v_readlane_b32 s61, v72, 63
    s_nop 1
    v_mul_f32 v73, s61, v9
    v_sub_f32 v74, v73, v31
    v_exp_f32 v74, v74
    v_mov_b32 v31, v73
    v_mul_f32 v30, v30, v74
    v_mul_f32 v22, v22, v74
    v_mul_f32 v23, v23, v74
    v_mul_f32 v24, v24, v74
    v_mul_f32 v25, v25, v74
    v_mul_f32 v26, v26, v74
    v_mul_f32 v27, v27, v74
    v_mul_f32 v28, v28, v74
    v_mul_f32 v29, v29, v74
    v_fma_f32 v48, v48, v8, v31
    v_fma_f32 v49, v49, v8, v31
    v_fma_f32 v50, v50, v8, v31
    v_fma_f32 v51, v51, v8, v31
    v_fma_f32 v52, v52, v8, v31
    v_fma_f32 v53, v53, v8, v31
    v_fma_f32 v54, v54, v8, v31
    v_fma_f32 v55, v55, v8, v31
    v_exp_f32 v48, v48
    v_exp_f32 v49, v49
    v_exp_f32 v50, v50
    v_exp_f32 v51, v51
    v_exp_f32 v52, v52
    v_exp_f32 v53, v53
    v_exp_f32 v54, v54
    v_exp_f32 v55, v55
    ds_read_b128 v[96:99], v3 offset:4096
    ds_read_b128 v[100:103], v3 offset:5120
    ds_read_b128 v[104:107], v3 offset:6144
    ds_read_b128 v[108:111], v3 offset:7168
    v_add_f32 v30, v30, v48
    v_cvt_pk_bf16_f32 v75, v48, v48
    v_and_b32 v64, v75, v4
    v_and_b32 v65, v75, v5
    v_and_b32 v66, v75, v6
    v_and_b32 v67, v75, v7
    s_waitcnt lgkmcnt(3)
    s_nop 0
    v_mfma_f32_16x16x32_bf16 v[22:25], v[96:99], v[64:67], v[22:25]
    s_waitcnt lgkmcnt(2)
    v_mfma_f32_16x16x32_bf16 v[26:29], v[100:103], v[64:67], v[26:29]
    v_add_f32 v30, v30, v49
    v_cvt_pk_bf16_f32 v75, v49, v49
    v_and_b32 v68, v75, v4
    v_and_b32 v69, v75, v5
    v_and_b32 v70, v75, v6
    v_and_b32 v71, v75, v7
    s_waitcnt lgkmcnt(1)
    s_nop 0
    v_mfma_f32_16x16x32_bf16 v[22:25], v[104:107], v[68:71], v[22:25]
    s_waitcnt lgkmcnt(0)
    v_mfma_f32_16x16x32_bf16 v[26:29], v[108:111], v[68:71], v[26:29]
    ds_read_b128 v[96:99], v3 offset:12288
    ds_read_b128 v[100:103], v3 offset:13312
    ds_read_b128 v[104:107], v3 offset:14336
    ds_read_b128 v[108:111], v3 offset:15360
    v_add_f32 v30, v30, v50
    v_cvt_pk_bf16_f32 v75, v50, v50
    v_and_b32 v64, v75, v4
    v_and_b32 v65, v75, v5
    v_and_b32 v66, v75, v6
    v_and_b32 v67, v75, v7
    s_waitcnt lgkmcnt(3)
    s_nop 0
    v_mfma_f32_16x16x32_bf16 v[22:25], v[96:99], v[64:67], v[22:25]
    s_waitcnt lgkmcnt(2)
    v_mfma_f32_16x16x32_bf16 v[26:29], v[100:103], v[64:67], v[26:29]
    v_add_f32 v30, v30, v51
    v_cvt_pk_bf16_f32 v75, v51, v51
    v_and_b32 v68, v75, v4
    v_and_b32 v69, v75, v5
    v_and_b32 v70, v75, v6
    v_and_b32 v71, v75, v7
    s_waitcnt lgkmcnt(1)
    s_nop 0
    v_mfma_f32_16x16x32_bf16 v[22:25], v[104:107], v[68:71], v[22:25]
    s_waitcnt lgkmcnt(0)
    v_mfma_f32_16x16x32_bf16 v[26:29], v[108:111], v[68:71], v[26:29]
    ds_read_b128 v[96:99], v3 offset:20480
    ds_read_b128 v[100:103], v3 offset:21504
    ds_read_b128 v[104:107], v3 offset:22528
    ds_read_b128 v[108:111], v3 offset:23552
    v_add_f32 v30, v30, v52
    v_cvt_pk_bf16_f32 v75, v52, v52
    v_and_b32 v64, v75, v4
    v_and_b32 v65, v75, v5
    v_and_b32 v66, v75, v6
    v_and_b32 v67, v75, v7
    s_waitcnt lgkmcnt(3)
    s_nop 0
    v_mfma_f32_16x16x32_bf16 v[22:25], v[96:99], v[64:67], v[22:25]
    s_waitcnt lgkmcnt(2)
    v_mfma_f32_16x16x32_bf16 v[26:29], v[100:103], v[64:67], v[26:29]
    v_add_f32 v30, v30, v53
    v_cvt_pk_bf16_f32 v75, v53, v53
    v_and_b32 v68, v75, v4
    v_and_b32 v69, v75, v5
    v_and_b32 v70, v75, v6
    v_and_b32 v71, v75, v7
    s_waitcnt lgkmcnt(1)
    s_nop 0
    v_mfma_f32_16x16x32_bf16 v[22:25], v[104:107], v[68:71], v[22:25]
    s_waitcnt lgkmcnt(0)
    v_mfma_f32_16x16x32_bf16 v[26:29], v[108:111], v[68:71], v[26:29]
    ds_read_b128 v[96:99], v3 offset:28672
    ds_read_b128 v[100:103], v3 offset:29696
    ds_read_b128 v[104:107], v3 offset:30720
    ds_read_b128 v[108:111], v3 offset:31744
    v_add_f32 v30, v30, v54
    v_cvt_pk_bf16_f32 v75, v54, v54
    v_and_b32 v64, v75, v4
    v_and_b32 v65, v75, v5
    v_and_b32 v66, v75, v6
    v_and_b32 v67, v75, v7
    s_waitcnt lgkmcnt(3)
    s_nop 0
    v_mfma_f32_16x16x32_bf16 v[22:25], v[96:99], v[64:67], v[22:25]
    s_waitcnt lgkmcnt(2)
    v_mfma_f32_16x16x32_bf16 v[26:29], v[100:103], v[64:67], v[26:29]
    v_add_f32 v30, v30, v55
    v_cvt_pk_bf16_f32 v75, v55, v55
    v_and_b32 v68, v75, v4
    v_and_b32 v69, v75, v5
    v_and_b32 v70, v75, v6
    v_and_b32 v71, v75, v7
    s_waitcnt lgkmcnt(1)
    s_nop 0
    v_mfma_f32_16x16x32_bf16 v[22:25], v[104:107], v[68:71], v[22:25]
    s_waitcnt lgkmcnt(0)
    v_mfma_f32_16x16x32_bf16 v[26:29], v[108:111], v[68:71], v[26:29]
    s_waitcnt vmcnt(7)
    v_mfma_f32_16x16x32_bf16 v[56:59], v[80:83], v[32:35], 0
    s_waitcnt vmcnt(6)
    v_mfma_f32_16x16x32_bf16 v[56:59], v[84:87], v[36:39], v[56:59]
    s_waitcnt vmcnt(5)
    v_mfma_f32_16x16x32_bf16 v[56:59], v[88:91], v[40:43], v[56:59]
    s_waitcnt vmcnt(4)
    v_mfma_f32_16x16x32_bf16 v[56:59], v[92:95], v[44:47], v[56:59]
    buffer_load_dwordx4 v[96:99], v2, s[8:11], s58 offen nt
    buffer_load_dwordx4 v[100:103], v2, s[8:11], s58 offen offset:256 nt
    buffer_load_dwordx4 v[104:107], v2, s[8:11], s58 offen offset:512 nt
    buffer_load_dwordx4 v[108:111], v2, s[8:11], s58 offen offset:768 nt
    s_waitcnt vmcnt(7)
    v_mfma_f32_16x16x32_bf16 v[60:63], v[112:115], v[32:35], 0
    s_waitcnt vmcnt(6)
    v_mfma_f32_16x16x32_bf16 v[60:63], v[116:119], v[36:39], v[60:63]
    s_waitcnt vmcnt(5)
    v_mfma_f32_16x16x32_bf16 v[60:63], v[120:123], v[40:43], v[60:63]
    s_waitcnt vmcnt(4)
    v_mfma_f32_16x16x32_bf16 v[60:63], v[124:127], v[44:47], v[60:63]
    buffer_load_dwordx4 v[80:83], v2, s[8:11], s59 offen nt
    buffer_load_dwordx4 v[84:87], v2, s[8:11], s59 offen offset:256 nt
    buffer_load_dwordx4 v[88:91], v2, s[8:11], s59 offen offset:512 nt
    buffer_load_dwordx4 v[92:95], v2, s[8:11], s59 offen offset:768 nt
    v_add_f32_dpp v48, v56, v57 quad_perm:[1,0,3,2] row_mask:0xf bank_mask:0xf
    v_add_f32_dpp v49, v58, v59 quad_perm:[1,0,3,2] row_mask:0xf bank_mask:0xf
    s_nop 1
    v_add_f32_dpp v50, v60, v61 quad_perm:[1,0,3,2] row_mask:0xf bank_mask:0xf
    v_add_f32_dpp v51, v62, v63 quad_perm:[1,0,3,2] row_mask:0xf bank_mask:0xf
    v_max3_f32 v72, v48, v49, v50
    v_max_f32 v72, v72, v51
    s_nop 1
    v_max_f32_dpp v72, v72, v72 row_bcast:15 row_mask:0xa bank_mask:0xf
    s_nop 1
    v_max_f32_dpp v72, v72, v72 row_bcast:31 row_mask:0xc bank_mask:0xf
    v_max_f32 v72, s61, v72
    s_nop 0
    v_readlane_b32 s61, v72, 63
    s_nop 1
    v_mul_f32 v73, s61, v9
    v_sub_f32 v74, v73, v31
    v_exp_f32 v74, v74
    v_mov_b32 v31, v73
    v_mul_f32 v30, v30, v74
    v_mul_f32 v22, v22, v74
    v_mul_f32 v23, v23, v74
    v_mul_f32 v24, v24, v74
    v_mul_f32 v25, v25, v74
    v_mul_f32 v26, v26, v74
    v_mul_f32 v27, v27, v74
    v_mul_f32 v28, v28, v74
    v_mul_f32 v29, v29, v74
    v_fma_f32 v48, v48, v8, v31
    v_fma_f32 v49, v49, v8, v31
    v_fma_f32 v50, v50, v8, v31
    v_fma_f32 v51, v51, v8, v31
    v_exp_f32 v48, v48
    v_exp_f32 v49, v49
    v_exp_f32 v50, v50
    v_exp_f32 v51, v51
    v_add_f32 v30, v30, v48
    v_cvt_pk_bf16_f32 v75, v48, v48
    v_and_b32 v64, v75, v4
    v_and_b32 v65, v75, v5
    v_and_b32 v66, v75, v6
    v_and_b32 v67, v75, v7
    s_waitcnt vmcnt(7)
    s_nop 0
    v_mfma_f32_16x16x32_bf16 v[22:25], v[96:99], v[64:67], v[22:25]
    s_waitcnt vmcnt(6)
    v_mfma_f32_16x16x32_bf16 v[26:29], v[100:103], v[64:67], v[26:29]
    v_add_f32 v30, v30, v49
    v_cvt_pk_bf16_f32 v75, v49, v49
    v_and_b32 v68, v75, v4
    v_and_b32 v69, v75, v5
    v_and_b32 v70, v75, v6
    v_and_b32 v71, v75, v7
    s_waitcnt vmcnt(5)
    s_nop 0
    v_mfma_f32_16x16x32_bf16 v[22:25], v[104:107], v[68:71], v[22:25]
    s_waitcnt vmcnt(4)
    v_mfma_f32_16x16x32_bf16 v[26:29], v[108:111], v[68:71], v[26:29]
    buffer_load_dwordx4 v[112:115], v1, s[4:7], s21 offen nt
    buffer_load_dwordx4 v[116:119], v1, s[4:7], s21 offen offset:128 nt
    buffer_load_dwordx4 v[120:123], v1, s[4:7], s21 offen offset:256 nt
    buffer_load_dwordx4 v[124:127], v1, s[4:7], s21 offen offset:384 nt
    v_add_f32 v30, v30, v50
    v_cvt_pk_bf16_f32 v75, v50, v50
    v_and_b32 v64, v75, v4
    v_and_b32 v65, v75, v5
    v_and_b32 v66, v75, v6
    v_and_b32 v67, v75, v7
    s_waitcnt vmcnt(7)
    s_nop 0
    v_mfma_f32_16x16x32_bf16 v[22:25], v[80:83], v[64:67], v[22:25]
    s_waitcnt vmcnt(6)
    v_mfma_f32_16x16x32_bf16 v[26:29], v[84:87], v[64:67], v[26:29]
    v_add_f32 v30, v30, v51
    v_cvt_pk_bf16_f32 v75, v51, v51
    v_and_b32 v68, v75, v4
    v_and_b32 v69, v75, v5
    v_and_b32 v70, v75, v6
    v_and_b32 v71, v75, v7
    s_waitcnt vmcnt(5)
    s_nop 0
    v_mfma_f32_16x16x32_bf16 v[22:25], v[88:91], v[68:71], v[22:25]
    s_waitcnt vmcnt(4)
    v_mfma_f32_16x16x32_bf16 v[26:29], v[92:95], v[68:71], v[26:29]
    buffer_load_dwordx4 v[96:99], v2, s[8:11], s21 offen nt
    buffer_load_dwordx4 v[100:103], v2, s[8:11], s21 offen offset:256 nt
    buffer_load_dwordx4 v[104:107], v2, s[8:11], s21 offen offset:512 nt
    buffer_load_dwordx4 v[108:111], v2, s[8:11], s21 offen offset:768 nt
    s_waitcnt vmcnt(7)
    v_mfma_f32_16x16x32_bf16 v[56:59], v[112:115], v[32:35], 0
    s_waitcnt vmcnt(6)
    v_mfma_f32_16x16x32_bf16 v[56:59], v[116:119], v[36:39], v[56:59]
    s_waitcnt vmcnt(5)
    v_mfma_f32_16x16x32_bf16 v[56:59], v[120:123], v[40:43], v[56:59]
    s_waitcnt vmcnt(4)
    v_mfma_f32_16x16x32_bf16 v[56:59], v[124:127], v[44:47], v[56:59]
    s_nop 7
    v_add_f32_dpp v48, v56, v57 quad_perm:[1,0,3,2] row_mask:0xf bank_mask:0xf
    v_add_f32 v48, s22, v48
    v_add_f32_dpp v49, v58, v59 quad_perm:[1,0,3,2] row_mask:0xf bank_mask:0xf
    v_add_f32 v49, s22, v49
    v_max_f32 v72, v48, v49
    s_nop 1
    v_max_f32_dpp v72, v72, v72 row_bcast:15 row_mask:0xa bank_mask:0xf
    s_nop 1
    v_max_f32_dpp v72, v72, v72 row_bcast:31 row_mask:0xc bank_mask:0xf
    v_max_f32 v72, s61, v72
    s_nop 0
    v_readlane_b32 s61, v72, 63
    s_nop 1
    v_mul_f32 v73, s61, v9
    v_sub_f32 v74, v73, v31
    v_exp_f32 v74, v74
    v_mov_b32 v31, v73
    v_mul_f32 v30, v30, v74
    v_mul_f32 v22, v22, v74
    v_mul_f32 v23, v23, v74
    v_mul_f32 v24, v24, v74
    v_mul_f32 v25, v25, v74
    v_mul_f32 v26, v26, v74
    v_mul_f32 v27, v27, v74
    v_mul_f32 v28, v28, v74
    v_mul_f32 v29, v29, v74
    v_fma_f32 v48, v48, v8, v31
    v_fma_f32 v49, v49, v8, v31
    v_exp_f32 v48, v48
    v_exp_f32 v49, v49
    v_add_f32 v30, v30, v48
    v_cvt_pk_bf16_f32 v75, v48, v48
    v_and_b32 v64, v75, v4
    v_and_b32 v65, v75, v5
    v_and_b32 v66, v75, v6
    v_and_b32 v67, v75, v7
    s_waitcnt vmcnt(3)
    s_nop 0
    v_mfma_f32_16x16x32_bf16 v[22:25], v[96:99], v[64:67], v[22:25]
    s_waitcnt vmcnt(2)
    v_mfma_f32_16x16x32_bf16 v[26:29], v[100:103], v[64:67], v[26:29]
    v_add_f32 v30, v30, v49
    v_cvt_pk_bf16_f32 v75, v49, v49
    v_and_b32 v68, v75, v4
    v_and_b32 v69, v75, v5
    v_and_b32 v70, v75, v6
    v_and_b32 v71, v75, v7
    s_waitcnt vmcnt(1)
    s_nop 0
    v_mfma_f32_16x16x32_bf16 v[22:25], v[104:107], v[68:71], v[22:25]
    s_waitcnt vmcnt(0)
    v_mfma_f32_16x16x32_bf16 v[26:29], v[108:111], v[68:71], v[26:29]
    v_add_f32_dpp v30, v30, v30 row_bcast:15 row_mask:0xa bank_mask:0xf
    s_nop 1
    v_add_f32_dpp v30, v30, v30 row_bcast:31 row_mask:0xc bank_mask:0xf
    s_nop 0
    v_readlane_b32 s63, v30, 63
    s_mov_b64 exec, s[64:65]
    ds_write_b32 v11, v22 offset:4160
    ds_write_b32 v11, v23 offset:4192
    ds_write_b32 v11, v24 offset:4224
    ds_write_b32 v11, v25 offset:4256
    ds_write_b32 v11, v26 offset:4672
    ds_write_b32 v11, v27 offset:4704
    ds_write_b32 v11, v28 offset:4736
    ds_write_b32 v11, v29 offset:4768
    s_mov_b64 exec, -1
    v_mov_b32 v72, s61
    v_mov_b32 v73, s63
    ds_write_b64 v10, v[72:73] offset:5184
    s_waitcnt lgkmcnt(0)
    s_mov_b64 exec, 1
    v_mov_b32 v72, 1
    v_mov_b32 v73, 0x2208c
    ds_add_rtn_u32 v74, v73, v72
    s_mov_b64 exec, -1
    s_waitcnt lgkmcnt(0)
    v_readfirstlane_b32 s63, v74
    s_cmp_lg_u32 s63, 3
    s_cbranch_scc1 L24
    v_lshlrev_b32 v77, 4, v0
    v_add_u32 v77, 0x20000, v77
    v_mov_b32 v76, 0x20000
    ds_read_b128 v[48:51], v77 offset:4160
    ds_read_b64 v[64:65], v76 offset:5184
    ds_read_b128 v[52:55], v77 offset:5200
    ds_read_b64 v[66:67], v76 offset:6224
    ds_read_b128 v[56:59], v77 offset:6240
    ds_read_b64 v[68:69], v76 offset:7264
    ds_read_b128 v[60:63], v77 offset:7280
    ds_read_b64 v[70:71], v76 offset:8304
    s_waitcnt lgkmcnt(0)
    v_max3_f32 v72, v64, v66, v68
    v_max_f32 v72, v72, v70
    v_sub_f32 v64, v64, v72
    v_mul_f32 v64, v64, v8
    v_exp_f32 v64, v64
    v_sub_f32 v66, v66, v72
    v_mul_f32 v66, v66, v8
    v_exp_f32 v66, v66
    v_sub_f32 v68, v68, v72
    v_mul_f32 v68, v68, v8
    v_exp_f32 v68, v68
    v_sub_f32 v70, v70, v72
    v_mul_f32 v70, v70, v8
    v_exp_f32 v70, v70
    v_mul_f32 v73, v64, v65
    v_fmac_f32 v73, v66, v67
    v_fmac_f32 v73, v68, v69
    v_fmac_f32 v73, v70, v71
    v_mul_f32 v48, v48, v64
    v_fmac_f32 v48, v52, v66
    v_fmac_f32 v48, v56, v68
    v_fmac_f32 v48, v60, v70
    v_mul_f32 v49, v49, v64
    v_fmac_f32 v49, v53, v66
    v_fmac_f32 v49, v57, v68
    v_fmac_f32 v49, v61, v70
    v_mul_f32 v50, v50, v64
    v_fmac_f32 v50, v54, v66
    v_fmac_f32 v50, v58, v68
    v_fmac_f32 v50, v62, v70
    v_mul_f32 v51, v51, v64
    v_fmac_f32 v51, v55, v66
    v_fmac_f32 v51, v59, v68
    v_fmac_f32 v51, v63, v70
    v_cvt_pk_bf16_f32 v74, v48, v49
    v_cvt_pk_bf16_f32 v75, v50, v51
    v_lshlrev_b32 v76, 3, v0
    s_lshl_b32 s63, s23, 9
    s_add_u32 s63, s63, 0x70000
    s_cmp_eq_u32 s3, 1
    s_cbranch_scc1 L25
    buffer_store_dwordx2 v[74:75], v76, s[12:15], s63 offen sc1
    s_branch L26
L25:
    s_nop 7
    buffer_store_dwordx2 v[74:75], v76, s[12:15], s63 offen
L26:
    s_nop 7
    s_lshl_b32 s63, s23, 3
    s_add_u32 s63, s63, 0x9800
    s_mov_b64 exec, 1
    s_cmp_eq_u32 s3, 1
    s_cbranch_scc1 L27
    buffer_store_dwordx2 v[72:73], v76, s[12:15], s63 offen sc1
    s_branch L28
L27:
    s_nop 7
    buffer_store_dwordx2 v[72:73], v76, s[12:15], s63 offen
L28:
    s_nop 7
    s_mov_b64 exec, -1
L24:
    s_nop 7
    s_branch L_end
L_chain:
    s_nop 7
    s_mov_b32 s20, s72
    s_and_b32 s21, s73, 0xffff
    s_mov_b32 s22, 0x700
    s_mov_b32 s23, 0x20000
    s_mov_b32 s24, s78
    s_and_b32 s25, s79, 0xffff
    s_mov_b32 s26, 0x380000
    s_mov_b32 s27, 0x20000
    s_mov_b32 s28, s80
    s_and_b32 s29, s81, 0xffff
    s_mov_b32 s30, 0x380000
    s_mov_b32 s31, 0x20000
    s_mov_b32 s32, s84
    s_and_b32 s33, s85, 0xffff
    s_mov_b32 s34, 0x188000
    s_mov_b32 s35, 0x20000
    s_mov_b32 s36, s86
    s_and_b32 s37, s87, 0xffff
    s_mov_b32 s38, 0x188000
    s_mov_b32 s39, 0x20000
    s_mov_b32 s40, s88
    s_and_b32 s41, s89, 0xffff
    s_mov_b32 s42, 0x188000
    s_mov_b32 s43, 0x20000
    s_mov_b32 s44, s90
    s_and_b32 s45, s91, 0xffff
    s_mov_b32 s46, 0x700
    s_mov_b32 s47, 0x20000
    s_sub_u32 s51, s49, 28
    s_lshl_b32 s53, s51, 2
    s_add_u32 s53, s53, s52
    s_lshr_b32 s63, s53, 3
    s_lshl_b32 s50, s48, 1
    s_add_u32 s50, s50, s63
    v_lshlrev_b32 v3, 4, v0
    v_lshlrev_b32 v1, 3, v0
    v_and_b32 v6, 15, v0
    v_lshrrev_b32 v7, 4, v0
    v_lshlrev_b32 v2, 4, v7
    v_cmp_gt_u32 s[66:67], 48, v0
    v_lshrrev_b32 v75, 2, v6
    v_lshl_add_u32 v75, v7, 3, v75
    v_lshlrev_b32 v75, 8, v75
    v_and_b32 v76, 3, v6
    s_lshl_b32 s63, s52, 6
    v_lshl_add_u32 v4, v76, 3, v75
    v_add_u32 v4, s63, v4
    v_and_b32 v77, 1, v76
    v_lshrrev_b32 v78, 1, v76
    v_lshl_add_u32 v5, v77, 7, v75
    v_lshl_add_u32 v5, v78, 3, v5
    s_lshl_b32 s63, s52, 5
    v_add_u32 v5, s63, v5
    buffer_load_dwordx2 v[80:81], v1, s[20:23], 0 offen
    buffer_load_dwordx2 v[82:83], v1, s[20:23], 0 offen offset:512
    buffer_load_dwordx2 v[84:85], v1, s[20:23], 0 offen offset:896
    buffer_load_dwordx2 v[86:87], v1, s[20:23], 0 offen offset:1408
    v_lshlrev_b32 v10, 13, v7
    v_lshl_add_u32 v10, v6, 4, v10
    s_lshl_b32 s71, s48, 10
    s_lshl_b32 s96, s51, 8
    s_add_u32 s54, s71, s96
    s_mul_i32 s63, s52, 0xe0000
    s_add_u32 s63, s63, s54
    s_mul_i32 s70, s52, 0x7000
    s_add_u32 s56, s63, 0
    s_add_u32 m0, s70, 0
    s_nop 0
    buffer_load_dwordx4 v10, s[24:27], s56 offen lds
    s_add_u32 s57, s63, 0x8000
    s_add_u32 m0, s70, 0x400
    s_nop 0
    buffer_load_dwordx4 v10, s[24:27], s57 offen lds
    s_add_u32 s58, s63, 0x10000
    s_add_u32 m0, s70, 0x800
    s_nop 0
    buffer_load_dwordx4 v10, s[24:27], s58 offen lds
    s_add_u32 s59, s63, 0x18000
    s_add_u32 m0, s70, 0xc00
    s_nop 0
    buffer_load_dwordx4 v10, s[24:27], s59 offen lds
    s_add_u32 s56, s63, 0x20000
    s_add_u32 m0, s70, 0x1000
    s_nop 0
    buffer_load_dwordx4 v10, s[24:27], s56 offen lds
    s_add_u32 s57, s63, 0x28000
    s_add_u32 m0, s70, 0x1400
    s_nop 0
    buffer_load_dwordx4 v10, s[24:27], s57 offen lds
    s_add_u32 s58, s63, 0x30000
    s_add_u32 m0, s70, 0x1800
    s_nop 0
    buffer_load_dwordx4 v10, s[24:27], s58 offen lds
    s_add_u32 s59, s63, 0x38000
    s_add_u32 m0, s70, 0x1c00
    s_nop 0
    buffer_load_dwordx4 v10, s[24:27], s59 offen lds
    s_add_u32 s56, s63, 0x40000
    s_add_u32 m0, s70, 0x2000
    s_nop 0
    buffer_load_dwordx4 v10, s[24:27], s56 offen lds
    s_add_u32 s57, s63, 0x48000
    s_add_u32 m0, s70, 0x2400
    s_nop 0
    buffer_load_dwordx4 v10, s[24:27], s57 offen lds
    s_add_u32 s58, s63, 0x50000
    s_add_u32 m0, s70, 0x2800
    s_nop 0
    buffer_load_dwordx4 v10, s[24:27], s58 offen lds
    s_add_u32 s59, s63, 0x58000
    s_add_u32 m0, s70, 0x2c00
    s_nop 0
    buffer_load_dwordx4 v10, s[24:27], s59 offen lds
    s_add_u32 s56, s63, 0x60000
    s_add_u32 m0, s70, 0x3000
    s_nop 0
    buffer_load_dwordx4 v10, s[24:27], s56 offen lds
    s_add_u32 s57, s63, 0x68000
    s_add_u32 m0, s70, 0x3400
    s_nop 0
    buffer_load_dwordx4 v10, s[24:27], s57 offen lds
    s_add_u32 s58, s63, 0x70000
    s_add_u32 m0, s70, 0x3800
    s_nop 0
    buffer_load_dwordx4 v10, s[24:27], s58 offen lds
    s_add_u32 s59, s63, 0x78000
    s_add_u32 m0, s70, 0x3c00
    s_nop 0
    buffer_load_dwordx4 v10, s[24:27], s59 offen lds
    s_add_u32 s56, s63, 0x80000
    s_add_u32 m0, s70, 0x4000
    s_nop 0
    buffer_load_dwordx4 v10, s[24:27], s56 offen lds
    s_add_u32 s57, s63, 0x88000
    s_add_u32 m0, s70, 0x4400
    s_nop 0
    buffer_load_dwordx4 v10, s[24:27], s57 offen lds
    s_add_u32 s58, s63, 0x90000
    s_add_u32 m0, s70, 0x4800
    s_nop 0
    buffer_load_dwordx4 v10, s[24:27], s58 offen lds
    s_add_u32 s59, s63, 0x98000
    s_add_u32 m0, s70, 0x4c00
    s_nop 0
    buffer_load_dwordx4 v10, s[24:27], s59 offen lds
    s_add_u32 s56, s63, 0xa0000
    s_add_u32 m0, s70, 0x5000
    s_nop 0
    buffer_load_dwordx4 v10, s[24:27], s56 offen lds
    s_add_u32 s57, s63, 0xa8000
    s_add_u32 m0, s70, 0x5400
    s_nop 0
    buffer_load_dwordx4 v10, s[24:27], s57 offen lds
    s_add_u32 s58, s63, 0xb0000
    s_add_u32 m0, s70, 0x5800
    s_nop 0
    buffer_load_dwordx4 v10, s[24:27], s58 offen lds
    s_add_u32 s59, s63, 0xb8000
    s_add_u32 m0, s70, 0x5c00
    s_nop 0
    buffer_load_dwordx4 v10, s[24:27], s59 offen lds
    s_add_u32 s56, s63, 0xc0000
    s_add_u32 m0, s70, 0x6000
    s_nop 0
    buffer_load_dwordx4 v10, s[24:27], s56 offen lds
    s_add_u32 s57, s63, 0xc8000
    s_add_u32 m0, s70, 0x6400
    s_nop 0
    buffer_load_dwordx4 v10, s[24:27], s57 offen lds
    s_add_u32 s58, s63, 0xd0000
    s_add_u32 m0, s70, 0x6800
    s_nop 0
    buffer_load_dwordx4 v10, s[24:27], s58 offen lds
    s_add_u32 s59, s63, 0xd8000
    s_add_u32 m0, s70, 0x6c00
    s_nop 0
    buffer_load_dwordx4 v10, s[24:27], s59 offen lds
    s_cmp_ge_u32 s53, 14
    s_cselect_b32 s96, 0, -1
    v_mov_b32 v88, -1
    v_mov_b32 v92, s96
    v_mov_b32 v89, -1
    v_mov_b32 v93, s96
    v_mov_b32 v90, -1
    v_mov_b32 v94, s96
    v_mov_b32 v91, -1
    v_mov_b32 v95, s96
    s_mov_b64 exec, 0xffffffff
    v_lshrrev_b32 v72, 3, v0
    v_lshlrev_b32 v72, 14, v72
    v_and_b32 v73, 7, v0
    v_lshl_add_u32 v72, v73, 4, v72
    s_lshl_b32 s63, s48, 11
    s_lshl_b32 s70, s53, 7
    s_add_u32 s63, s63, s70
    s_add_u32 s70, s63, 0x90000
    buffer_store_dwordx4 v[92:95], v72, s[12:15], s70 offen sc1
    s_add_u32 s70, s63, 0xb0000
    buffer_store_dwordx4 v[92:95], v72, s[12:15], s70 offen sc1
    s_mov_b64 exec, 0xff
    v_lshrrev_b32 v72, 1, v0
    v_lshlrev_b32 v72, 12, v72
    v_and_b32 v73, 1, v0
    v_lshl_add_u32 v72, v73, 4, v72
    s_lshl_b32 s63, s48, 9
    s_lshl_b32 s70, s53, 5
    s_add_u32 s63, s63, s70
    s_add_u32 s63, s63, 0xa0000
    buffer_store_dwordx4 v[88:91], v72, s[12:15], s63 offen sc1
    v_lshrrev_b32 v72, 2, v0
    v_lshlrev_b32 v72, 13, v72
    v_and_b32 v73, 3, v0
    v_lshl_add_u32 v72, v73, 4, v72
    s_lshl_b32 s63, s48, 10
    s_lshl_b32 s70, s53, 6
    s_add_u32 s63, s63, s70
    s_add_u32 s63, s63, 0x4000
    buffer_store_dwordx4 v[88:91], v72, s[12:15], s63 offen sc1
    s_mov_b64 exec, -1
    s_lshl_b32 s55, s52, 12
    s_add_u32 s55, s55, 0x24000
    s_waitcnt vmcnt(34)
    v_lshlrev_b32 v12, 16, v80
    v_and_b32 v13, 0xffff0000, v80
    v_lshlrev_b32 v14, 16, v81
    v_and_b32 v15, 0xffff0000, v81
    v_lshlrev_b32 v16, 16, v82
    v_and_b32 v17, 0xffff0000, v82
    v_lshlrev_b32 v18, 16, v83
    v_and_b32 v19, 0xffff0000, v83
    v_cndmask_b32 v16, 0, v16, s[66:67]
    v_cndmask_b32 v17, 0, v17, s[66:67]
    v_cndmask_b32 v18, 0, v18, s[66:67]
    v_cndmask_b32 v19, 0, v19, s[66:67]
    v_add_u32 v77, s55, v1
    v_cvt_pk_bf16_f32 v72, v12, v13
    v_cvt_pk_bf16_f32 v73, v14, v15
    v_cvt_pk_bf16_f32 v74, v16, v17
    v_cvt_pk_bf16_f32 v75, v18, v19
    ds_write_b64 v77, v[72:73] offset:2048
    ds_write_b64 v77, v[74:75] offset:2560
    v_add_f32 v36, v12, v13
    v_add_f32 v36, v36, v14
    v_add_f32 v36, v36, v15
    v_add_f32 v36, v36, v16
    v_add_f32 v36, v36, v17
    v_add_f32 v36, v36, v18
    v_add_f32 v36, v36, v19
    s_nop 1
    v_add_f32_dpp v36, v36, v36 row_ror:8 row_mask:0xf bank_mask:0xf
    s_nop 1
    v_add_f32_dpp v36, v36, v36 row_ror:4 row_mask:0xf bank_mask:0xf
    s_nop 1
    v_add_f32_dpp v36, v36, v36 row_ror:2 row_mask:0xf bank_mask:0xf
    s_nop 1
    v_add_f32_dpp v36, v36, v36 row_ror:1 row_mask:0xf bank_mask:0xf
    s_nop 1
    v_add_f32_dpp v36, v36, v36 row_bcast:15 row_mask:0xa bank_mask:0xf
    s_nop 1
    v_add_f32_dpp v36, v36, v36 row_bcast:31 row_mask:0xc bank_mask:0xf
    s_nop 0
    v_readlane_b32 s63, v36, 63
    v_mov_b32 v37, 0x3b124925
    s_nop 0
    v_mul_f32 v37, s63, v37
    v_sub_f32 v28, v12, v37
    v_sub_f32 v29, v13, v37
    v_sub_f32 v30, v14, v37
    v_sub_f32 v31, v15, v37
    v_sub_f32 v32, v16, v37
    v_sub_f32 v33, v17, v37
    v_sub_f32 v34, v18, v37
    v_sub_f32 v35, v19, v37
    v_cndmask_b32 v32, 0, v32, s[66:67]
    v_cndmask_b32 v33, 0, v33, s[66:67]
    v_cndmask_b32 v34, 0, v34, s[66:67]
    v_cndmask_b32 v35, 0, v35, s[66:67]
    v_mul_f32 v36, v28, v28
    v_fmac_f32 v36, v29, v29
    v_fmac_f32 v36, v30, v30
    v_fmac_f32 v36, v31, v31
    v_fmac_f32 v36, v32, v32
    v_fmac_f32 v36, v33, v33
    v_fmac_f32 v36, v34, v34
    v_fmac_f32 v36, v35, v35
    s_nop 1
    v_add_f32_dpp v36, v36, v36 row_ror:8 row_mask:0xf bank_mask:0xf
    s_nop 1
    v_add_f32_dpp v36, v36, v36 row_ror:4 row_mask:0xf bank_mask:0xf
    s_nop 1
    v_add_f32_dpp v36, v36, v36 row_ror:2 row_mask:0xf bank_mask:0xf
    s_nop 1
    v_add_f32_dpp v36, v36, v36 row_ror:1 row_mask:0xf bank_mask:0xf
    s_nop 1
    v_add_f32_dpp v36, v36, v36 row_bcast:15 row_mask:0xa bank_mask:0xf
    s_nop 1
    v_add_f32_dpp v36, v36, v36 row_bcast:31 row_mask:0xc bank_mask:0xf
    s_nop 0
    v_readlane_b32 s63, v36, 63
    v_mov_b32 v37, 0x3b124925
    v_mov_b32 v36, 0x3727c5ac
    v_fma_f32 v37, s63, v37, v36
    v_rsq_f32 v37, v37
    s_nop 0
    v_mul_f32 v28, v28, v37
    v_mul_f32 v29, v29, v37
    v_mul_f32 v30, v30, v37
    v_mul_f32 v31, v31, v37
    v_mul_f32 v32, v32, v37
    v_mul_f32 v33, v33, v37
    v_mul_f32 v34, v34, v37
    v_mul_f32 v35, v35, v37
    v_cvt_pk_bf16_f32 v28, v28, v29
    v_cvt_pk_bf16_f32 v29, v30, v31
    v_cvt_pk_bf16_f32 v30, v32, v33
    v_cvt_pk_bf16_f32 v31, v34, v35
    v_add_u32 v36, s55, v1
    ds_write_b64 v36, v[28:29]
    ds_write_b64 v36, v[30:31] offset:512
    s_waitcnt vmcnt(32)
    v_lshlrev_b32 v20, 16, v84
    v_and_b32 v21, 0xffff0000, v84
    v_lshlrev_b32 v22, 16, v85
    v_and_b32 v23, 0xffff0000, v85
    v_lshlrev_b32 v24, 16, v86
    v_and_b32 v25, 0xffff0000, v86
    v_lshlrev_b32 v26, 16, v87
    v_and_b32 v27, 0xffff0000, v87
    v_cndmask_b32 v24, 0, v24, s[66:67]
    v_cndmask_b32 v25, 0, v25, s[66:67]
    v_cndmask_b32 v26, 0, v26, s[66:67]
    v_cndmask_b32 v27, 0, v27, s[66:67]
    v_add_u32 v77, s55, v1
    v_cvt_pk_bf16_f32 v72, v20, v21
    v_cvt_pk_bf16_f32 v73, v22, v23
    v_cvt_pk_bf16_f32 v74, v24, v25
    v_cvt_pk_bf16_f32 v75, v26, v27
    ds_write_b64 v77, v[72:73] offset:3072
    ds_write_b64 v77, v[74:75] offset:3584
    v_add_f32 v36, v20, v21
    v_add_f32 v36, v36, v22
    v_add_f32 v36, v36, v23
    v_add_f32 v36, v36, v24
    v_add_f32 v36, v36, v25
    v_add_f32 v36, v36, v26
    v_add_f32 v36, v36, v27
    s_nop 1
    v_add_f32_dpp v36, v36, v36 row_ror:8 row_mask:0xf bank_mask:0xf
    s_nop 1
    v_add_f32_dpp v36, v36, v36 row_ror:4 row_mask:0xf bank_mask:0xf
    s_nop 1
    v_add_f32_dpp v36, v36, v36 row_ror:2 row_mask:0xf bank_mask:0xf
    s_nop 1
    v_add_f32_dpp v36, v36, v36 row_ror:1 row_mask:0xf bank_mask:0xf
    s_nop 1
    v_add_f32_dpp v36, v36, v36 row_bcast:15 row_mask:0xa bank_mask:0xf
    s_nop 1
    v_add_f32_dpp v36, v36, v36 row_bcast:31 row_mask:0xc bank_mask:0xf
    s_nop 0
    v_readlane_b32 s63, v36, 63
    v_mov_b32 v37, 0x3b124925
    s_nop 0
    v_mul_f32 v37, s63, v37
    v_sub_f32 v28, v20, v37
    v_sub_f32 v29, v21, v37
    v_sub_f32 v30, v22, v37
    v_sub_f32 v31, v23, v37
    v_sub_f32 v32, v24, v37
    v_sub_f32 v33, v25, v37
    v_sub_f32 v34, v26, v37
    v_sub_f32 v35, v27, v37
    v_cndmask_b32 v32, 0, v32, s[66:67]
    v_cndmask_b32 v33, 0, v33, s[66:67]
    v_cndmask_b32 v34, 0, v34, s[66:67]
    v_cndmask_b32 v35, 0, v35, s[66:67]
    v_mul_f32 v36, v28, v28
    v_fmac_f32 v36, v29, v29
    v_fmac_f32 v36, v30, v30
    v_fmac_f32 v36, v31, v31
    v_fmac_f32 v36, v32, v32
    v_fmac_f32 v36, v33, v33
    v_fmac_f32 v36, v34, v34
    v_fmac_f32 v36, v35, v35
    s_nop 1
    v_add_f32_dpp v36, v36, v36 row_ror:8 row_mask:0xf bank_mask:0xf
    s_nop 1
    v_add_f32_dpp v36, v36, v36 row_ror:4 row_mask:0xf bank_mask:0xf
    s_nop 1
    v_add_f32_dpp v36, v36, v36 row_ror:2 row_mask:0xf bank_mask:0xf
    s_nop 1
    v_add_f32_dpp v36, v36, v36 row_ror:1 row_mask:0xf bank_mask:0xf
    s_nop 1
    v_add_f32_dpp v36, v36, v36 row_bcast:15 row_mask:0xa bank_mask:0xf
    s_nop 1
    v_add_f32_dpp v36, v36, v36 row_bcast:31 row_mask:0xc bank_mask:0xf
    s_nop 0
    v_readlane_b32 s63, v36, 63
    v_mov_b32 v37, 0x3b124925
    v_mov_b32 v36, 0x3727c5ac
    v_fma_f32 v37, s63, v37, v36
    v_rsq_f32 v37, v37
    s_nop 0
    v_mul_f32 v28, v28, v37
    v_mul_f32 v29, v29, v37
    v_mul_f32 v30, v30, v37
    v_mul_f32 v31, v31, v37
    v_mul_f32 v32, v32, v37
    v_mul_f32 v33, v33, v37
    v_mul_f32 v34, v34, v37
    v_mul_f32 v35, v35, v37
    v_cvt_pk_bf16_f32 v28, v28, v29
    v_cvt_pk_bf16_f32 v29, v30, v31
    v_cvt_pk_bf16_f32 v30, v32, v33
    v_cvt_pk_bf16_f32 v31, v34, v35
    v_add_u32 v36, s55, v1
    ds_write_b64 v36, v[28:29] offset:1024
    ds_write_b64 v36, v[30:31] offset:1536
    s_waitcnt vmcnt(0) lgkmcnt(0)
    s_barrier
    s_cmp_lg_u32 s52, 0
    s_cbranch_scc1 L29
    s_getreg_b32 s63, hwreg(HW_REG_XCC_ID)
    s_and_b32 s63, s63, 7
    s_mul_i32 s70, s63, s63
    s_lshl_b32 s70, s70, 20
    s_lshl_b32 s63, s63, 8
    s_add_u32 s63, s63, s70
    s_add_u32 s63, s63, 1
    v_mov_b32 v73, s63
    s_and_b32 s63, s48, 3
    s_lshl_b32 s63, s63, 6
    s_lshr_b32 s70, s48, 2
    s_lshl_b32 s70, s70, 2
    s_add_u32 s63, s63, s70
    v_mov_b32 v72, s63
    s_mov_b64 exec, 1
    buffer_atomic_add v73, v72, s[16:19], 0 offen sc1
    s_mov_b64 exec, -1
L29:
    s_nop 7
    v_add_u32 v76, 0x10000, v4
    ds_read_b64_tr_b16 v[80:81], v4
    ds_read_b64_tr_b16 v[82:83], v4 offset:1024
    ds_read_b64_tr_b16 v[136:137], v4 offset:32
    ds_read_b64_tr_b16 v[138:139], v4 offset:1056
    ds_read_b64_tr_b16 v[84:85], v4 offset:8192
    ds_read_b64_tr_b16 v[86:87], v4 offset:9216
    ds_read_b64_tr_b16 v[140:141], v4 offset:8224
    ds_read_b64_tr_b16 v[142:143], v4 offset:9248
    ds_read_b64_tr_b16 v[88:89], v4 offset:16384
    ds_read_b64_tr_b16 v[90:91], v4 offset:17408
    ds_read_b64_tr_b16 v[144:145], v4 offset:16416
    ds_read_b64_tr_b16 v[146:147], v4 offset:17440
    ds_read_b64_tr_b16 v[92:93], v4 offset:24576
    ds_read_b64_tr_b16 v[94:95], v4 offset:25600
    ds_read_b64_tr_b16 v[148:149], v4 offset:24608
    ds_read_b64_tr_b16 v[150:151], v4 offset:25632
    ds_read_b64_tr_b16 v[96:97], v4 offset:32768
    ds_read_b64_tr_b16 v[98:99], v4 offset:33792
    ds_read_b64_tr_b16 v[152:153], v4 offset:32800
    ds_read_b64_tr_b16 v[154:155], v4 offset:33824
    ds_read_b64_tr_b16 v[100:101], v4 offset:40960
    ds_read_b64_tr_b16 v[102:103], v4 offset:41984
    ds_read_b64_tr_b16 v[156:157], v4 offset:40992
    ds_read_b64_tr_b16 v[158:159], v4 offset:42016
    ds_read_b64_tr_b16 v[104:105], v4 offset:49152
    ds_read_b64_tr_b16 v[106:107], v4 offset:50176
    ds_read_b64_tr_b16 v[160:161], v4 offset:49184
    ds_read_b64_tr_b16 v[162:163], v4 offset:50208
    ds_read_b64_tr_b16 v[108:109], v4 offset:57344
    ds_read_b64_tr_b16 v[110:111], v4 offset:58368
    ds_read_b64_tr_b16 v[164:165], v4 offset:57376
    ds_read_b64_tr_b16 v[166:167], v4 offset:58400
    ds_read_b64_tr_b16 v[112:113], v76
    ds_read_b64_tr_b16 v[114:115], v76 offset:1024
    ds_read_b64_tr_b16 v[168:169], v76 offset:32
    ds_read_b64_tr_b16 v[170:171], v76 offset:1056
    ds_read_b64_tr_b16 v[116:117], v76 offset:8192
    ds_read_b64_tr_b16 v[118:119], v76 offset:9216
    ds_read_b64_tr_b16 v[172:173], v76 offset:8224
    ds_read_b64_tr_b16 v[174:175], v76 offset:9248
    ds_read_b64_tr_b16 v[120:121], v76 offset:16384
    ds_read_b64_tr_b16 v[122:123], v76 offset:17408
    ds_read_b64_tr_b16 v[176:177], v76 offset:16416
    ds_read_b64_tr_b16 v[178:179], v76 offset:17440
    ds_read_b64_tr_b16 v[124:125], v76 offset:24576
    ds_read_b64_tr_b16 v[126:127], v76 offset:25600
    ds_read_b64_tr_b16 v[180:181], v76 offset:24608
    ds_read_b64_tr_b16 v[182:183], v76 offset:25632
    ds_read_b64_tr_b16 v[128:129], v76 offset:32768
    ds_read_b64_tr_b16 v[130:131], v76 offset:33792
    ds_read_b64_tr_b16 v[184:185], v76 offset:32800
    ds_read_b64_tr_b16 v[186:187], v76 offset:33824
    ds_read_b64_tr_b16 v[132:133], v76 offset:40960
    ds_read_b64_tr_b16 v[134:135], v76 offset:41984
    ds_read_b64_tr_b16 v[188:189], v76 offset:40992
    ds_read_b64_tr_b16 v[190:191], v76 offset:42016
    s_waitcnt lgkmcnt(0)
    v_add_u32 v77, s55, v2
    ds_read_b128 v[48:51], v77
    ds_read_b128 v[52:55], v77 offset:64
    ds_read_b128 v[56:59], v77 offset:128
    ds_read_b128 v[60:63], v77 offset:192
    ds_read_b128 v[64:67], v77 offset:256
    ds_read_b128 v[68:71], v77 offset:320
    s_waitcnt lgkmcnt(5)
    v_mfma_f32_16x16x32_bf16 v[40:43], v[80:83], v[48:51], 0
    v_mfma_f32_16x16x32_bf16 v[44:47], v[136:139], v[48:51], 0
    ds_read_b128 v[48:51], v77 offset:384
    s_waitcnt lgkmcnt(5)
    v_mfma_f32_16x16x32_bf16 v[40:43], v[84:87], v[52:55], v[40:43]
    v_mfma_f32_16x16x32_bf16 v[44:47], v[140:143], v[52:55], v[44:47]
    ds_read_b128 v[52:55], v77 offset:448
    s_waitcnt lgkmcnt(5)
    v_mfma_f32_16x16x32_bf16 v[40:43], v[88:91], v[56:59], v[40:43]
    v_mfma_f32_16x16x32_bf16 v[44:47], v[144:147], v[56:59], v[44:47]
    ds_read_b128 v[56:59], v77 offset:512
    s_waitcnt lgkmcnt(5)
    v_mfma_f32_16x16x32_bf16 v[40:43], v[92:95], v[60:63], v[40:43]
    v_mfma_f32_16x16x32_bf16 v[44:47], v[148:151], v[60:63], v[44:47]
    ds_read_b128 v[60:63], v77 offset:576
    s_waitcnt lgkmcnt(5)
    v_mfma_f32_16x16x32_bf16 v[40:43], v[96:99], v[64:67], v[40:43]
    v_mfma_f32_16x16x32_bf16 v[44:47], v[152:155], v[64:67], v[44:47]
    ds_read_b128 v[64:67], v77 offset:640
    s_waitcnt lgkmcnt(5)
    v_mfma_f32_16x16x32_bf16 v[40:43], v[100:103], v[68:71], v[40:43]
    v_mfma_f32_16x16x32_bf16 v[44:47], v[156:159], v[68:71], v[44:47]
    ds_read_b128 v[68:71], v77 offset:704
    s_waitcnt lgkmcnt(5)
    v_mfma_f32_16x16x32_bf16 v[40:43], v[104:107], v[48:51], v[40:43]
    v_mfma_f32_16x16x32_bf16 v[44:47], v[160:163], v[48:51], v[44:47]
    ds_read_b128 v[48:51], v77 offset:768
    s_waitcnt lgkmcnt(5)
    v_mfma_f32_16x16x32_bf16 v[40:43], v[108:111], v[52:55], v[40:43]
    v_mfma_f32_16x16x32_bf16 v[44:47], v[164:167], v[52:55], v[44:47]
    ds_read_b128 v[52:55], v77 offset:832
    s_waitcnt lgkmcnt(5)
    v_mfma_f32_16x16x32_bf16 v[40:43], v[112:115], v[56:59], v[40:43]
    v_mfma_f32_16x16x32_bf16 v[44:47], v[168:171], v[56:59], v[44:47]
    s_waitcnt lgkmcnt(4)
    v_mfma_f32_16x16x32_bf16 v[40:43], v[116:119], v[60:63], v[40:43]
    v_mfma_f32_16x16x32_bf16 v[44:47], v[172:175], v[60:63], v[44:47]
    s_waitcnt lgkmcnt(3)
    v_mfma_f32_16x16x32_bf16 v[40:43], v[120:123], v[64:67], v[40:43]
    v_mfma_f32_16x16x32_bf16 v[44:47], v[176:179], v[64:67], v[44:47]
    s_waitcnt lgkmcnt(2)
    v_mfma_f32_16x16x32_bf16 v[40:43], v[124:127], v[68:71], v[40:43]
    v_mfma_f32_16x16x32_bf16 v[44:47], v[180:183], v[68:71], v[44:47]
    s_waitcnt lgkmcnt(1)
    v_mfma_f32_16x16x32_bf16 v[40:43], v[128:131], v[48:51], v[40:43]
    v_mfma_f32_16x16x32_bf16 v[44:47], v[184:187], v[48:51], v[44:47]
    s_waitcnt lgkmcnt(0)
    v_mfma_f32_16x16x32_bf16 v[40:43], v[132:135], v[52:55], v[40:43]
    v_mfma_f32_16x16x32_bf16 v[44:47], v[188:191], v[52:55], v[44:47]
    s_nop 6
    v_cvt_pk_bf16_f32 v38, v40, v41
    v_cvt_pk_bf16_f32 v39, v42, v43
    v_cvt_pk_bf16_f32 v72, v44, v45
    v_cvt_pk_bf16_f32 v73, v46, v47
    v_lshrrev_b32 v74, 1, v2
    s_lshl_b32 s63, s48, 10
    s_lshl_b32 s70, s53, 6
    s_add_u32 s63, s63, s70
    s_add_u32 s63, s63, 0
    s_mov_b64 exec, s[98:99]
    buffer_store_dwordx2 v[38:39], v74, s[12:15], s63 offen sc1
    buffer_store_dwordx2 v[72:73], v74, s[12:15], s63 offen offset:32 sc1
    s_mov_b64 exec, -1
    v_add_u32 v77, s55, v2
    ds_read_b128 v[48:51], v77 offset:1024
    ds_read_b128 v[52:55], v77 offset:1088
    ds_read_b128 v[56:59], v77 offset:1152
    ds_read_b128 v[60:63], v77 offset:1216
    ds_read_b128 v[64:67], v77 offset:1280
    ds_read_b128 v[68:71], v77 offset:1344
    s_waitcnt lgkmcnt(5)
    v_mfma_f32_16x16x32_bf16 v[40:43], v[80:83], v[48:51], 0
    v_mfma_f32_16x16x32_bf16 v[44:47], v[136:139], v[48:51], 0
    ds_read_b128 v[48:51], v77 offset:1408
    s_waitcnt lgkmcnt(5)
    v_mfma_f32_16x16x32_bf16 v[40:43], v[84:87], v[52:55], v[40:43]
    v_mfma_f32_16x16x32_bf16 v[44:47], v[140:143], v[52:55], v[44:47]
    ds_read_b128 v[52:55], v77 offset:1472
    s_waitcnt lgkmcnt(5)
    v_mfma_f32_16x16x32_bf16 v[40:43], v[88:91], v[56:59], v[40:43]
    v_mfma_f32_16x16x32_bf16 v[44:47], v[144:147], v[56:59], v[44:47]
    ds_read_b128 v[56:59], v77 offset:1536
    s_waitcnt lgkmcnt(5)
    v_mfma_f32_16x16x32_bf16 v[40:43], v[92:95], v[60:63], v[40:43]
    v_mfma_f32_16x16x32_bf16 v[44:47], v[148:151], v[60:63], v[44:47]
    ds_read_b128 v[60:63], v77 offset:1600
    s_waitcnt lgkmcnt(5)
    v_mfma_f32_16x16x32_bf16 v[40:43], v[96:99], v[64:67], v[40:43]
    v_mfma_f32_16x16x32_bf16 v[44:47], v[152:155], v[64:67], v[44:47]
    ds_read_b128 v[64:67], v77 offset:1664
    s_waitcnt lgkmcnt(5)
    v_mfma_f32_16x16x32_bf16 v[40:43], v[100:103], v[68:71], v[40:43]
    v_mfma_f32_16x16x32_bf16 v[44:47], v[156:159], v[68:71], v[44:47]
    ds_read_b128 v[68:71], v77 offset:1728
    s_waitcnt lgkmcnt(5)
    v_mfma_f32_16x16x32_bf16 v[40:43], v[104:107], v[48:51], v[40:43]
    v_mfma_f32_16x16x32_bf16 v[44:47], v[160:163], v[48:51], v[44:47]
    ds_read_b128 v[48:51], v77 offset:1792
    s_waitcnt lgkmcnt(5)
    v_mfma_f32_16x16x32_bf16 v[40:43], v[108:111], v[52:55], v[40:43]
    v_mfma_f32_16x16x32_bf16 v[44:47], v[164:167], v[52:55], v[44:47]
    ds_read_b128 v[52:55], v77 offset:1856
    s_waitcnt lgkmcnt(5)
    v_mfma_f32_16x16x32_bf16 v[40:43], v[112:115], v[56:59], v[40:43]
    v_mfma_f32_16x16x32_bf16 v[44:47], v[168:171], v[56:59], v[44:47]
    s_waitcnt lgkmcnt(4)
    v_mfma_f32_16x16x32_bf16 v[40:43], v[116:119], v[60:63], v[40:43]
    v_mfma_f32_16x16x32_bf16 v[44:47], v[172:175], v[60:63], v[44:47]
    s_waitcnt lgkmcnt(3)
    v_mfma_f32_16x16x32_bf16 v[40:43], v[120:123], v[64:67], v[40:43]
    v_mfma_f32_16x16x32_bf16 v[44:47], v[176:179], v[64:67], v[44:47]
    s_waitcnt lgkmcnt(2)
    v_mfma_f32_16x16x32_bf16 v[40:43], v[124:127], v[68:71], v[40:43]
    v_mfma_f32_16x16x32_bf16 v[44:47], v[180:183], v[68:71], v[44:47]
    s_waitcnt lgkmcnt(1)
    v_mfma_f32_16x16x32_bf16 v[40:43], v[128:131], v[48:51], v[40:43]
    v_mfma_f32_16x16x32_bf16 v[44:47], v[184:187], v[48:51], v[44:47]
    s_waitcnt lgkmcnt(0)
    v_mfma_f32_16x16x32_bf16 v[40:43], v[132:135], v[52:55], v[40:43]
    v_mfma_f32_16x16x32_bf16 v[44:47], v[188:191], v[52:55], v[44:47]
    s_nop 6
    v_cvt_pk_bf16_f32 v38, v40, v41
    v_cvt_pk_bf16_f32 v39, v42, v43
    v_cvt_pk_bf16_f32 v72, v44, v45
    v_cvt_pk_bf16_f32 v73, v46, v47
    v_lshrrev_b32 v74, 1, v2
    s_lshl_b32 s63, s48, 10
    s_lshl_b32 s70, s53, 6
    s_add_u32 s63, s63, s70
    s_add_u32 s63, s63, 0x2000
    s_mov_b64 exec, s[98:99]
    buffer_store_dwordx2 v[38:39], v74, s[12:15], s63 offen sc1
    buffer_store_dwordx2 v[72:73], v74, s[12:15], s63 offen offset:32 sc1
    s_mov_b64 exec, -1
    s_and_b32 s63, s48, 3
    s_lshl_b32 s63, s63, 6
    s_lshr_b32 s70, s48, 2
    s_lshl_b32 s70, s70, 2
    s_add_u32 s63, s63, s70
    v_mov_b32 v76, s63
L30:
    s_nop 7
    buffer_load_dword v78, v76, s[16:19], 0 offen sc1
    s_waitcnt vmcnt(0)
    v_and_b32 v79, 0xff, v78
    v_cmp_gt_u32 vcc, 32, v79
    s_cbranch_vccz L31
    s_sleep 8
    s_sub_u32 s62, s62, 1
    s_cmp_eq_u32 s62, 0
    s_cbranch_scc1 L_end
    s_branch L30
L31:
    s_nop 7
    v_readfirstlane_b32 s63, v78
    s_lshr_b32 s70, s63, 8
    s_and_b32 s70, s70, 0xfff
    s_lshr_b32 s63, s63, 20
    s_mul_i32 s70, s70, s70
    s_lshl_b32 s63, s63, 5
    s_cmp_eq_u32 s63, s70
    s_cselect_b32 s3, 1, 0
    v_mov_b32 v72, s3
    v_mov_b32 v73, 0
    s_lshl_b32 s70, s50, 6
    s_add_u32 s70, s70, 0xa000
    s_mov_b64 exec, 1
    buffer_store_dword v72, v73, s[12:15], s70 offen sc1
    s_mov_b64 exec, -1
    s_waitcnt vmcnt(0)
    s_and_b32 s63, s50, 3
    s_lshl_b32 s63, s63, 6
    s_lshr_b32 s70, s50, 2
    s_lshl_b32 s70, s70, 2
    s_add_u32 s63, s63, s70
    s_add_u32 s63, s63, 16
    v_mov_b32 v72, s63
    v_mov_b32 v73, 1
    s_mov_b64 exec, 1
    buffer_atomic_add v73, v72, s[16:19], 0 offen sc1
    s_mov_b64 exec, -1
    v_mul_u32_u24 v10, 0x380, v7
    v_lshl_add_u32 v10, v6, 4, v10
    s_mul_i32 s71, s48, 0x70000
    s_lshl_b32 s96, s51, 8
    s_add_u32 s71, s71, s96
    s_mul_i32 s63, s52, 0x1c000
    s_add_u32 s63, s63, s71
    s_add_u32 s56, s63, 0
    buffer_load_dwordx4 a[0:3], v10, s[28:31], s56 offen
    s_add_u32 s57, s63, 0xe00
    buffer_load_dwordx4 a[4:7], v10, s[28:31], s57 offen
    s_add_u32 s58, s63, 0x1c00
    buffer_load_dwordx4 a[8:11], v10, s[28:31], s58 offen
    s_add_u32 s59, s63, 0x2a00
    buffer_load_dwordx4 a[12:15], v10, s[28:31], s59 offen
    s_add_u32 s56, s63, 0x3800
    buffer_load_dwordx4 a[16:19], v10, s[28:31], s56 offen
    s_add_u32 s57, s63, 0x4600
    buffer_load_dwordx4 a[20:23], v10, s[28:31], s57 offen
    s_add_u32 s58, s63, 0x5400
    buffer_load_dwordx4 a[24:27], v10, s[28:31], s58 offen
    s_add_u32 s59, s63, 0x6200
    buffer_load_dwordx4 a[28:31], v10, s[28:31], s59 offen
    s_add_u32 s56, s63, 0x7000
    buffer_load_dwordx4 a[32:35], v10, s[28:31], s56 offen
    s_add_u32 s57, s63, 0x7e00
    buffer_load_dwordx4 a[36:39], v10, s[28:31], s57 offen
    s_add_u32 s58, s63, 0x8c00
    buffer_load_dwordx4 a[40:43], v10, s[28:31], s58 offen
    s_add_u32 s59, s63, 0x9a00
    buffer_load_dwordx4 a[44:47], v10, s[28:31], s59 offen
    s_add_u32 s56, s63, 0xa800
    buffer_load_dwordx4 a[48:51], v10, s[28:31], s56 offen
    s_add_u32 s57, s63, 0xb600
    buffer_load_dwordx4 a[52:55], v10, s[28:31], s57 offen
    s_add_u32 s58, s63, 0xc400
    buffer_load_dwordx4 a[56:59], v10, s[28:31], s58 offen
    s_add_u32 s59, s63, 0xd200
    buffer_load_dwordx4 a[60:63], v10, s[28:31], s59 offen
    s_add_u32 s56, s63, 0xe000
    buffer_load_dwordx4 a[64:67], v10, s[28:31], s56 offen
    s_add_u32 s57, s63, 0xee00
    buffer_load_dwordx4 a[68:71], v10, s[28:31], s57 offen
    s_add_u32 s58, s63, 0xfc00
    buffer_load_dwordx4 a[72:75], v10, s[28:31], s58 offen
    s_add_u32 s59, s63, 0x10a00
    buffer_load_dwordx4 a[76:79], v10, s[28:31], s59 offen
    s_add_u32 s56, s63, 0x11800
    buffer_load_dwordx4 a[80:83], v10, s[28:31], s56 offen
    s_add_u32 s57, s63, 0x12600
    buffer_load_dwordx4 a[84:87], v10, s[28:31], s57 offen
    s_add_u32 s58, s63, 0x13400
    buffer_load_dwordx4 a[88:91], v10, s[28:31], s58 offen
    s_add_u32 s59, s63, 0x14200
    buffer_load_dwordx4 a[92:95], v10, s[28:31], s59 offen
    s_add_u32 s56, s63, 0x15000
    buffer_load_dwordx4 a[96:99], v10, s[28:31], s56 offen
    s_add_u32 s57, s63, 0x15e00
    buffer_load_dwordx4 a[100:103], v10, s[28:31], s57 offen
    s_add_u32 s58, s63, 0x16c00
    buffer_load_dwordx4 a[104:107], v10, s[28:31], s58 offen
    s_add_u32 s59, s63, 0x17a00
    buffer_load_dwordx4 a[108:111], v10, s[28:31], s59 offen
    s_add_u32 s56, s63, 0x18800
    buffer_load_dwordx4 a[112:115], v10, s[28:31], s56 offen
    s_add_u32 s57, s63, 0x19600
    buffer_load_dwordx4 a[116:119], v10, s[28:31], s57 offen
    s_add_u32 s58, s63, 0x1a400
    buffer_load_dwordx4 a[120:123], v10, s[28:31], s58 offen
    s_add_u32 s59, s63, 0x1b200
    buffer_load_dwordx4 a[124:127], v10, s[28:31], s59 offen
    v_mul_u32_u24 v11, 0xe00, v7
    v_and_b32 v72, 7, v6
    v_lshl_add_u32 v11, v72, 4, v11
    v_cmp_gt_u32 s[68:69], 8, v6
    s_mul_i32 s71, s48, 0x1c0
    s_lshl_b32 s96, s51, 7
    s_add_u32 s71, s71, s96
    s_mov_b64 exec, s[68:69]
    s_mul_i32 s63, s52, 0x62000
    s_add_u32 s63, s63, s71
    s_add_u32 s56, s63, 0
    buffer_load_dwordx4 a[128:131], v11, s[32:35], s56 offen
    s_add_u32 s57, s63, 0x3800
    buffer_load_dwordx4 a[132:135], v11, s[32:35], s57 offen
    s_add_u32 s58, s63, 0x7000
    buffer_load_dwordx4 a[136:139], v11, s[32:35], s58 offen
    s_add_u32 s59, s63, 0xa800
    buffer_load_dwordx4 a[140:143], v11, s[32:35], s59 offen
    s_add_u32 s56, s63, 0xe000
    buffer_load_dwordx4 a[144:147], v11, s[32:35], s56 offen
    s_add_u32 s57, s63, 0x11800
    buffer_load_dwordx4 a[148:151], v11, s[32:35], s57 offen
    s_add_u32 s58, s63, 0x15000
    buffer_load_dwordx4 a[152:155], v11, s[32:35], s58 offen
    s_add_u32 s59, s63, 0x18800
    buffer_load_dwordx4 a[156:159], v11, s[32:35], s59 offen
    s_add_u32 s56, s63, 0x1c000
    buffer_load_dwordx4 a[160:163], v11, s[32:35], s56 offen
    s_add_u32 s57, s63, 0x1f800
    buffer_load_dwordx4 a[164:167], v11, s[32:35], s57 offen
    s_add_u32 s58, s63, 0x23000
    buffer_load_dwordx4 a[168:171], v11, s[32:35], s58 offen
    s_add_u32 s59, s63, 0x26800
    buffer_load_dwordx4 a[172:175], v11, s[32:35], s59 offen
    s_add_u32 s56, s63, 0x2a000
    buffer_load_dwordx4 a[176:179], v11, s[32:35], s56 offen
    s_add_u32 s57, s63, 0x2d800
    buffer_load_dwordx4 a[180:183], v11, s[32:35], s57 offen
    s_add_u32 s58, s63, 0x31000
    buffer_load_dwordx4 a[184:187], v11, s[32:35], s58 offen
    s_add_u32 s59, s63, 0x34800
    buffer_load_dwordx4 a[188:191], v11, s[32:35], s59 offen
    s_add_u32 s56, s63, 0x38000
    buffer_load_dwordx4 a[192:195], v11, s[32:35], s56 offen
    s_add_u32 s57, s63, 0x3b800
    buffer_load_dwordx4 a[196:199], v11, s[32:35], s57 offen
    s_add_u32 s58, s63, 0x3f000
    buffer_load_dwordx4 a[200:203], v11, s[32:35], s58 offen
    s_add_u32 s59, s63, 0x42800
    buffer_load_dwordx4 a[204:207], v11, s[32:35], s59 offen
    s_add_u32 s56, s63, 0x46000
    buffer_load_dwordx4 a[208:211], v11, s[32:35], s56 offen
    s_add_u32 s57, s63, 0x49800
    buffer_load_dwordx4 a[212:215], v11, s[32:35], s57 offen
    s_add_u32 s58, s63, 0x4d000
    buffer_load_dwordx4 a[216:219], v11, s[32:35], s58 offen
    s_add_u32 s59, s63, 0x50800
    buffer_load_dwordx4 a[220:223], v11, s[32:35], s59 offen
    s_add_u32 s56, s63, 0x54000
    buffer_load_dwordx4 a[224:227], v11, s[32:35], s56 offen
    s_add_u32 s57, s63, 0x57800
    buffer_load_dwordx4 a[228:231], v11, s[32:35], s57 offen
    s_add_u32 s58, s63, 0x5b000
    buffer_load_dwordx4 a[232:235], v11, s[32:35], s58 offen
    s_add_u32 s59, s63, 0x5e800
    buffer_load_dwordx4 a[236:239], v11, s[32:35], s59 offen
    s_not_b64 exec, s[68:69]
    s_mul_i32 s63, s52, 0x62000
    s_add_u32 s63, s63, s71
    s_add_u32 s56, s63, 0
    buffer_load_dwordx4 a[128:131], v11, s[36:39], s56 offen
    s_add_u32 s57, s63, 0x3800
    buffer_load_dwordx4 a[132:135], v11, s[36:39], s57 offen
    s_add_u32 s58, s63, 0x7000
    buffer_load_dwordx4 a[136:139], v11, s[36:39], s58 offen
    s_add_u32 s59, s63, 0xa800
    buffer_load_dwordx4 a[140:143], v11, s[36:39], s59 offen
    s_add_u32 s56, s63, 0xe000
    buffer_load_dwordx4 a[144:147], v11, s[36:39], s56 offen
    s_add_u32 s57, s63, 0x11800
    buffer_load_dwordx4 a[148:151], v11, s[36:39], s57 offen
    s_add_u32 s58, s63, 0x15000
    buffer_load_dwordx4 a[152:155], v11, s[36:39], s58 offen
    s_add_u32 s59, s63, 0x18800
    buffer_load_dwordx4 a[156:159], v11, s[36:39], s59 offen
    s_add_u32 s56, s63, 0x1c000
    buffer_load_dwordx4 a[160:163], v11, s[36:39], s56 offen
    s_add_u32 s57, s63, 0x1f800
    buffer_load_dwordx4 a[164:167], v11, s[36:39], s57 offen
    s_add_u32 s58, s63, 0x23000
    buffer_load_dwordx4 a[168:171], v11, s[36:39], s58 offen
    s_add_u32 s59, s63, 0x26800
    buffer_load_dwordx4 a[172:175], v11, s[36:39], s59 offen
    s_add_u32 s56, s63, 0x2a000
    buffer_load_dwordx4 a[176:179], v11, s[36:39], s56 offen
    s_add_u32 s57, s63, 0x2d800
    buffer_load_dwordx4 a[180:183], v11, s[36:39], s57 offen
    s_add_u32 s58, s63, 0x31000
    buffer_load_dwordx4 a[184:187], v11, s[36:39], s58 offen
    s_add_u32 s59, s63, 0x34800
    buffer_load_dwordx4 a[188:191], v11, s[36:39], s59 offen
    s_add_u32 s56, s63, 0x38000
    buffer_load_dwordx4 a[192:195], v11, s[36:39], s56 offen
    s_add_u32 s57, s63, 0x3b800
    buffer_load_dwordx4 a[196:199], v11, s[36:39], s57 offen
    s_add_u32 s58, s63, 0x3f000
    buffer_load_dwordx4 a[200:203], v11, s[36:39], s58 offen
    s_add_u32 s59, s63, 0x42800
    buffer_load_dwordx4 a[204:207], v11, s[36:39], s59 offen
    s_add_u32 s56, s63, 0x46000
    buffer_load_dwordx4 a[208:211], v11, s[36:39], s56 offen
    s_add_u32 s57, s63, 0x49800
    buffer_load_dwordx4 a[212:215], v11, s[36:39], s57 offen
    s_add_u32 s58, s63, 0x4d000
    buffer_load_dwordx4 a[216:219], v11, s[36:39], s58 offen
    s_add_u32 s59, s63, 0x50800
    buffer_load_dwordx4 a[220:223], v11, s[36:39], s59 offen
    s_add_u32 s56, s63, 0x54000
    buffer_load_dwordx4 a[224:227], v11, s[36:39], s56 offen
    s_add_u32 s57, s63, 0x57800
    buffer_load_dwordx4 a[228:231], v11, s[36:39], s57 offen
    s_add_u32 s58, s63, 0x5b000
    buffer_load_dwordx4 a[232:235], v11, s[36:39], s58 offen
    s_add_u32 s59, s63, 0x5e800
    buffer_load_dwordx4 a[236:239], v11, s[36:39], s59 offen
    s_mov_b64 exec, -1
    s_mul_i32 s71, s48, 0x31000
    s_lshl_b32 s96, s51, 8
    s_add_u32 s71, s71, s96
    s_mul_i32 s63, s52, 0xc400
    s_add_u32 s63, s63, s71
    s_add_u32 s56, s63, 0
    buffer_load_dwordx4 v[200:203], v10, s[40:43], s56 offen
    s_add_u32 s57, s63, 0xe00
    buffer_load_dwordx4 v[204:207], v10, s[40:43], s57 offen
    s_add_u32 s58, s63, 0x1c00
    buffer_load_dwordx4 v[208:211], v10, s[40:43], s58 offen
    s_add_u32 s59, s63, 0x2a00
    buffer_load_dwordx4 v[212:215], v10, s[40:43], s59 offen
    s_add_u32 s56, s63, 0x3800
    buffer_load_dwordx4 v[216:219], v10, s[40:43], s56 offen
    s_add_u32 s57, s63, 0x4600
    buffer_load_dwordx4 v[220:223], v10, s[40:43], s57 offen
    s_add_u32 s58, s63, 0x5400
    buffer_load_dwordx4 v[224:227], v10, s[40:43], s58 offen
    s_add_u32 s59, s63, 0x6200
    buffer_load_dwordx4 v[228:231], v10, s[40:43], s59 offen
    s_add_u32 s56, s63, 0x7000
    buffer_load_dwordx4 v[232:235], v10, s[40:43], s56 offen
    s_add_u32 s57, s63, 0x7e00
    buffer_load_dwordx4 v[236:239], v10, s[40:43], s57 offen
    s_add_u32 s58, s63, 0x8c00
    buffer_load_dwordx4 v[240:243], v10, s[40:43], s58 offen
    s_add_u32 s59, s63, 0x9a00
    buffer_load_dwordx4 v[244:247], v10, s[40:43], s59 offen
    s_add_u32 s56, s63, 0xa800
    buffer_load_dwordx4 v[248:251], v10, s[40:43], s56 offen
    s_add_u32 s57, s63, 0xb600
    buffer_load_dwordx4 v[252:255], v10, s[40:43], s57 offen
    s_mul_i32 s70, s52, 0x7000
    v_add_u32 v77, s70, v3
    ds_read_b128 v[80:83], v77
    ds_read_b128 v[84:87], v77 offset:1024
    ds_read_b128 v[88:91], v77 offset:2048
    ds_read_b128 v[92:95], v77 offset:3072
    ds_read_b128 v[96:99], v77 offset:4096
    ds_read_b128 v[100:103], v77 offset:5120
    ds_read_b128 v[104:107], v77 offset:6144
    ds_read_b128 v[108:111], v77 offset:7168
    ds_read_b128 v[112:115], v77 offset:8192
    ds_read_b128 v[116:119], v77 offset:9216
    ds_read_b128 v[120:123], v77 offset:10240
    ds_read_b128 v[124:127], v77 offset:11264
    ds_read_b128 v[128:131], v77 offset:12288
    ds_read_b128 v[132:135], v77 offset:13312
    ds_read_b128 v[136:139], v77 offset:14336
    ds_read_b128 v[140:143], v77 offset:15360
    ds_read_b128 v[144:147], v77 offset:16384
    ds_read_b128 v[148:151], v77 offset:17408
    ds_read_b128 v[152:155], v77 offset:18432
    ds_read_b128 v[156:159], v77 offset:19456
    ds_read_b128 v[160:163], v77 offset:20480
    ds_read_b128 v[164:167], v77 offset:21504
    ds_read_b128 v[168:171], v77 offset:22528
    ds_read_b128 v[172:175], v77 offset:23552
    ds_read_b128 v[176:179], v77 offset:24576
    ds_read_b128 v[180:183], v77 offset:25600
    ds_read_b128 v[184:187], v77 offset:26624
    ds_read_b128 v[188:191], v77 offset:27648
    s_waitcnt lgkmcnt(0)
    s_barrier
    s_mul_i32 s70, s52, 0x8000
    v_add_u32 v77, s70, v3
    ds_write_b128 v77, a[0:3]
    ds_write_b128 v77, a[4:7] offset:1024
    ds_write_b128 v77, a[8:11] offset:2048
    ds_write_b128 v77, a[12:15] offset:3072
    ds_write_b128 v77, a[16:19] offset:4096
    ds_write_b128 v77, a[20:23] offset:5120
    ds_write_b128 v77, a[24:27] offset:6144
    ds_write_b128 v77, a[28:31] offset:7168
    ds_write_b128 v77, a[32:35] offset:8192
    ds_write_b128 v77, a[36:39] offset:9216
    ds_write_b128 v77, a[40:43] offset:10240
    ds_write_b128 v77, a[44:47] offset:11264
    ds_write_b128 v77, a[48:51] offset:12288
    ds_write_b128 v77, a[52:55] offset:13312
    ds_write_b128 v77, a[56:59] offset:14336
    ds_write_b128 v77, a[60:63] offset:15360
    ds_write_b128 v77, a[64:67] offset:16384
    ds_write_b128 v77, a[68:71] offset:17408
    ds_write_b128 v77, a[72:75] offset:18432
    ds_write_b128 v77, a[76:79] offset:19456
    ds_write_b128 v77, a[80:83] offset:20480
    ds_write_b128 v77, a[84:87] offset:21504
    ds_write_b128 v77, a[88:91] offset:22528
    ds_write_b128 v77, a[92:95] offset:23552
    ds_write_b128 v77, a[96:99] offset:24576
    ds_write_b128 v77, a[100:103] offset:25600
    ds_write_b128 v77, a[104:107] offset:26624
    ds_write_b128 v77, a[108:111] offset:27648
    ds_write_b128 v77, a[112:115] offset:28672
    ds_write_b128 v77, a[116:119] offset:29696
    ds_write_b128 v77, a[120:123] offset:30720
    ds_write_b128 v77, a[124:127] offset:31744
    s_waitcnt lgkmcnt(0)
    s_barrier
    v_add_u32 v76, 0x10000, v4
    ds_read_b64_tr_b16 a[0:1], v4
    ds_read_b64_tr_b16 a[2:3], v4 offset:1024
    ds_read_b64_tr_b16 a[64:65], v4 offset:32
    ds_read_b64_tr_b16 a[66:67], v4 offset:1056
    ds_read_b64_tr_b16 a[4:5], v4 offset:8192
    ds_read_b64_tr_b16 a[6:7], v4 offset:9216
    ds_read_b64_tr_b16 a[68:69], v4 offset:8224
    ds_read_b64_tr_b16 a[70:71], v4 offset:9248
    ds_read_b64_tr_b16 a[8:9], v4 offset:16384
    ds_read_b64_tr_b16 a[10:11], v4 offset:17408
    ds_read_b64_tr_b16 a[72:73], v4 offset:16416
    ds_read_b64_tr_b16 a[74:75], v4 offset:17440
    ds_read_b64_tr_b16 a[12:13], v4 offset:24576
    ds_read_b64_tr_b16 a[14:15], v4 offset:25600
    ds_read_b64_tr_b16 a[76:77], v4 offset:24608
    ds_read_b64_tr_b16 a[78:79], v4 offset:25632
    ds_read_b64_tr_b16 a[16:17], v4 offset:32768
    ds_read_b64_tr_b16 a[18:19], v4 offset:33792
    ds_read_b64_tr_b16 a[80:81], v4 offset:32800
    ds_read_b64_tr_b16 a[82:83], v4 offset:33824
    ds_read_b64_tr_b16 a[20:21], v4 offset:40960
    ds_read_b64_tr_b16 a[22:23], v4 offset:41984
    ds_read_b64_tr_b16 a[84:85], v4 offset:40992
    ds_read_b64_tr_b16 a[86:87], v4 offset:42016
    ds_read_b64_tr_b16 a[24:25], v4 offset:49152
    ds_read_b64_tr_b16 a[26:27], v4 offset:50176
    ds_read_b64_tr_b16 a[88:89], v4 offset:49184
    ds_read_b64_tr_b16 a[90:91], v4 offset:50208
    ds_read_b64_tr_b16 a[28:29], v4 offset:57344
    ds_read_b64_tr_b16 a[30:31], v4 offset:58368
    ds_read_b64_tr_b16 a[92:93], v4 offset:57376
    ds_read_b64_tr_b16 a[94:95], v4 offset:58400
    ds_read_b64_tr_b16 a[32:33], v76
    ds_read_b64_tr_b16 a[34:35], v76 offset:1024
    ds_read_b64_tr_b16 a[96:97], v76 offset:32
    ds_read_b64_tr_b16 a[98:99], v76 offset:1056
    ds_read_b64_tr_b16 a[36:37], v76 offset:8192
    ds_read_b64_tr_b16 a[38:39], v76 offset:9216
    ds_read_b64_tr_b16 a[100:101], v76 offset:8224
    ds_read_b64_tr_b16 a[102:103], v76 offset:9248
    ds_read_b64_tr_b16 a[40:41], v76 offset:16384
    ds_read_b64_tr_b16 a[42:43], v76 offset:17408
    ds_read_b64_tr_b16 a[104:105], v76 offset:16416
    ds_read_b64_tr_b16 a[106:107], v76 offset:17440
    ds_read_b64_tr_b16 a[44:45], v76 offset:24576
    ds_read_b64_tr_b16 a[46:47], v76 offset:25600
    ds_read_b64_tr_b16 a[108:109], v76 offset:24608
    ds_read_b64_tr_b16 a[110:111], v76 offset:25632
    ds_read_b64_tr_b16 a[48:49], v76 offset:32768
    ds_read_b64_tr_b16 a[50:51], v76 offset:33792
    ds_read_b64_tr_b16 a[112:113], v76 offset:32800
    ds_read_b64_tr_b16 a[114:115], v76 offset:33824
    ds_read_b64_tr_b16 a[52:53], v76 offset:40960
    ds_read_b64_tr_b16 a[54:55], v76 offset:41984
    ds_read_b64_tr_b16 a[116:117], v76 offset:40992
    ds_read_b64_tr_b16 a[118:119], v76 offset:42016
    ds_read_b64_tr_b16 a[56:57], v76 offset:49152
    ds_read_b64_tr_b16 a[58:59], v76 offset:50176
    ds_read_b64_tr_b16 a[120:121], v76 offset:49184
    ds_read_b64_tr_b16 a[122:123], v76 offset:50208
    ds_read_b64_tr_b16 a[60:61], v76 offset:57344
    ds_read_b64_tr_b16 a[62:63], v76 offset:58368
    ds_read_b64_tr_b16 a[124:125], v76 offset:57376
    ds_read_b64_tr_b16 a[126:127], v76 offset:58400
    s_waitcnt lgkmcnt(0)
    s_waitcnt lgkmcnt(0)
    s_barrier
    s_mul_i32 s70, s52, 0x7000
    v_add_u32 v77, s70, v3
    s_waitcnt vmcnt(41)
    ds_write_b128 v77, a[128:131]
    s_waitcnt vmcnt(40)
    ds_write_b128 v77, a[132:135] offset:1024
    s_waitcnt vmcnt(39)
    ds_write_b128 v77, a[136:139] offset:2048
    s_waitcnt vmcnt(38)
    ds_write_b128 v77, a[140:143] offset:3072
    s_waitcnt vmcnt(37)
    ds_write_b128 v77, a[144:147] offset:4096
    s_waitcnt vmcnt(36)
    ds_write_b128 v77, a[148:151] offset:5120
    s_waitcnt vmcnt(35)
    ds_write_b128 v77, a[152:155] offset:6144
    s_waitcnt vmcnt(34)
    ds_write_b128 v77, a[156:159] offset:7168
    s_waitcnt vmcnt(33)
    ds_write_b128 v77, a[160:163] offset:8192
    s_waitcnt vmcnt(32)
    ds_write_b128 v77, a[164:167] offset:9216
    s_waitcnt vmcnt(31)
    ds_write_b128 v77, a[168:171] offset:10240
    s_waitcnt vmcnt(30)
    ds_write_b128 v77, a[172:175] offset:11264
    s_waitcnt vmcnt(29)
    ds_write_b128 v77, a[176:179] offset:12288
    s_waitcnt vmcnt(28)
    ds_write_b128 v77, a[180:183] offset:13312
    s_waitcnt vmcnt(27)
    ds_write_b128 v77, a[184:187] offset:14336
    s_waitcnt vmcnt(26)
    ds_write_b128 v77, a[188:191] offset:15360
    s_waitcnt vmcnt(25)
    ds_write_b128 v77, a[192:195] offset:16384
    s_waitcnt vmcnt(24)
    ds_write_b128 v77, a[196:199] offset:17408
    s_waitcnt vmcnt(23)
    ds_write_b128 v77, a[200:203] offset:18432
    s_waitcnt vmcnt(22)
    ds_write_b128 v77, a[204:207] offset:19456
    s_waitcnt vmcnt(21)
    ds_write_b128 v77, a[208:211] offset:20480
    s_waitcnt vmcnt(20)
    ds_write_b128 v77, a[212:215] offset:21504
    s_waitcnt vmcnt(19)
    ds_write_b128 v77, a[216:219] offset:22528
    s_waitcnt vmcnt(18)
    ds_write_b128 v77, a[220:223] offset:23552
    s_waitcnt vmcnt(17)
    ds_write_b128 v77, a[224:227] offset:24576
    s_waitcnt vmcnt(16)
    ds_write_b128 v77, a[228:231] offset:25600
    s_waitcnt vmcnt(15)
    ds_write_b128 v77, a[232:235] offset:26624
    s_waitcnt vmcnt(14)
    ds_write_b128 v77, a[236:239] offset:27648
    s_waitcnt lgkmcnt(0)
    s_barrier
    v_add_u32 v76, 0x10000, v5
    ds_read_b64_tr_b16 a[128:129], v5
    ds_read_b64_tr_b16 a[130:131], v5 offset:1024
    ds_read_b64_tr_b16 a[184:185], v5 offset:16
    ds_read_b64_tr_b16 a[186:187], v5 offset:1040
    ds_read_b64_tr_b16 a[132:133], v5 offset:8192
    ds_read_b64_tr_b16 a[134:135], v5 offset:9216
    ds_read_b64_tr_b16 a[188:189], v5 offset:8208
    ds_read_b64_tr_b16 a[190:191], v5 offset:9232
    ds_read_b64_tr_b16 a[136:137], v5 offset:16384
    ds_read_b64_tr_b16 a[138:139], v5 offset:17408
    ds_read_b64_tr_b16 a[192:193], v5 offset:16400
    ds_read_b64_tr_b16 a[194:195], v5 offset:17424
    ds_read_b64_tr_b16 a[140:141], v5 offset:24576
    ds_read_b64_tr_b16 a[142:143], v5 offset:25600
    ds_read_b64_tr_b16 a[196:197], v5 offset:24592
    ds_read_b64_tr_b16 a[198:199], v5 offset:25616
    ds_read_b64_tr_b16 a[144:145], v5 offset:32768
    ds_read_b64_tr_b16 a[146:147], v5 offset:33792
    ds_read_b64_tr_b16 a[200:201], v5 offset:32784
    ds_read_b64_tr_b16 a[202:203], v5 offset:33808
    ds_read_b64_tr_b16 a[148:149], v5 offset:40960
    ds_read_b64_tr_b16 a[150:151], v5 offset:41984
    ds_read_b64_tr_b16 a[204:205], v5 offset:40976
    ds_read_b64_tr_b16 a[206:207], v5 offset:42000
    ds_read_b64_tr_b16 a[152:153], v5 offset:49152
    ds_read_b64_tr_b16 a[154:155], v5 offset:50176
    ds_read_b64_tr_b16 a[208:209], v5 offset:49168
    ds_read_b64_tr_b16 a[210:211], v5 offset:50192
    ds_read_b64_tr_b16 a[156:157], v5 offset:57344
    ds_read_b64_tr_b16 a[158:159], v5 offset:58368
    ds_read_b64_tr_b16 a[212:213], v5 offset:57360
    ds_read_b64_tr_b16 a[214:215], v5 offset:58384
    ds_read_b64_tr_b16 a[160:161], v76
    ds_read_b64_tr_b16 a[162:163], v76 offset:1024
    ds_read_b64_tr_b16 a[216:217], v76 offset:16
    ds_read_b64_tr_b16 a[218:219], v76 offset:1040
    ds_read_b64_tr_b16 a[164:165], v76 offset:8192
    ds_read_b64_tr_b16 a[166:167], v76 offset:9216
    ds_read_b64_tr_b16 a[220:221], v76 offset:8208
    ds_read_b64_tr_b16 a[222:223], v76 offset:9232
    ds_read_b64_tr_b16 a[168:169], v76 offset:16384
    ds_read_b64_tr_b16 a[170:171], v76 offset:17408
    ds_read_b64_tr_b16 a[224:225], v76 offset:16400
    ds_read_b64_tr_b16 a[226:227], v76 offset:17424
    ds_read_b64_tr_b16 a[172:173], v76 offset:24576
    ds_read_b64_tr_b16 a[174:175], v76 offset:25600
    ds_read_b64_tr_b16 a[228:229], v76 offset:24592
    ds_read_b64_tr_b16 a[230:231], v76 offset:25616
    ds_read_b64_tr_b16 a[176:177], v76 offset:32768
    ds_read_b64_tr_b16 a[178:179], v76 offset:33792
    ds_read_b64_tr_b16 a[232:233], v76 offset:32784
    ds_read_b64_tr_b16 a[234:235], v76 offset:33808
    ds_read_b64_tr_b16 a[180:181], v76 offset:40960
    ds_read_b64_tr_b16 a[182:183], v76 offset:41984
    ds_read_b64_tr_b16 a[236:237], v76 offset:40976
    ds_read_b64_tr_b16 a[238:239], v76 offset:42000
    s_waitcnt lgkmcnt(0)
    s_waitcnt lgkmcnt(0)
    s_barrier
    s_mul_i32 s70, s52, 0x3800
    v_add_u32 v77, s70, v3
    s_waitcnt vmcnt(13)
    ds_write_b128 v77, v[200:203]
    s_waitcnt vmcnt(12)
    ds_write_b128 v77, v[204:207] offset:1024
    s_waitcnt vmcnt(11)
    ds_write_b128 v77, v[208:211] offset:2048
    s_waitcnt vmcnt(10)
    ds_write_b128 v77, v[212:215] offset:3072
    s_waitcnt vmcnt(9)
    ds_write_b128 v77, v[216:219] offset:4096
    s_waitcnt vmcnt(8)
    ds_write_b128 v77, v[220:223] offset:5120
    s_waitcnt vmcnt(7)
    ds_write_b128 v77, v[224:227] offset:6144
    s_waitcnt vmcnt(6)
    ds_write_b128 v77, v[228:231] offset:7168
    s_waitcnt vmcnt(5)
    ds_write_b128 v77, v[232:235] offset:8192
    s_waitcnt vmcnt(4)
    ds_write_b128 v77, v[236:239] offset:9216
    s_waitcnt vmcnt(3)
    ds_write_b128 v77, v[240:243] offset:10240
    s_waitcnt vmcnt(2)
    ds_write_b128 v77, v[244:247] offset:11264
    s_waitcnt vmcnt(1)
    ds_write_b128 v77, v[248:251] offset:12288
    s_waitcnt vmcnt(0)
    ds_write_b128 v77, v[252:255] offset:13312
    s_waitcnt lgkmcnt(0)
    s_barrier
    ds_read_b64_tr_b16 v[200:201], v4
    ds_read_b64_tr_b16 v[202:203], v4 offset:1024
    ds_read_b64_tr_b16 v[228:229], v4 offset:32
    ds_read_b64_tr_b16 v[230:231], v4 offset:1056
    ds_read_b64_tr_b16 v[204:205], v4 offset:8192
    ds_read_b64_tr_b16 v[206:207], v4 offset:9216
    ds_read_b64_tr_b16 v[232:233], v4 offset:8224
    ds_read_b64_tr_b16 v[234:235], v4 offset:9248
    ds_read_b64_tr_b16 v[208:209], v4 offset:16384
    ds_read_b64_tr_b16 v[210:211], v4 offset:17408
    ds_read_b64_tr_b16 v[236:237], v4 offset:16416
    ds_read_b64_tr_b16 v[238:239], v4 offset:17440
    ds_read_b64_tr_b16 v[212:213], v4 offset:24576
    ds_read_b64_tr_b16 v[214:215], v4 offset:25600
    ds_read_b64_tr_b16 v[240:241], v4 offset:24608
    ds_read_b64_tr_b16 v[242:243], v4 offset:25632
    ds_read_b64_tr_b16 v[216:217], v4 offset:32768
    ds_read_b64_tr_b16 v[218:219], v4 offset:33792
    ds_read_b64_tr_b16 v[244:245], v4 offset:32800
    ds_read_b64_tr_b16 v[246:247], v4 offset:33824
    ds_read_b64_tr_b16 v[220:221], v4 offset:40960
    ds_read_b64_tr_b16 v[222:223], v4 offset:41984
    ds_read_b64_tr_b16 v[248:249], v4 offset:40992
    ds_read_b64_tr_b16 v[250:251], v4 offset:42016
    ds_read_b64_tr_b16 v[224:225], v4 offset:49152
    ds_read_b64_tr_b16 v[226:227], v4 offset:50176
    ds_read_b64_tr_b16 v[252:253], v4 offset:49184
    ds_read_b64_tr_b16 v[254:255], v4 offset:50208
    s_waitcnt lgkmcnt(0)
    s_waitcnt lgkmcnt(0)
    s_barrier
    s_mul_i32 s70, s52, 0x7000
    v_add_u32 v77, s70, v3
    ds_write_b128 v77, v[80:83]
    ds_write_b128 v77, v[84:87] offset:1024
    ds_write_b128 v77, v[88:91] offset:2048
    ds_write_b128 v77, v[92:95] offset:3072
    ds_write_b128 v77, v[96:99] offset:4096
    ds_write_b128 v77, v[100:103] offset:5120
    ds_write_b128 v77, v[104:107] offset:6144
    ds_write_b128 v77, v[108:111] offset:7168
    ds_write_b128 v77, v[112:115] offset:8192
    ds_write_b128 v77, v[116:119] offset:9216
    ds_write_b128 v77, v[120:123] offset:10240
    ds_write_b128 v77, v[124:127] offset:11264
    ds_write_b128 v77, v[128:131] offset:12288
    ds_write_b128 v77, v[132:135] offset:13312
    ds_write_b128 v77, v[136:139] offset:14336
    ds_write_b128 v77, v[140:143] offset:15360
    ds_write_b128 v77, v[144:147] offset:16384
    ds_write_b128 v77, v[148:151] offset:17408
    ds_write_b128 v77, v[152:155] offset:18432
    ds_write_b128 v77, v[156:159] offset:19456
    ds_write_b128 v77, v[160:163] offset:20480
    ds_write_b128 v77, v[164:167] offset:21504
    ds_write_b128 v77, v[168:171] offset:22528
    ds_write_b128 v77, v[172:175] offset:23552
    ds_write_b128 v77, v[176:179] offset:24576
    ds_write_b128 v77, v[180:183] offset:25600
    ds_write_b128 v77, v[184:187] offset:26624
    ds_write_b128 v77, v[188:191] offset:27648
    v_and_b32 v76, 3, v0
    v_lshlrev_b32 v76, 6, v76
    v_and_b32 v77, 4, v0
    v_add_u32 v76, v76, v77
L32:
    s_nop 7
    buffer_load_dword v78, v76, s[16:19], 0 offen sc1
    s_waitcnt vmcnt(0)
    v_and_b32 v79, 0xff, v78
    v_cmp_gt_u32 vcc, 32, v79
    s_cbranch_vccz L33
    s_sleep 8
    s_sub_u32 s62, s62, 1
    s_cmp_eq_u32 s62, 0
    s_cbranch_scc1 L_end
    s_branch L32
L33:
    s_nop 7
    s_waitcnt vmcnt(0) lgkmcnt(0)
    s_barrier
    s_mov_b64 s[24:25], s[98:99]
    v_cmp_gt_u32 s[98:99], 2, v6
    s_mov_b32 s61, 0
L_it:
    s_nop 7
    s_lshl_b32 s64, s61, 17
    s_lshl_b32 s65, s61, 14
    s_lshl_b32 s97, s61, 12
    s_lshl_b32 s20, s61, 11
    s_and_b32 s63, s61, 1
    s_lshl_b32 s21, s63, 13
    s_lshl_b32 s60, s63, 10
    s_lshr_b32 s23, s61, 1
    v_and_b32 v10, s23, v6
    v_min_u32 v75, 13, v6
    v_lshlrev_b32 v72, 9, v75
    v_add_u32 v72, v72, v2
    v_lshlrev_b32 v73, 3, v75
    v_cmp_gt_u32 s[68:69], 14, v6
    s_lshr_b32 s70, s52, 1
    s_mul_i32 s70, s70, 0x1c00
    s_lshl_b32 s63, s48, 14
    s_add_u32 s63, s63, s70
    s_and_b32 s70, s52, 1
    s_lshl_b32 s70, s70, 8
    s_add_u32 s63, s63, s70
    s_add_u32 s63, s63, s64
    s_add_u32 s56, s63, 0x10000
    s_lshl_b32 s70, s23, 17
    s_add_u32 s57, s56, s70
    s_lshl_b32 s63, s48, 8
    s_add_u32 s63, s63, s20
    s_add_u32 s71, s63, 0x8000
    s_lshl_b32 s70, s23, 11
    s_add_u32 s96, s71, s70
L34:
    s_nop 7
    buffer_load_dwordx2 v[28:29], v73, s[12:15], s71 offen sc1
    buffer_load_dwordx2 v[30:31], v73, s[12:15], s71 offen offset:112 sc1
    buffer_load_dwordx4 v[40:43], v72, s[12:15], s56 offen sc1
    buffer_load_dwordx4 v[44:47], v72, s[12:15], s56 offen offset:64 sc1
    buffer_load_dwordx4 v[48:51], v72, s[12:15], s56 offen offset:128 sc1
    buffer_load_dwordx4 v[52:55], v72, s[12:15], s56 offen offset:192 sc1
    buffer_load_dwordx2 v[20:21], v73, s[12:15], s96 offen sc1
    buffer_load_dwordx2 v[22:23], v73, s[12:15], s96 offen offset:112 sc1
    buffer_load_dwordx4 v[56:59], v72, s[12:15], s57 offen sc1
    buffer_load_dwordx4 v[60:63], v72, s[12:15], s57 offen offset:64 sc1
    buffer_load_dwordx4 v[64:67], v72, s[12:15], s57 offen offset:128 sc1
    buffer_load_dwordx4 v[68:71], v72, s[12:15], s57 offen offset:192 sc1
    s_waitcnt vmcnt(0)
    v_max3_u32 v74, v28, v29, v30
    v_max3_u32 v74, v74, v31, v40
    v_max3_u32 v74, v74, v41, v42
    v_max3_u32 v74, v74, v43, v44
    v_max3_u32 v74, v74, v45, v46
    v_max3_u32 v74, v74, v47, v48
    v_max3_u32 v74, v74, v49, v50
    v_max3_u32 v74, v74, v51, v52
    v_max3_u32 v74, v74, v53, v54
    v_max3_u32 v74, v74, v55, v20
    v_max3_u32 v74, v74, v21, v22
    v_max3_u32 v74, v74, v23, v56
    v_max3_u32 v74, v74, v57, v58
    v_max3_u32 v74, v74, v59, v60
    v_max3_u32 v74, v74, v61, v62
    v_max3_u32 v74, v74, v63, v64
    v_max3_u32 v74, v74, v65, v66
    v_max3_u32 v74, v74, v67, v68
    v_max3_u32 v74, v74, v69, v70
    v_max_u32 v74, v74, v71
    v_cmp_eq_u32 vcc, -1, v74
    s_cbranch_vccz L35
    s_sub_u32 s62, s62, 1
    s_cmp_eq_u32 s62, 0
    s_cbranch_scc1 L_end
    s_branch L34
L35:
    s_nop 7
    s_lshl_b32 s63, s52, 12
    v_add_u32 v77, s63, v3
    v_add_u32 v76, 0x20000, v77
    v_add_u32 v77, 0x1c000, v77
    ds_write_b128 v76, v[40:43]
    ds_write_b128 v77, v[56:59]
    ds_write_b128 v76, v[44:47] offset:1024
    ds_write_b128 v77, v[60:63] offset:1024
    ds_write_b128 v76, v[48:51] offset:2048
    ds_write_b128 v77, v[64:67] offset:2048
    ds_write_b128 v76, v[52:55] offset:3072
    ds_write_b128 v77, v[68:71] offset:3072
    s_waitcnt lgkmcnt(0)
    s_barrier
    s_cmp_ge_u32 s53, 14
    s_cbranch_scc1 L36
    s_lshl_b32 s96, s23, 14
    v_add_u32 v76, 0x20000, v3
    ds_read_b128 v[80:83], v76
    ds_read_b128 v[84:87], v76 offset:1024
    ds_read_b128 v[88:91], v76 offset:2048
    ds_read_b128 v[92:95], v76 offset:3072
    ds_read_b128 v[96:99], v76 offset:4096
    ds_read_b128 v[100:103], v76 offset:5120
    ds_read_b128 v[104:107], v76 offset:6144
    ds_read_b128 v[108:111], v76 offset:7168
    ds_read_b128 v[112:115], v76 offset:8192
    ds_read_b128 v[116:119], v76 offset:9216
    ds_read_b128 v[120:123], v76 offset:10240
    ds_read_b128 v[124:127], v76 offset:11264
    ds_read_b128 v[128:131], v76 offset:12288
    ds_read_b128 v[132:135], v76 offset:13312
    ds_read_b128 v[136:139], v76 offset:14336
    ds_read_b128 v[140:143], v76 offset:15360
    v_mov_b32 v34, v28
    v_mov_b32 v36, v30
    s_nop 0
    v_max_f32_dpp v34, v34, v34 row_ror:8 row_mask:0xf bank_mask:0xf
    v_max_f32_dpp v36, v36, v36 row_ror:8 row_mask:0xf bank_mask:0xf
    s_nop 0
    v_max_f32_dpp v34, v34, v34 row_ror:4 row_mask:0xf bank_mask:0xf
    v_max_f32_dpp v36, v36, v36 row_ror:4 row_mask:0xf bank_mask:0xf
    s_nop 0
    v_max_f32_dpp v34, v34, v34 row_ror:2 row_mask:0xf bank_mask:0xf
    v_max_f32_dpp v36, v36, v36 row_ror:2 row_mask:0xf bank_mask:0xf
    s_nop 0
    v_max_f32_dpp v34, v34, v34 row_ror:1 row_mask:0xf bank_mask:0xf
    v_max_f32_dpp v36, v36, v36 row_ror:1 row_mask:0xf bank_mask:0xf
    v_sub_f32 v32, v28, v34
    v_mul_f32 v32, v32, v8
    v_exp_f32 v32, v32
    v_sub_f32 v33, v30, v36
    v_mul_f32 v33, v33, v8
    v_exp_f32 v33, v33
    v_cndmask_b32 v32, 0, v32, s[68:69]
    v_mul_f32 v35, v32, v29
    v_cndmask_b32 v33, 0, v33, s[68:69]
    v_mul_f32 v37, v33, v31
    s_waitcnt lgkmcnt(15)
    v_mfma_f32_16x16x32_bf16 v[40:43], a[0:3], v[80:83], 0
    v_mfma_f32_16x16x32_bf16 v[48:51], a[64:67], v[80:83], 0
    s_waitcnt lgkmcnt(14)
    v_mfma_f32_16x16x32_bf16 v[40:43], a[4:7], v[84:87], v[40:43]
    v_mfma_f32_16x16x32_bf16 v[48:51], a[68:71], v[84:87], v[48:51]
    s_waitcnt lgkmcnt(13)
    v_mfma_f32_16x16x32_bf16 v[40:43], a[8:11], v[88:91], v[40:43]
    v_mfma_f32_16x16x32_bf16 v[48:51], a[72:75], v[88:91], v[48:51]
    s_waitcnt lgkmcnt(12)
    v_mfma_f32_16x16x32_bf16 v[40:43], a[12:15], v[92:95], v[40:43]
    v_mfma_f32_16x16x32_bf16 v[48:51], a[76:79], v[92:95], v[48:51]
    s_waitcnt lgkmcnt(11)
    v_mfma_f32_16x16x32_bf16 v[40:43], a[16:19], v[96:99], v[40:43]
    v_mfma_f32_16x16x32_bf16 v[48:51], a[80:83], v[96:99], v[48:51]
    s_waitcnt lgkmcnt(10)
    v_mfma_f32_16x16x32_bf16 v[40:43], a[20:23], v[100:103], v[40:43]
    v_mfma_f32_16x16x32_bf16 v[48:51], a[84:87], v[100:103], v[48:51]
    s_waitcnt lgkmcnt(9)
    v_mfma_f32_16x16x32_bf16 v[40:43], a[24:27], v[104:107], v[40:43]
    v_mfma_f32_16x16x32_bf16 v[48:51], a[88:91], v[104:107], v[48:51]
    s_waitcnt lgkmcnt(8)
    v_mfma_f32_16x16x32_bf16 v[40:43], a[28:31], v[108:111], v[40:43]
    v_mfma_f32_16x16x32_bf16 v[48:51], a[92:95], v[108:111], v[48:51]
    s_waitcnt lgkmcnt(7)
    v_mfma_f32_16x16x32_bf16 v[44:47], a[32:35], v[112:115], 0
    v_mfma_f32_16x16x32_bf16 v[52:55], a[96:99], v[112:115], 0
    s_waitcnt lgkmcnt(6)
    v_mfma_f32_16x16x32_bf16 v[44:47], a[36:39], v[116:119], v[44:47]
    v_mfma_f32_16x16x32_bf16 v[52:55], a[100:103], v[116:119], v[52:55]
    s_waitcnt lgkmcnt(5)
    v_mfma_f32_16x16x32_bf16 v[44:47], a[40:43], v[120:123], v[44:47]
    v_mfma_f32_16x16x32_bf16 v[52:55], a[104:107], v[120:123], v[52:55]
    s_waitcnt lgkmcnt(4)
    v_mfma_f32_16x16x32_bf16 v[44:47], a[44:47], v[124:127], v[44:47]
    v_mfma_f32_16x16x32_bf16 v[52:55], a[108:111], v[124:127], v[52:55]
    s_waitcnt lgkmcnt(3)
    v_mfma_f32_16x16x32_bf16 v[44:47], a[48:51], v[128:131], v[44:47]
    v_mfma_f32_16x16x32_bf16 v[52:55], a[112:115], v[128:131], v[52:55]
    s_waitcnt lgkmcnt(2)
    v_mfma_f32_16x16x32_bf16 v[44:47], a[52:55], v[132:135], v[44:47]
    v_mfma_f32_16x16x32_bf16 v[52:55], a[116:119], v[132:135], v[52:55]
    s_waitcnt lgkmcnt(1)
    v_mfma_f32_16x16x32_bf16 v[44:47], a[56:59], v[136:139], v[44:47]
    v_mfma_f32_16x16x32_bf16 v[52:55], a[120:123], v[136:139], v[52:55]
    s_waitcnt lgkmcnt(0)
    v_mfma_f32_16x16x32_bf16 v[44:47], a[60:63], v[140:143], v[44:47]
    v_mfma_f32_16x16x32_bf16 v[52:55], a[124:127], v[140:143], v[52:55]
    v_add_f32_dpp v35, v35, v35 row_ror:8 row_mask:0xf bank_mask:0xf
    v_add_f32_dpp v37, v37, v37 row_ror:8 row_mask:0xf bank_mask:0xf
    s_nop 0
    v_add_f32_dpp v35, v35, v35 row_ror:4 row_mask:0xf bank_mask:0xf
    v_add_f32_dpp v37, v37, v37 row_ror:4 row_mask:0xf bank_mask:0xf
    s_nop 0
    v_add_f32_dpp v35, v35, v35 row_ror:2 row_mask:0xf bank_mask:0xf
    v_add_f32_dpp v37, v37, v37 row_ror:2 row_mask:0xf bank_mask:0xf
    s_nop 0
    v_add_f32_dpp v35, v35, v35 row_ror:1 row_mask:0xf bank_mask:0xf
    v_add_f32_dpp v37, v37, v37 row_ror:1 row_mask:0xf bank_mask:0xf
    v_rcp_f32 v35, v35
    v_rcp_f32 v37, v37
    v_mul_f32 v32, v32, v35
    v_mul_f32 v33, v33, v37
    v_mul_f32 v56, v40, v32
    v_fmac_f32 v56, v44, v33
    v_mul_f32 v57, v41, v32
    v_fmac_f32 v57, v45, v33
    v_mul_f32 v58, v42, v32
    v_fmac_f32 v58, v46, v33
    v_mul_f32 v59, v43, v32
    v_fmac_f32 v59, v47, v33
    v_mul_f32 v60, v48, v32
    v_fmac_f32 v60, v52, v33
    v_mul_f32 v61, v49, v32
    v_fmac_f32 v61, v53, v33
    v_mul_f32 v62, v50, v32
    v_fmac_f32 v62, v54, v33
    v_mul_f32 v63, v51, v32
    v_fmac_f32 v63, v55, v33
    v_add_f32_dpp v56, v56, v56 row_ror:8 row_mask:0xf bank_mask:0xf
    v_add_f32_dpp v57, v57, v57 row_ror:8 row_mask:0xf bank_mask:0xf
    v_add_f32_dpp v58, v58, v58 row_ror:8 row_mask:0xf bank_mask:0xf
    v_add_f32_dpp v59, v59, v59 row_ror:8 row_mask:0xf bank_mask:0xf
    v_add_f32_dpp v60, v60, v60 row_ror:8 row_mask:0xf bank_mask:0xf
    v_add_f32_dpp v61, v61, v61 row_ror:8 row_mask:0xf bank_mask:0xf
    v_add_f32_dpp v62, v62, v62 row_ror:8 row_mask:0xf bank_mask:0xf
    v_add_f32_dpp v63, v63, v63 row_ror:8 row_mask:0xf bank_mask:0xf
    v_add_f32_dpp v56, v56, v56 row_ror:4 row_mask:0xf bank_mask:0xf
    v_add_f32_dpp v57, v57, v57 row_ror:4 row_mask:0xf bank_mask:0xf
    v_add_f32_dpp v58, v58, v58 row_ror:4 row_mask:0xf bank_mask:0xf
    v_add_f32_dpp v59, v59, v59 row_ror:4 row_mask:0xf bank_mask:0xf
    v_add_f32_dpp v60, v60, v60 row_ror:4 row_mask:0xf bank_mask:0xf
    v_add_f32_dpp v61, v61, v61 row_ror:4 row_mask:0xf bank_mask:0xf
    v_add_f32_dpp v62, v62, v62 row_ror:4 row_mask:0xf bank_mask:0xf
    v_add_f32_dpp v63, v63, v63 row_ror:4 row_mask:0xf bank_mask:0xf
    v_add_f32_dpp v56, v56, v56 row_ror:2 row_mask:0xf bank_mask:0xf
    v_add_f32_dpp v57, v57, v57 row_ror:2 row_mask:0xf bank_mask:0xf
    v_add_f32_dpp v58, v58, v58 row_ror:2 row_mask:0xf bank_mask:0xf
    v_add_f32_dpp v59, v59, v59 row_ror:2 row_mask:0xf bank_mask:0xf
    v_add_f32_dpp v60, v60, v60 row_ror:2 row_mask:0xf bank_mask:0xf
    v_add_f32_dpp v61, v61, v61 row_ror:2 row_mask:0xf bank_mask:0xf
    v_add_f32_dpp v62, v62, v62 row_ror:2 row_mask:0xf bank_mask:0xf
    v_add_f32_dpp v63, v63, v63 row_ror:2 row_mask:0xf bank_mask:0xf
    v_add_f32_dpp v56, v56, v56 row_ror:1 row_mask:0xf bank_mask:0xf
    v_add_f32_dpp v57, v57, v57 row_ror:1 row_mask:0xf bank_mask:0xf
    v_add_f32_dpp v58, v58, v58 row_ror:1 row_mask:0xf bank_mask:0xf
    v_add_f32_dpp v59, v59, v59 row_ror:1 row_mask:0xf bank_mask:0xf
    v_add_f32_dpp v60, v60, v60 row_ror:1 row_mask:0xf bank_mask:0xf
    v_add_f32_dpp v61, v61, v61 row_ror:1 row_mask:0xf bank_mask:0xf
    v_add_f32_dpp v62, v62, v62 row_ror:1 row_mask:0xf bank_mask:0xf
    v_add_f32_dpp v63, v63, v63 row_ror:1 row_mask:0xf bank_mask:0xf
    s_lshl_b32 s63, s48, 11
    s_lshl_b32 s70, s53, 7
    s_add_u32 s63, s63, s70
    s_add_u32 s63, s63, s65
    s_add_u32 s63, s63, 0x90000
    s_mov_b64 exec, s[24:25]
    buffer_store_dwordx4 v[56:59], v2, s[12:15], s63 offen sc1
    buffer_store_dwordx4 v[60:63], v2, s[12:15], s63 offen offset:64 sc1
    s_mov_b64 exec, -1
    s_cmp_eq_u32 s23, 0
    s_cbranch_scc1 L36
    v_add_u32 v76, 0x1c000, v3
    ds_read_b128 v[80:83], v76
    ds_read_b128 v[84:87], v76 offset:1024
    ds_read_b128 v[88:91], v76 offset:2048
    ds_read_b128 v[92:95], v76 offset:3072
    ds_read_b128 v[96:99], v76 offset:4096
    ds_read_b128 v[100:103], v76 offset:5120
    ds_read_b128 v[104:107], v76 offset:6144
    ds_read_b128 v[108:111], v76 offset:7168
    ds_read_b128 v[112:115], v76 offset:8192
    ds_read_b128 v[116:119], v76 offset:9216
    ds_read_b128 v[120:123], v76 offset:10240
    ds_read_b128 v[124:127], v76 offset:11264
    ds_read_b128 v[128:131], v76 offset:12288
    ds_read_b128 v[132:135], v76 offset:13312
    ds_read_b128 v[136:139], v76 offset:14336
    ds_read_b128 v[140:143], v76 offset:15360
    v_mov_b32 v34, v20
    v_mov_b32 v36, v22
    s_nop 0
    v_max_f32_dpp v34, v34, v34 row_ror:8 row_mask:0xf bank_mask:0xf
    v_max_f32_dpp v36, v36, v36 row_ror:8 row_mask:0xf bank_mask:0xf
    s_nop 0
    v_max_f32_dpp v34, v34, v34 row_ror:4 row_mask:0xf bank_mask:0xf
    v_max_f32_dpp v36, v36, v36 row_ror:4 row_mask:0xf bank_mask:0xf
    s_nop 0
    v_max_f32_dpp v34, v34, v34 row_ror:2 row_mask:0xf bank_mask:0xf
    v_max_f32_dpp v36, v36, v36 row_ror:2 row_mask:0xf bank_mask:0xf
    s_nop 0
    v_max_f32_dpp v34, v34, v34 row_ror:1 row_mask:0xf bank_mask:0xf
    v_max_f32_dpp v36, v36, v36 row_ror:1 row_mask:0xf bank_mask:0xf
    v_sub_f32 v32, v20, v34
    v_mul_f32 v32, v32, v8
    v_exp_f32 v32, v32
    v_sub_f32 v33, v22, v36
    v_mul_f32 v33, v33, v8
    v_exp_f32 v33, v33
    v_cndmask_b32 v32, 0, v32, s[68:69]
    v_mul_f32 v35, v32, v21
    v_cndmask_b32 v33, 0, v33, s[68:69]
    v_mul_f32 v37, v33, v23
    s_waitcnt lgkmcnt(15)
    v_mfma_f32_16x16x32_bf16 v[40:43], a[0:3], v[80:83], 0
    v_mfma_f32_16x16x32_bf16 v[48:51], a[64:67], v[80:83], 0
    s_waitcnt lgkmcnt(14)
    v_mfma_f32_16x16x32_bf16 v[40:43], a[4:7], v[84:87], v[40:43]
    v_mfma_f32_16x16x32_bf16 v[48:51], a[68:71], v[84:87], v[48:51]
    s_waitcnt lgkmcnt(13)
    v_mfma_f32_16x16x32_bf16 v[40:43], a[8:11], v[88:91], v[40:43]
    v_mfma_f32_16x16x32_bf16 v[48:51], a[72:75], v[88:91], v[48:51]
    s_waitcnt lgkmcnt(12)
    v_mfma_f32_16x16x32_bf16 v[40:43], a[12:15], v[92:95], v[40:43]
    v_mfma_f32_16x16x32_bf16 v[48:51], a[76:79], v[92:95], v[48:51]
    s_waitcnt lgkmcnt(11)
    v_mfma_f32_16x16x32_bf16 v[40:43], a[16:19], v[96:99], v[40:43]
    v_mfma_f32_16x16x32_bf16 v[48:51], a[80:83], v[96:99], v[48:51]
    s_waitcnt lgkmcnt(10)
    v_mfma_f32_16x16x32_bf16 v[40:43], a[20:23], v[100:103], v[40:43]
    v_mfma_f32_16x16x32_bf16 v[48:51], a[84:87], v[100:103], v[48:51]
    s_waitcnt lgkmcnt(9)
    v_mfma_f32_16x16x32_bf16 v[40:43], a[24:27], v[104:107], v[40:43]
    v_mfma_f32_16x16x32_bf16 v[48:51], a[88:91], v[104:107], v[48:51]
    s_waitcnt lgkmcnt(8)
    v_mfma_f32_16x16x32_bf16 v[40:43], a[28:31], v[108:111], v[40:43]
    v_mfma_f32_16x16x32_bf16 v[48:51], a[92:95], v[108:111], v[48:51]
    s_waitcnt lgkmcnt(7)
    v_mfma_f32_16x16x32_bf16 v[44:47], a[32:35], v[112:115], 0
    v_mfma_f32_16x16x32_bf16 v[52:55], a[96:99], v[112:115], 0
    s_waitcnt lgkmcnt(6)
    v_mfma_f32_16x16x32_bf16 v[44:47], a[36:39], v[116:119], v[44:47]
    v_mfma_f32_16x16x32_bf16 v[52:55], a[100:103], v[116:119], v[52:55]
    s_waitcnt lgkmcnt(5)
    v_mfma_f32_16x16x32_bf16 v[44:47], a[40:43], v[120:123], v[44:47]
    v_mfma_f32_16x16x32_bf16 v[52:55], a[104:107], v[120:123], v[52:55]
    s_waitcnt lgkmcnt(4)
    v_mfma_f32_16x16x32_bf16 v[44:47], a[44:47], v[124:127], v[44:47]
    v_mfma_f32_16x16x32_bf16 v[52:55], a[108:111], v[124:127], v[52:55]
    s_waitcnt lgkmcnt(3)
    v_mfma_f32_16x16x32_bf16 v[44:47], a[48:51], v[128:131], v[44:47]
    v_mfma_f32_16x16x32_bf16 v[52:55], a[112:115], v[128:131], v[52:55]
    s_waitcnt lgkmcnt(2)
    v_mfma_f32_16x16x32_bf16 v[44:47], a[52:55], v[132:135], v[44:47]
    v_mfma_f32_16x16x32_bf16 v[52:55], a[116:119], v[132:135], v[52:55]
    s_waitcnt lgkmcnt(1)
    v_mfma_f32_16x16x32_bf16 v[44:47], a[56:59], v[136:139], v[44:47]
    v_mfma_f32_16x16x32_bf16 v[52:55], a[120:123], v[136:139], v[52:55]
    s_waitcnt lgkmcnt(0)
    v_mfma_f32_16x16x32_bf16 v[44:47], a[60:63], v[140:143], v[44:47]
    v_mfma_f32_16x16x32_bf16 v[52:55], a[124:127], v[140:143], v[52:55]
    v_add_f32_dpp v35, v35, v35 row_ror:8 row_mask:0xf bank_mask:0xf
    v_add_f32_dpp v37, v37, v37 row_ror:8 row_mask:0xf bank_mask:0xf
    s_nop 0
    v_add_f32_dpp v35, v35, v35 row_ror:4 row_mask:0xf bank_mask:0xf
    v_add_f32_dpp v37, v37, v37 row_ror:4 row_mask:0xf bank_mask:0xf
    s_nop 0
    v_add_f32_dpp v35, v35, v35 row_ror:2 row_mask:0xf bank_mask:0xf
    v_add_f32_dpp v37, v37, v37 row_ror:2 row_mask:0xf bank_mask:0xf
    s_nop 0
    v_add_f32_dpp v35, v35, v35 row_ror:1 row_mask:0xf bank_mask:0xf
    v_add_f32_dpp v37, v37, v37 row_ror:1 row_mask:0xf bank_mask:0xf
    v_rcp_f32 v35, v35
    v_rcp_f32 v37, v37
    v_mul_f32 v32, v32, v35
    v_mul_f32 v33, v33, v37
    v_mul_f32 v64, v40, v32
    v_fmac_f32 v64, v44, v33
    v_mul_f32 v65, v41, v32
    v_fmac_f32 v65, v45, v33
    v_mul_f32 v66, v42, v32
    v_fmac_f32 v66, v46, v33
    v_mul_f32 v67, v43, v32
    v_fmac_f32 v67, v47, v33
    v_mul_f32 v68, v48, v32
    v_fmac_f32 v68, v52, v33
    v_mul_f32 v69, v49, v32
    v_fmac_f32 v69, v53, v33
    v_mul_f32 v70, v50, v32
    v_fmac_f32 v70, v54, v33
    v_mul_f32 v71, v51, v32
    v_fmac_f32 v71, v55, v33
    v_add_f32_dpp v64, v64, v64 row_ror:8 row_mask:0xf bank_mask:0xf
    v_add_f32_dpp v65, v65, v65 row_ror:8 row_mask:0xf bank_mask:0xf
    v_add_f32_dpp v66, v66, v66 row_ror:8 row_mask:0xf bank_mask:0xf
    v_add_f32_dpp v67, v67, v67 row_ror:8 row_mask:0xf bank_mask:0xf
    v_add_f32_dpp v68, v68, v68 row_ror:8 row_mask:0xf bank_mask:0xf
    v_add_f32_dpp v69, v69, v69 row_ror:8 row_mask:0xf bank_mask:0xf
    v_add_f32_dpp v70, v70, v70 row_ror:8 row_mask:0xf bank_mask:0xf
    v_add_f32_dpp v71, v71, v71 row_ror:8 row_mask:0xf bank_mask:0xf
    v_add_f32_dpp v64, v64, v64 row_ror:4 row_mask:0xf bank_mask:0xf
    v_add_f32_dpp v65, v65, v65 row_ror:4 row_mask:0xf bank_mask:0xf
    v_add_f32_dpp v66, v66, v66 row_ror:4 row_mask:0xf bank_mask:0xf
    v_add_f32_dpp v67, v67, v67 row_ror:4 row_mask:0xf bank_mask:0xf
    v_add_f32_dpp v68, v68, v68 row_ror:4 row_mask:0xf bank_mask:0xf
    v_add_f32_dpp v69, v69, v69 row_ror:4 row_mask:0xf bank_mask:0xf
    v_add_f32_dpp v70, v70, v70 row_ror:4 row_mask:0xf bank_mask:0xf
    v_add_f32_dpp v71, v71, v71 row_ror:4 row_mask:0xf bank_mask:0xf
    v_add_f32_dpp v64, v64, v64 row_ror:2 row_mask:0xf bank_mask:0xf
    v_add_f32_dpp v65, v65, v65 row_ror:2 row_mask:0xf bank_mask:0xf
    v_add_f32_dpp v66, v66, v66 row_ror:2 row_mask:0xf bank_mask:0xf
    v_add_f32_dpp v67, v67, v67 row_ror:2 row_mask:0xf bank_mask:0xf
    v_add_f32_dpp v68, v68, v68 row_ror:2 row_mask:0xf bank_mask:0xf
    v_add_f32_dpp v69, v69, v69 row_ror:2 row_mask:0xf bank_mask:0xf
    v_add_f32_dpp v70, v70, v70 row_ror:2 row_mask:0xf bank_mask:0xf
    v_add_f32_dpp v71, v71, v71 row_ror:2 row_mask:0xf bank_mask:0xf
    v_add_f32_dpp v64, v64, v64 row_ror:1 row_mask:0xf bank_mask:0xf
    v_add_f32_dpp v65, v65, v65 row_ror:1 row_mask:0xf bank_mask:0xf
    v_add_f32_dpp v66, v66, v66 row_ror:1 row_mask:0xf bank_mask:0xf
    v_add_f32_dpp v67, v67, v67 row_ror:1 row_mask:0xf bank_mask:0xf
    v_add_f32_dpp v68, v68, v68 row_ror:1 row_mask:0xf bank_mask:0xf
    v_add_f32_dpp v69, v69, v69 row_ror:1 row_mask:0xf bank_mask:0xf
    v_add_f32_dpp v70, v70, v70 row_ror:1 row_mask:0xf bank_mask:0xf
    v_add_f32_dpp v71, v71, v71 row_ror:1 row_mask:0xf bank_mask:0xf
    s_lshl_b32 s63, s48, 11
    s_lshl_b32 s70, s53, 7
    s_add_u32 s63, s63, s70
    s_add_u32 s63, s63, s65
    s_add_u32 s63, s63, 0x90000
    s_add_u32 s63, s63, s96
    s_mov_b64 exec, s[24:25]
    buffer_store_dwordx4 v[64:67], v2, s[12:15], s63 offen sc1
    buffer_store_dwordx4 v[68:71], v2, s[12:15], s63 offen offset:64 sc1
    s_mov_b64 exec, -1
L36:
    s_nop 7
    s_waitcnt lgkmcnt(0)
    s_barrier
    s_lshl_b32 s63, s52, 12
    s_add_u32 s63, s63, s65
    s_add_u32 s56, s63, 0x90000
    s_lshl_b32 s70, s23, 14
    s_add_u32 s57, s56, s70
    v_add_u32 v77, s55, v1
    v_add_u32 v77, s60, v77
    ds_read_b64 v[12:13], v77 offset:2048
    ds_read_b64 v[16:17], v77 offset:2560
    v_add_u32 v77, s55, v1
    v_add_u32 v77, s60, v77
    s_lshl_b32 s63, s23, 10
    v_add_u32 v77, s63, v77
    ds_read_b64 v[20:21], v77 offset:2048
    ds_read_b64 v[24:25], v77 offset:2560
    s_waitcnt lgkmcnt(0)
    v_and_b32 v15, 0xffff0000, v13
    v_lshlrev_b32 v14, 16, v13
    v_and_b32 v19, 0xffff0000, v17
    v_lshlrev_b32 v18, 16, v17
    v_and_b32 v13, 0xffff0000, v12
    v_lshlrev_b32 v12, 16, v12
    v_and_b32 v17, 0xffff0000, v16
    v_lshlrev_b32 v16, 16, v16
    v_and_b32 v23, 0xffff0000, v21
    v_lshlrev_b32 v22, 16, v21
    v_and_b32 v27, 0xffff0000, v25
    v_lshlrev_b32 v26, 16, v25
    v_and_b32 v21, 0xffff0000, v20
    v_lshlrev_b32 v20, 16, v20
    v_and_b32 v25, 0xffff0000, v24
    v_lshlrev_b32 v24, 16, v24
L37:
    s_nop 7
    buffer_load_dwordx4 v[40:43], v3, s[12:15], s56 offen sc1
    buffer_load_dwordx4 v[44:47], v3, s[12:15], s56 offen offset:1024 sc1
    buffer_load_dwordx4 v[48:51], v3, s[12:15], s56 offen offset:2048 sc1
    buffer_load_dwordx4 v[52:55], v3, s[12:15], s56 offen offset:3072 sc1
    buffer_load_dwordx4 v[192:195], v3, s[12:15], s57 offen sc1
    buffer_load_dwordx4 v[196:199], v3, s[12:15], s57 offen offset:1024 sc1
    buffer_load_dwordx4 v[28:31], v3, s[12:15], s57 offen offset:2048 sc1
    buffer_load_dwordx4 v[32:35], v3, s[12:15], s57 offen offset:3072 sc1
    s_waitcnt vmcnt(0)
    v_max3_u32 v74, v40, v41, v42
    v_max3_u32 v74, v74, v43, v44
    v_max3_u32 v74, v74, v45, v46
    v_max3_u32 v74, v74, v47, v48
    v_max3_u32 v74, v74, v49, v50
    v_max3_u32 v74, v74, v51, v52
    v_max3_u32 v74, v74, v53, v54
    v_max3_u32 v74, v74, v55, v192
    v_max3_u32 v74, v74, v193, v194
    v_max3_u32 v74, v74, v195, v196
    v_max3_u32 v74, v74, v197, v198
    v_max3_u32 v74, v74, v199, v28
    v_max3_u32 v74, v74, v29, v30
    v_max3_u32 v74, v74, v31, v32
    v_max3_u32 v74, v74, v33, v34
    v_max_u32 v74, v74, v35
    v_cmp_eq_u32 vcc, -1, v74
    s_cbranch_vccz L38
    s_sub_u32 s62, s62, 1
    s_cmp_eq_u32 s62, 0
    s_cbranch_scc1 L_end
    s_branch L37
L38:
    s_nop 7
    s_lshl_b32 s63, s52, 11
    s_add_u32 s63, s63, 0x20000
    v_add_u32 v77, s63, v3
    v_add_f32 v40, v40, v48
    v_add_f32 v41, v41, v49
    v_add_f32 v42, v42, v50
    v_add_f32 v43, v43, v51
    ds_write_b128 v77, v[40:43]
    v_add_f32 v44, v44, v52
    v_add_f32 v45, v45, v53
    v_add_f32 v46, v46, v54
    v_add_f32 v47, v47, v55
    ds_write_b128 v77, v[44:47] offset:1024
    v_add_f32 v192, v192, v28
    v_add_f32 v193, v193, v29
    v_add_f32 v194, v194, v30
    v_add_f32 v195, v195, v31
    ds_write_b128 v77, v[192:195] offset:8192
    v_add_f32 v196, v196, v32
    v_add_f32 v197, v197, v33
    v_add_f32 v198, v198, v34
    v_add_f32 v199, v199, v35
    ds_write_b128 v77, v[196:199] offset:9216
    s_waitcnt lgkmcnt(0)
    s_barrier
    v_add_u32 v76, 0x20000, v3
    ds_read_b128 v[40:43], v76
    ds_read_b128 v[44:47], v76 offset:1024
    ds_read_b128 v[48:51], v76 offset:2048
    ds_read_b128 v[52:55], v76 offset:3072
    ds_read_b128 v[56:59], v76 offset:4096
    ds_read_b128 v[60:63], v76 offset:5120
    ds_read_b128 v[64:67], v76 offset:6144
    ds_read_b128 v[68:71], v76 offset:7168
    s_waitcnt lgkmcnt(0)
    v_add_f32 v40, v40, v48
    v_add_f32 v41, v41, v49
    v_add_f32 v42, v42, v50
    v_add_f32 v43, v43, v51
    v_add_f32 v44, v44, v52
    v_add_f32 v45, v45, v53
    v_add_f32 v46, v46, v54
    v_add_f32 v47, v47, v55
    v_add_f32 v40, v40, v56
    v_add_f32 v41, v41, v57
    v_add_f32 v42, v42, v58
    v_add_f32 v43, v43, v59
    v_add_f32 v44, v44, v60
    v_add_f32 v45, v45, v61
    v_add_f32 v46, v46, v62
    v_add_f32 v47, v47, v63
    v_add_f32 v40, v40, v64
    v_add_f32 v41, v41, v65
    v_add_f32 v42, v42, v66
    v_add_f32 v43, v43, v67
    v_add_f32 v44, v44, v68
    v_add_f32 v45, v45, v69
    v_add_f32 v46, v46, v70
    v_add_f32 v47, v47, v71
    v_cvt_pk_bf16_f32 v72, v40, v41
    v_lshlrev_b32 v40, 16, v72
    v_and_b32 v41, 0xffff0000, v72
    v_cvt_pk_bf16_f32 v72, v42, v43
    v_lshlrev_b32 v42, 16, v72
    v_and_b32 v43, 0xffff0000, v72
    v_cvt_pk_bf16_f32 v72, v44, v45
    v_lshlrev_b32 v44, 16, v72
    v_and_b32 v45, 0xffff0000, v72
    v_cvt_pk_bf16_f32 v72, v46, v47
    v_lshlrev_b32 v46, 16, v72
    v_and_b32 v47, 0xffff0000, v72
    v_add_f32 v12, v12, v40
    v_add_f32 v13, v13, v41
    v_add_f32 v14, v14, v42
    v_add_f32 v15, v15, v43
    v_add_f32 v16, v16, v44
    v_add_f32 v17, v17, v45
    v_add_f32 v18, v18, v46
    v_add_f32 v19, v19, v47
    v_cvt_pk_bf16_f32 v72, v12, v13
    v_lshlrev_b32 v12, 16, v72
    v_and_b32 v13, 0xffff0000, v72
    v_cvt_pk_bf16_f32 v72, v14, v15
    v_lshlrev_b32 v14, 16, v72
    v_and_b32 v15, 0xffff0000, v72
    v_cvt_pk_bf16_f32 v72, v16, v17
    v_lshlrev_b32 v16, 16, v72
    v_and_b32 v17, 0xffff0000, v72
    v_cvt_pk_bf16_f32 v72, v18, v19
    v_lshlrev_b32 v18, 16, v72
    v_and_b32 v19, 0xffff0000, v72
    v_add_u32 v77, s55, v1
    v_add_u32 v77, s60, v77
    v_cvt_pk_bf16_f32 v72, v12, v13
    v_cvt_pk_bf16_f32 v73, v14, v15
    v_cvt_pk_bf16_f32 v74, v16, v17
    v_cvt_pk_bf16_f32 v75, v18, v19
    ds_write_b64 v77, v[72:73] offset:2048
    ds_write_b64 v77, v[74:75] offset:2560
    ds_read_b128 v[40:43], v76 offset:8192
    ds_read_b128 v[44:47], v76 offset:9216
    ds_read_b128 v[48:51], v76 offset:10240
    ds_read_b128 v[52:55], v76 offset:11264
    ds_read_b128 v[56:59], v76 offset:12288
    ds_read_b128 v[60:63], v76 offset:13312
    ds_read_b128 v[64:67], v76 offset:14336
    ds_read_b128 v[68:71], v76 offset:15360
    s_waitcnt lgkmcnt(0)
    v_add_f32 v40, v40, v48
    v_add_f32 v41, v41, v49
    v_add_f32 v42, v42, v50
    v_add_f32 v43, v43, v51
    v_add_f32 v44, v44, v52
    v_add_f32 v45, v45, v53
    v_add_f32 v46, v46, v54
    v_add_f32 v47, v47, v55
    v_add_f32 v40, v40, v56
    v_add_f32 v41, v41, v57
    v_add_f32 v42, v42, v58
    v_add_f32 v43, v43, v59
    v_add_f32 v44, v44, v60
    v_add_f32 v45, v45, v61
    v_add_f32 v46, v46, v62
    v_add_f32 v47, v47, v63
    v_add_f32 v40, v40, v64
    v_add_f32 v41, v41, v65
    v_add_f32 v42, v42, v66
    v_add_f32 v43, v43, v67
    v_add_f32 v44, v44, v68
    v_add_f32 v45, v45, v69
    v_add_f32 v46, v46, v70
    v_add_f32 v47, v47, v71
    v_cvt_pk_bf16_f32 v72, v40, v41
    v_lshlrev_b32 v40, 16, v72
    v_and_b32 v41, 0xffff0000, v72
    v_cvt_pk_bf16_f32 v72, v42, v43
    v_lshlrev_b32 v42, 16, v72
    v_and_b32 v43, 0xffff0000, v72
    v_cvt_pk_bf16_f32 v72, v44, v45
    v_lshlrev_b32 v44, 16, v72
    v_and_b32 v45, 0xffff0000, v72
    v_cvt_pk_bf16_f32 v72, v46, v47
    v_lshlrev_b32 v46, 16, v72
    v_and_b32 v47, 0xffff0000, v72
    v_add_f32 v20, v20, v40
    v_add_f32 v21, v21, v41
    v_add_f32 v22, v22, v42
    v_add_f32 v23, v23, v43
    v_add_f32 v24, v24, v44
    v_add_f32 v25, v25, v45
    v_add_f32 v26, v26, v46
    v_add_f32 v27, v27, v47
    v_cvt_pk_bf16_f32 v72, v20, v21
    v_lshlrev_b32 v20, 16, v72
    v_and_b32 v21, 0xffff0000, v72
    v_cvt_pk_bf16_f32 v72, v22, v23
    v_lshlrev_b32 v22, 16, v72
    v_and_b32 v23, 0xffff0000, v72
    v_cvt_pk_bf16_f32 v72, v24, v25
    v_lshlrev_b32 v24, 16, v72
    v_and_b32 v25, 0xffff0000, v72
    v_cvt_pk_bf16_f32 v72, v26, v27
    v_lshlrev_b32 v26, 16, v72
    v_and_b32 v27, 0xffff0000, v72
    v_add_u32 v77, s55, v1
    v_add_u32 v77, s60, v77
    s_lshl_b32 s63, s23, 10
    v_add_u32 v77, s63, v77
    v_cvt_pk_bf16_f32 v72, v20, v21
    v_cvt_pk_bf16_f32 v73, v22, v23
    v_cvt_pk_bf16_f32 v74, v24, v25
    v_cvt_pk_bf16_f32 v75, v26, v27
    ds_write_b64 v77, v[72:73] offset:2048
    ds_write_b64 v77, v[74:75] offset:2560
    s_cmp_ge_u32 s53, 14
    s_cbranch_scc1 L39
    v_add_f32 v36, v12, v13
    v_add_f32 v36, v36, v14
    v_add_f32 v36, v36, v15
    v_add_f32 v36, v36, v16
    v_add_f32 v36, v36, v17
    v_add_f32 v36, v36, v18
    v_add_f32 v36, v36, v19
    s_nop 1
    v_add_f32_dpp v36, v36, v36 row_ror:8 row_mask:0xf bank_mask:0xf
    s_nop 1
    v_add_f32_dpp v36, v36, v36 row_ror:4 row_mask:0xf bank_mask:0xf
    s_nop 1
    v_add_f32_dpp v36, v36, v36 row_ror:2 row_mask:0xf bank_mask:0xf
    s_nop 1
    v_add_f32_dpp v36, v36, v36 row_ror:1 row_mask:0xf bank_mask:0xf
    s_nop 1
    v_add_f32_dpp v36, v36, v36 row_bcast:15 row_mask:0xa bank_mask:0xf
    s_nop 1
    v_add_f32_dpp v36, v36, v36 row_bcast:31 row_mask:0xc bank_mask:0xf
    s_nop 0
    v_readlane_b32 s63, v36, 63
    v_mov_b32 v37, 0x3b124925
    s_nop 0
    v_mul_f32 v37, s63, v37
    v_sub_f32 v28, v12, v37
    v_sub_f32 v29, v13, v37
    v_sub_f32 v30, v14, v37
    v_sub_f32 v31, v15, v37
    v_sub_f32 v32, v16, v37
    v_sub_f32 v33, v17, v37
    v_sub_f32 v34, v18, v37
    v_sub_f32 v35, v19, v37
    v_cndmask_b32 v32, 0, v32, s[66:67]
    v_cndmask_b32 v33, 0, v33, s[66:67]
    v_cndmask_b32 v34, 0, v34, s[66:67]
    v_cndmask_b32 v35, 0, v35, s[66:67]
    v_mul_f32 v36, v28, v28
    v_fmac_f32 v36, v29, v29
    v_fmac_f32 v36, v30, v30
    v_fmac_f32 v36, v31, v31
    v_fmac_f32 v36, v32, v32
    v_fmac_f32 v36, v33, v33
    v_fmac_f32 v36, v34, v34
    v_fmac_f32 v36, v35, v35
    s_nop 1
    v_add_f32_dpp v36, v36, v36 row_ror:8 row_mask:0xf bank_mask:0xf
    s_nop 1
    v_add_f32_dpp v36, v36, v36 row_ror:4 row_mask:0xf bank_mask:0xf
    s_nop 1
    v_add_f32_dpp v36, v36, v36 row_ror:2 row_mask:0xf bank_mask:0xf
    s_nop 1
    v_add_f32_dpp v36, v36, v36 row_ror:1 row_mask:0xf bank_mask:0xf
    s_nop 1
    v_add_f32_dpp v36, v36, v36 row_bcast:15 row_mask:0xa bank_mask:0xf
    s_nop 1
    v_add_f32_dpp v36, v36, v36 row_bcast:31 row_mask:0xc bank_mask:0xf
    s_nop 0
    v_readlane_b32 s63, v36, 63
    v_mov_b32 v37, 0x3b124925
    v_mov_b32 v36, 0x3727c5ac
    v_fma_f32 v37, s63, v37, v36
    v_rsq_f32 v37, v37
    s_nop 0
    v_mul_f32 v28, v28, v37
    v_mul_f32 v29, v29, v37
    v_mul_f32 v30, v30, v37
    v_mul_f32 v31, v31, v37
    v_mul_f32 v32, v32, v37
    v_mul_f32 v33, v33, v37
    v_mul_f32 v34, v34, v37
    v_mul_f32 v35, v35, v37
    v_cvt_pk_bf16_f32 v28, v28, v29
    v_cvt_pk_bf16_f32 v29, v30, v31
    v_cvt_pk_bf16_f32 v30, v32, v33
    v_cvt_pk_bf16_f32 v31, v34, v35
    v_add_u32 v36, s55, v1
    ds_write_b64 v36, v[28:29]
    ds_write_b64 v36, v[30:31] offset:512
    v_add_f32 v36, v20, v21
    v_add_f32 v36, v36, v22
    v_add_f32 v36, v36, v23
    v_add_f32 v36, v36, v24
    v_add_f32 v36, v36, v25
    v_add_f32 v36, v36, v26
    v_add_f32 v36, v36, v27
    s_nop 1
    v_add_f32_dpp v36, v36, v36 row_ror:8 row_mask:0xf bank_mask:0xf
    s_nop 1
    v_add_f32_dpp v36, v36, v36 row_ror:4 row_mask:0xf bank_mask:0xf
    s_nop 1
    v_add_f32_dpp v36, v36, v36 row_ror:2 row_mask:0xf bank_mask:0xf
    s_nop 1
    v_add_f32_dpp v36, v36, v36 row_ror:1 row_mask:0xf bank_mask:0xf
    s_nop 1
    v_add_f32_dpp v36, v36, v36 row_bcast:15 row_mask:0xa bank_mask:0xf
    s_nop 1
    v_add_f32_dpp v36, v36, v36 row_bcast:31 row_mask:0xc bank_mask:0xf
    s_nop 0
    v_readlane_b32 s63, v36, 63
    v_mov_b32 v37, 0x3b124925
    s_nop 0
    v_mul_f32 v37, s63, v37
    v_sub_f32 v28, v20, v37
    v_sub_f32 v29, v21, v37
    v_sub_f32 v30, v22, v37
    v_sub_f32 v31, v23, v37
    v_sub_f32 v32, v24, v37
    v_sub_f32 v33, v25, v37
    v_sub_f32 v34, v26, v37
    v_sub_f32 v35, v27, v37
    v_cndmask_b32 v32, 0, v32, s[66:67]
    v_cndmask_b32 v33, 0, v33, s[66:67]
    v_cndmask_b32 v34, 0, v34, s[66:67]
    v_cndmask_b32 v35, 0, v35, s[66:67]
    v_mul_f32 v36, v28, v28
    v_fmac_f32 v36, v29, v29
    v_fmac_f32 v36, v30, v30
    v_fmac_f32 v36, v31, v31
    v_fmac_f32 v36, v32, v32
    v_fmac_f32 v36, v33, v33
    v_fmac_f32 v36, v34, v34
    v_fmac_f32 v36, v35, v35
    s_nop 1
    v_add_f32_dpp v36, v36, v36 row_ror:8 row_mask:0xf bank_mask:0xf
    s_nop 1
    v_add_f32_dpp v36, v36, v36 row_ror:4 row_mask:0xf bank_mask:0xf
    s_nop 1
    v_add_f32_dpp v36, v36, v36 row_ror:2 row_mask:0xf bank_mask:0xf
    s_nop 1
    v_add_f32_dpp v36, v36, v36 row_ror:1 row_mask:0xf bank_mask:0xf
    s_nop 1
    v_add_f32_dpp v36, v36, v36 row_bcast:15 row_mask:0xa bank_mask:0xf
    s_nop 1
    v_add_f32_dpp v36, v36, v36 row_bcast:31 row_mask:0xc bank_mask:0xf
    s_nop 0
    v_readlane_b32 s63, v36, 63
    v_mov_b32 v37, 0x3b124925
    v_mov_b32 v36, 0x3727c5ac
    v_fma_f32 v37, s63, v37, v36
    v_rsq_f32 v37, v37
    s_nop 0
    v_mul_f32 v28, v28, v37
    v_mul_f32 v29, v29, v37
    v_mul_f32 v30, v30, v37
    v_mul_f32 v31, v31, v37
    v_mul_f32 v32, v32, v37
    v_mul_f32 v33, v33, v37
    v_mul_f32 v34, v34, v37
    v_mul_f32 v35, v35, v37
    v_cvt_pk_bf16_f32 v28, v28, v29
    v_cvt_pk_bf16_f32 v29, v30, v31
    v_cvt_pk_bf16_f32 v30, v32, v33
    v_cvt_pk_bf16_f32 v31, v34, v35
    v_add_u32 v36, s55, v1
    ds_write_b64 v36, v[28:29] offset:1024
    ds_write_b64 v36, v[30:31] offset:1536
    s_waitcnt lgkmcnt(0)
    v_and_b32 v76, 1, v6
    v_lshl_add_u32 v77, v76, 10, v2
    v_add_u32 v77, s55, v77
    ds_read_b128 v[80:83], v77
    ds_read_b128 v[84:87], v77 offset:64
    ds_read_b128 v[88:91], v77 offset:128
    ds_read_b128 v[92:95], v77 offset:192
    ds_read_b128 v[96:99], v77 offset:256
    ds_read_b128 v[100:103], v77 offset:320
    ds_read_b128 v[104:107], v77 offset:384
    ds_read_b128 v[108:111], v77 offset:448
    ds_read_b128 v[112:115], v77 offset:512
    ds_read_b128 v[116:119], v77 offset:576
    ds_read_b128 v[120:123], v77 offset:640
    ds_read_b128 v[124:127], v77 offset:704
    ds_read_b128 v[128:131], v77 offset:768
    ds_read_b128 v[132:135], v77 offset:832
    s_waitcnt lgkmcnt(13)
    v_mfma_f32_16x16x32_bf16 v[40:43], a[128:131], v[80:83], 0
    v_mfma_f32_16x16x32_bf16 v[44:47], a[184:187], v[80:83], 0
    s_waitcnt lgkmcnt(12)
    v_mfma_f32_16x16x32_bf16 v[40:43], a[132:135], v[84:87], v[40:43]
    v_mfma_f32_16x16x32_bf16 v[44:47], a[188:191], v[84:87], v[44:47]
    s_waitcnt lgkmcnt(11)
    v_mfma_f32_16x16x32_bf16 v[40:43], a[136:139], v[88:91], v[40:43]
    v_mfma_f32_16x16x32_bf16 v[44:47], a[192:195], v[88:91], v[44:47]
    s_waitcnt lgkmcnt(10)
    v_mfma_f32_16x16x32_bf16 v[40:43], a[140:143], v[92:95], v[40:43]
    v_mfma_f32_16x16x32_bf16 v[44:47], a[196:199], v[92:95], v[44:47]
    s_waitcnt lgkmcnt(9)
    v_mfma_f32_16x16x32_bf16 v[40:43], a[144:147], v[96:99], v[40:43]
    v_mfma_f32_16x16x32_bf16 v[44:47], a[200:203], v[96:99], v[44:47]
    s_waitcnt lgkmcnt(8)
    v_mfma_f32_16x16x32_bf16 v[40:43], a[148:151], v[100:103], v[40:43]
    v_mfma_f32_16x16x32_bf16 v[44:47], a[204:207], v[100:103], v[44:47]
    s_waitcnt lgkmcnt(7)
    v_mfma_f32_16x16x32_bf16 v[40:43], a[152:155], v[104:107], v[40:43]
    v_mfma_f32_16x16x32_bf16 v[44:47], a[208:211], v[104:107], v[44:47]
    s_waitcnt lgkmcnt(6)
    v_mfma_f32_16x16x32_bf16 v[40:43], a[156:159], v[108:111], v[40:43]
    v_mfma_f32_16x16x32_bf16 v[44:47], a[212:215], v[108:111], v[44:47]
    s_waitcnt lgkmcnt(5)
    v_mfma_f32_16x16x32_bf16 v[40:43], a[160:163], v[112:115], v[40:43]
    v_mfma_f32_16x16x32_bf16 v[44:47], a[216:219], v[112:115], v[44:47]
    s_waitcnt lgkmcnt(4)
    v_mfma_f32_16x16x32_bf16 v[40:43], a[164:167], v[116:119], v[40:43]
    v_mfma_f32_16x16x32_bf16 v[44:47], a[220:223], v[116:119], v[44:47]
    s_waitcnt lgkmcnt(3)
    v_mfma_f32_16x16x32_bf16 v[40:43], a[168:171], v[120:123], v[40:43]
    v_mfma_f32_16x16x32_bf16 v[44:47], a[224:227], v[120:123], v[44:47]
    s_waitcnt lgkmcnt(2)
    v_mfma_f32_16x16x32_bf16 v[40:43], a[172:175], v[124:127], v[40:43]
    v_mfma_f32_16x16x32_bf16 v[44:47], a[228:231], v[124:127], v[44:47]
    s_waitcnt lgkmcnt(1)
    v_mfma_f32_16x16x32_bf16 v[40:43], a[176:179], v[128:131], v[40:43]
    v_mfma_f32_16x16x32_bf16 v[44:47], a[232:235], v[128:131], v[44:47]
    s_waitcnt lgkmcnt(0)
    v_mfma_f32_16x16x32_bf16 v[40:43], a[180:183], v[132:135], v[40:43]
    v_mfma_f32_16x16x32_bf16 v[44:47], a[236:239], v[132:135], v[44:47]
    s_nop 6
    v_cvt_pk_bf16_f32 v72, v40, v41
    v_lshlrev_b32 v40, 16, v72
    v_and_b32 v41, 0xffff0000, v72
    v_cvt_pk_bf16_f32 v72, v42, v43
    v_lshlrev_b32 v42, 16, v72
    v_and_b32 v43, 0xffff0000, v72
    v_mov_b32 v48, v40
    v_mov_b32 v49, v41
    v_mov_b32 v50, v42
    v_mov_b32 v51, v43
    v_permlane16_swap_b32 v40, v48
    v_permlane16_swap_b32 v41, v49
    v_permlane16_swap_b32 v42, v50
    v_permlane16_swap_b32 v43, v51
    v_mul_f32 v40, v40, v48
    v_mul_f32 v41, v41, v49
    v_mul_f32 v42, v42, v50
    v_mul_f32 v43, v43, v51
    v_cvt_pk_bf16_f32 v56, v40, v41
    v_cvt_pk_bf16_f32 v57, v42, v43
    v_cvt_pk_bf16_f32 v72, v44, v45
    v_lshlrev_b32 v44, 16, v72
    v_and_b32 v45, 0xffff0000, v72
    v_cvt_pk_bf16_f32 v72, v46, v47
    v_lshlrev_b32 v46, 16, v72
    v_and_b32 v47, 0xffff0000, v72
    v_mov_b32 v52, v44
    v_mov_b32 v53, v45
    v_mov_b32 v54, v46
    v_mov_b32 v55, v47
    v_permlane16_swap_b32 v44, v52
    v_permlane16_swap_b32 v45, v53
    v_permlane16_swap_b32 v46, v54
    v_permlane16_swap_b32 v47, v55
    v_mul_f32 v44, v44, v52
    v_mul_f32 v45, v45, v53
    v_mul_f32 v46, v46, v54
    v_mul_f32 v47, v47, v55
    v_cvt_pk_bf16_f32 v58, v44, v45
    v_cvt_pk_bf16_f32 v59, v46, v47
    v_lshrrev_b32 v74, 5, v0
    v_lshlrev_b32 v74, 3, v74
    v_lshl_add_u32 v74, v10, 12, v74
    s_lshl_b32 s63, s48, 9
    s_add_u32 s63, s63, s97
    s_add_u32 s56, s63, 0xa0000
    s_lshl_b32 s70, s53, 5
    s_add_u32 s63, s56, s70
    s_mov_b32 s100, 3
    s_mov_b32 s101, 3
    s_mov_b64 exec, s[100:101]
    s_cmp_eq_u32 s3, 1
    s_cbranch_scc1 L40
    buffer_store_dwordx2 v[56:57], v74, s[12:15], s63 offen sc1
    buffer_store_dwordx2 v[58:59], v74, s[12:15], s63 offen offset:16 sc1
    s_branch L41
L40:
    s_nop 7
    buffer_store_dwordx2 v[56:57], v74, s[12:15], s63 offen
    buffer_store_dwordx2 v[58:59], v74, s[12:15], s63 offen offset:16
L41:
    s_nop 7
    s_mov_b64 exec, -1
    v_lshl_add_u32 v75, v10, 12, v2
L42:
    s_nop 7
    buffer_load_dwordx4 v[80:83], v75, s[12:15], s56 offen sc1
    buffer_load_dwordx4 v[84:87], v75, s[12:15], s56 offen offset:64 sc1
    buffer_load_dwordx4 v[88:91], v75, s[12:15], s56 offen offset:128 sc1
    buffer_load_dwordx4 v[92:95], v75, s[12:15], s56 offen offset:192 sc1
    buffer_load_dwordx4 v[96:99], v75, s[12:15], s56 offen offset:256 sc1
    buffer_load_dwordx4 v[100:103], v75, s[12:15], s56 offen offset:320 sc1
    buffer_load_dwordx4 v[104:107], v75, s[12:15], s56 offen offset:384 sc1
    s_waitcnt vmcnt(0)
    v_max3_u32 v74, v80, v81, v82
    v_max3_u32 v74, v74, v83, v84
    v_max3_u32 v74, v74, v85, v86
    v_max3_u32 v74, v74, v87, v88
    v_max3_u32 v74, v74, v89, v90
    v_max3_u32 v74, v74, v91, v92
    v_max3_u32 v74, v74, v93, v94
    v_max3_u32 v74, v74, v95, v96
    v_max3_u32 v74, v74, v97, v98
    v_max3_u32 v74, v74, v99, v100
    v_max3_u32 v74, v74, v101, v102
    v_max3_u32 v74, v74, v103, v104
    v_max3_u32 v74, v74, v105, v106
    v_max_u32 v74, v74, v107
    v_cmp_eq_u32 vcc, -1, v74
    s_cbranch_vccz L43
    s_sub_u32 s62, s62, 1
    s_cmp_eq_u32 s62, 0
    s_cbranch_scc1 L_end
    s_branch L42
L43:
    s_nop 7
    v_mfma_f32_16x16x32_bf16 v[40:43], v[200:203], v[80:83], 0
    v_mfma_f32_16x16x32_bf16 v[44:47], v[228:231], v[80:83], 0
    v_mfma_f32_16x16x32_bf16 v[40:43], v[204:207], v[84:87], v[40:43]
    v_mfma_f32_16x16x32_bf16 v[44:47], v[232:235], v[84:87], v[44:47]
    v_mfma_f32_16x16x32_bf16 v[40:43], v[208:211], v[88:91], v[40:43]
    v_mfma_f32_16x16x32_bf16 v[44:47], v[236:239], v[88:91], v[44:47]
    v_mfma_f32_16x16x32_bf16 v[40:43], v[212:215], v[92:95], v[40:43]
    v_mfma_f32_16x16x32_bf16 v[44:47], v[240:243], v[92:95], v[44:47]
    v_mfma_f32_16x16x32_bf16 v[40:43], v[216:219], v[96:99], v[40:43]
    v_mfma_f32_16x16x32_bf16 v[44:47], v[244:247], v[96:99], v[44:47]
    v_mfma_f32_16x16x32_bf16 v[40:43], v[220:223], v[100:103], v[40:43]
    v_mfma_f32_16x16x32_bf16 v[44:47], v[248:251], v[100:103], v[44:47]
    v_mfma_f32_16x16x32_bf16 v[40:43], v[224:227], v[104:107], v[40:43]
    v_mfma_f32_16x16x32_bf16 v[44:47], v[252:255], v[104:107], v[44:47]
    s_lshl_b32 s63, s48, 11
    s_lshl_b32 s70, s53, 7
    s_add_u32 s63, s63, s70
    s_add_u32 s63, s63, s65
    s_add_u32 s63, s63, 0xb0000
    v_lshl_add_u32 v75, v10, 14, v2
    s_mov_b64 exec, s[98:99]
    buffer_store_dwordx4 v[40:43], v75, s[12:15], s63 offen sc1
    buffer_store_dwordx4 v[44:47], v75, s[12:15], s63 offen offset:64 sc1
    s_mov_b64 exec, -1
L39:
    s_nop 7
    s_cmp_lt_u32 s61, 2
    s_cbranch_scc1 L45
    s_cmp_lg_u32 s2, 0xe0
    s_cbranch_scc1 L_end
    s_branch L46
L45:
    s_nop 7
    v_add_u32 v76, 0x10000, v4
    ds_read_b64_tr_b16 v[80:81], v4
    ds_read_b64_tr_b16 v[82:83], v4 offset:1024
    ds_read_b64_tr_b16 v[136:137], v4 offset:32
    ds_read_b64_tr_b16 v[138:139], v4 offset:1056
    ds_read_b64_tr_b16 v[84:85], v4 offset:8192
    ds_read_b64_tr_b16 v[86:87], v4 offset:9216
    ds_read_b64_tr_b16 v[140:141], v4 offset:8224
    ds_read_b64_tr_b16 v[142:143], v4 offset:9248
    ds_read_b64_tr_b16 v[88:89], v4 offset:16384
    ds_read_b64_tr_b16 v[90:91], v4 offset:17408
    ds_read_b64_tr_b16 v[144:145], v4 offset:16416
    ds_read_b64_tr_b16 v[146:147], v4 offset:17440
    ds_read_b64_tr_b16 v[92:93], v4 offset:24576
    ds_read_b64_tr_b16 v[94:95], v4 offset:25600
    ds_read_b64_tr_b16 v[148:149], v4 offset:24608
    ds_read_b64_tr_b16 v[150:151], v4 offset:25632
    ds_read_b64_tr_b16 v[96:97], v4 offset:32768
    ds_read_b64_tr_b16 v[98:99], v4 offset:33792
    ds_read_b64_tr_b16 v[152:153], v4 offset:32800
    ds_read_b64_tr_b16 v[154:155], v4 offset:33824
    ds_read_b64_tr_b16 v[100:101], v4 offset:40960
    ds_read_b64_tr_b16 v[102:103], v4 offset:41984
    ds_read_b64_tr_b16 v[156:157], v4 offset:40992
    ds_read_b64_tr_b16 v[158:159], v4 offset:42016
    ds_read_b64_tr_b16 v[104:105], v4 offset:49152
    ds_read_b64_tr_b16 v[106:107], v4 offset:50176
    ds_read_b64_tr_b16 v[160:161], v4 offset:49184
    ds_read_b64_tr_b16 v[162:163], v4 offset:50208
    ds_read_b64_tr_b16 v[108:109], v4 offset:57344
    ds_read_b64_tr_b16 v[110:111], v4 offset:58368
    ds_read_b64_tr_b16 v[164:165], v4 offset:57376
    ds_read_b64_tr_b16 v[166:167], v4 offset:58400
    ds_read_b64_tr_b16 v[112:113], v76
    ds_read_b64_tr_b16 v[114:115], v76 offset:1024
    ds_read_b64_tr_b16 v[168:169], v76 offset:32
    ds_read_b64_tr_b16 v[170:171], v76 offset:1056
    ds_read_b64_tr_b16 v[116:117], v76 offset:8192
    ds_read_b64_tr_b16 v[118:119], v76 offset:9216
    ds_read_b64_tr_b16 v[172:173], v76 offset:8224
    ds_read_b64_tr_b16 v[174:175], v76 offset:9248
    ds_read_b64_tr_b16 v[120:121], v76 offset:16384
    ds_read_b64_tr_b16 v[122:123], v76 offset:17408
    ds_read_b64_tr_b16 v[176:177], v76 offset:16416
    ds_read_b64_tr_b16 v[178:179], v76 offset:17440
    ds_read_b64_tr_b16 v[124:125], v76 offset:24576
    ds_read_b64_tr_b16 v[126:127], v76 offset:25600
    ds_read_b64_tr_b16 v[180:181], v76 offset:24608
    ds_read_b64_tr_b16 v[182:183], v76 offset:25632
    ds_read_b64_tr_b16 v[128:129], v76 offset:32768
    ds_read_b64_tr_b16 v[130:131], v76 offset:33792
    ds_read_b64_tr_b16 v[184:185], v76 offset:32800
    ds_read_b64_tr_b16 v[186:187], v76 offset:33824
    ds_read_b64_tr_b16 v[132:133], v76 offset:40960
    ds_read_b64_tr_b16 v[134:135], v76 offset:41984
    ds_read_b64_tr_b16 v[188:189], v76 offset:40992
    ds_read_b64_tr_b16 v[190:191], v76 offset:42016
    s_waitcnt lgkmcnt(0)
L46:
    s_nop 7
    s_waitcnt lgkmcnt(0)
    s_barrier
    s_lshl_b32 s63, s52, 12
    s_add_u32 s63, s63, s65
    s_add_u32 s56, s63, 0xb0000
    s_lshl_b32 s70, s23, 14
    s_add_u32 s57, s56, s70
    v_add_u32 v77, s55, v1
    v_add_u32 v77, s60, v77
    ds_read_b64 v[12:13], v77 offset:2048
    ds_read_b64 v[16:17], v77 offset:2560
    v_add_u32 v77, s55, v1
    v_add_u32 v77, s60, v77
    s_lshl_b32 s63, s23, 10
    v_add_u32 v77, s63, v77
    ds_read_b64 v[20:21], v77 offset:2048
    ds_read_b64 v[24:25], v77 offset:2560
    s_waitcnt lgkmcnt(0)
    v_and_b32 v15, 0xffff0000, v13
    v_lshlrev_b32 v14, 16, v13
    v_and_b32 v19, 0xffff0000, v17
    v_lshlrev_b32 v18, 16, v17
    v_and_b32 v13, 0xffff0000, v12
    v_lshlrev_b32 v12, 16, v12
    v_and_b32 v17, 0xffff0000, v16
    v_lshlrev_b32 v16, 16, v16
    v_and_b32 v23, 0xffff0000, v21
    v_lshlrev_b32 v22, 16, v21
    v_and_b32 v27, 0xffff0000, v25
    v_lshlrev_b32 v26, 16, v25
    v_and_b32 v21, 0xffff0000, v20
    v_lshlrev_b32 v20, 16, v20
    v_and_b32 v25, 0xffff0000, v24
    v_lshlrev_b32 v24, 16, v24
L47:
    s_nop 7
    buffer_load_dwordx4 v[40:43], v3, s[12:15], s56 offen sc1
    buffer_load_dwordx4 v[44:47], v3, s[12:15], s56 offen offset:1024 sc1
    buffer_load_dwordx4 v[48:51], v3, s[12:15], s56 offen offset:2048 sc1
    buffer_load_dwordx4 v[52:55], v3, s[12:15], s56 offen offset:3072 sc1
    buffer_load_dwordx4 v[192:195], v3, s[12:15], s57 offen sc1
    buffer_load_dwordx4 v[196:199], v3, s[12:15], s57 offen offset:1024 sc1
    buffer_load_dwordx4 v[28:31], v3, s[12:15], s57 offen offset:2048 sc1
    buffer_load_dwordx4 v[32:35], v3, s[12:15], s57 offen offset:3072 sc1
    s_waitcnt vmcnt(0)
    v_max3_u32 v74, v40, v41, v42
    v_max3_u32 v74, v74, v43, v44
    v_max3_u32 v74, v74, v45, v46
    v_max3_u32 v74, v74, v47, v48
    v_max3_u32 v74, v74, v49, v50
    v_max3_u32 v74, v74, v51, v52
    v_max3_u32 v74, v74, v53, v54
    v_max3_u32 v74, v74, v55, v192
    v_max3_u32 v74, v74, v193, v194
    v_max3_u32 v74, v74, v195, v196
    v_max3_u32 v74, v74, v197, v198
    v_max3_u32 v74, v74, v199, v28
    v_max3_u32 v74, v74, v29, v30
    v_max3_u32 v74, v74, v31, v32
    v_max3_u32 v74, v74, v33, v34
    v_max_u32 v74, v74, v35
    v_cmp_eq_u32 vcc, -1, v74
    s_cbranch_vccz L48
    s_sub_u32 s62, s62, 1
    s_cmp_eq_u32 s62, 0
    s_cbranch_scc1 L_end
    s_branch L47
L48:
    s_nop 7
    s_lshl_b32 s63, s52, 11
    s_add_u32 s63, s63, 0x20000
    v_add_u32 v77, s63, v3
    v_add_f32 v40, v40, v48
    v_add_f32 v41, v41, v49
    v_add_f32 v42, v42, v50
    v_add_f32 v43, v43, v51
    ds_write_b128 v77, v[40:43]
    v_add_f32 v44, v44, v52
    v_add_f32 v45, v45, v53
    v_add_f32 v46, v46, v54
    v_add_f32 v47, v47, v55
    ds_write_b128 v77, v[44:47] offset:1024
    v_add_f32 v192, v192, v28
    v_add_f32 v193, v193, v29
    v_add_f32 v194, v194, v30
    v_add_f32 v195, v195, v31
    ds_write_b128 v77, v[192:195] offset:8192
    v_add_f32 v196, v196, v32
    v_add_f32 v197, v197, v33
    v_add_f32 v198, v198, v34
    v_add_f32 v199, v199, v35
    ds_write_b128 v77, v[196:199] offset:9216
    s_waitcnt lgkmcnt(0)
    s_barrier
    v_add_u32 v76, 0x20000, v3
    ds_read_b128 v[40:43], v76
    ds_read_b128 v[44:47], v76 offset:1024
    ds_read_b128 v[48:51], v76 offset:2048
    ds_read_b128 v[52:55], v76 offset:3072
    ds_read_b128 v[56:59], v76 offset:4096
    ds_read_b128 v[60:63], v76 offset:5120
    ds_read_b128 v[64:67], v76 offset:6144
    ds_read_b128 v[68:71], v76 offset:7168
    s_waitcnt lgkmcnt(0)
    v_add_f32 v40, v40, v48
    v_add_f32 v41, v41, v49
    v_add_f32 v42, v42, v50
    v_add_f32 v43, v43, v51
    v_add_f32 v44, v44, v52
    v_add_f32 v45, v45, v53
    v_add_f32 v46, v46, v54
    v_add_f32 v47, v47, v55
    v_add_f32 v40, v40, v56
    v_add_f32 v41, v41, v57
    v_add_f32 v42, v42, v58
    v_add_f32 v43, v43, v59
    v_add_f32 v44, v44, v60
    v_add_f32 v45, v45, v61
    v_add_f32 v46, v46, v62
    v_add_f32 v47, v47, v63
    v_add_f32 v40, v40, v64
    v_add_f32 v41, v41, v65
    v_add_f32 v42, v42, v66
    v_add_f32 v43, v43, v67
    v_add_f32 v44, v44, v68
    v_add_f32 v45, v45, v69
    v_add_f32 v46, v46, v70
    v_add_f32 v47, v47, v71
    v_cvt_pk_bf16_f32 v72, v40, v41
    v_lshlrev_b32 v40, 16, v72
    v_and_b32 v41, 0xffff0000, v72
    v_cvt_pk_bf16_f32 v72, v42, v43
    v_lshlrev_b32 v42, 16, v72
    v_and_b32 v43, 0xffff0000, v72
    v_cvt_pk_bf16_f32 v72, v44, v45
    v_lshlrev_b32 v44, 16, v72
    v_and_b32 v45, 0xffff0000, v72
    v_cvt_pk_bf16_f32 v72, v46, v47
    v_lshlrev_b32 v46, 16, v72
    v_and_b32 v47, 0xffff0000, v72
    v_add_f32 v12, v12, v40
    v_add_f32 v13, v13, v41
    v_add_f32 v14, v14, v42
    v_add_f32 v15, v15, v43
    v_add_f32 v16, v16, v44
    v_add_f32 v17, v17, v45
    v_add_f32 v18, v18, v46
    v_add_f32 v19, v19, v47
    v_cvt_pk_bf16_f32 v72, v12, v13
    v_lshlrev_b32 v12, 16, v72
    v_and_b32 v13, 0xffff0000, v72
    v_cvt_pk_bf16_f32 v72, v14, v15
    v_lshlrev_b32 v14, 16, v72
    v_and_b32 v15, 0xffff0000, v72
    v_cvt_pk_bf16_f32 v72, v16, v17
    v_lshlrev_b32 v16, 16, v72
    v_and_b32 v17, 0xffff0000, v72
    v_cvt_pk_bf16_f32 v72, v18, v19
    v_lshlrev_b32 v18, 16, v72
    v_and_b32 v19, 0xffff0000, v72
    v_add_u32 v77, s55, v1
    v_add_u32 v77, s60, v77
    v_cvt_pk_bf16_f32 v72, v12, v13
    v_cvt_pk_bf16_f32 v73, v14, v15
    v_cvt_pk_bf16_f32 v74, v16, v17
    v_cvt_pk_bf16_f32 v75, v18, v19
    ds_write_b64 v77, v[72:73] offset:2048
    ds_write_b64 v77, v[74:75] offset:2560
    ds_read_b128 v[40:43], v76 offset:8192
    ds_read_b128 v[44:47], v76 offset:9216
    ds_read_b128 v[48:51], v76 offset:10240
    ds_read_b128 v[52:55], v76 offset:11264
    ds_read_b128 v[56:59], v76 offset:12288
    ds_read_b128 v[60:63], v76 offset:13312
    ds_read_b128 v[64:67], v76 offset:14336
    ds_read_b128 v[68:71], v76 offset:15360
    s_waitcnt lgkmcnt(0)
    v_add_f32 v40, v40, v48
    v_add_f32 v41, v41, v49
    v_add_f32 v42, v42, v50
    v_add_f32 v43, v43, v51
    v_add_f32 v44, v44, v52
    v_add_f32 v45, v45, v53
    v_add_f32 v46, v46, v54
    v_add_f32 v47, v47, v55
    v_add_f32 v40, v40, v56
    v_add_f32 v41, v41, v57
    v_add_f32 v42, v42, v58
    v_add_f32 v43, v43, v59
    v_add_f32 v44, v44, v60
    v_add_f32 v45, v45, v61
    v_add_f32 v46, v46, v62
    v_add_f32 v47, v47, v63
    v_add_f32 v40, v40, v64
    v_add_f32 v41, v41, v65
    v_add_f32 v42, v42, v66
    v_add_f32 v43, v43, v67
    v_add_f32 v44, v44, v68
    v_add_f32 v45, v45, v69
    v_add_f32 v46, v46, v70
    v_add_f32 v47, v47, v71
    v_cvt_pk_bf16_f32 v72, v40, v41
    v_lshlrev_b32 v40, 16, v72
    v_and_b32 v41, 0xffff0000, v72
    v_cvt_pk_bf16_f32 v72, v42, v43
    v_lshlrev_b32 v42, 16, v72
    v_and_b32 v43, 0xffff0000, v72
    v_cvt_pk_bf16_f32 v72, v44, v45
    v_lshlrev_b32 v44, 16, v72
    v_and_b32 v45, 0xffff0000, v72
    v_cvt_pk_bf16_f32 v72, v46, v47
    v_lshlrev_b32 v46, 16, v72
    v_and_b32 v47, 0xffff0000, v72
    v_add_f32 v20, v20, v40
    v_add_f32 v21, v21, v41
    v_add_f32 v22, v22, v42
    v_add_f32 v23, v23, v43
    v_add_f32 v24, v24, v44
    v_add_f32 v25, v25, v45
    v_add_f32 v26, v26, v46
    v_add_f32 v27, v27, v47
    v_cvt_pk_bf16_f32 v72, v20, v21
    v_lshlrev_b32 v20, 16, v72
    v_and_b32 v21, 0xffff0000, v72
    v_cvt_pk_bf16_f32 v72, v22, v23
    v_lshlrev_b32 v22, 16, v72
    v_and_b32 v23, 0xffff0000, v72
    v_cvt_pk_bf16_f32 v72, v24, v25
    v_lshlrev_b32 v24, 16, v72
    v_and_b32 v25, 0xffff0000, v72
    v_cvt_pk_bf16_f32 v72, v26, v27
    v_lshlrev_b32 v26, 16, v72
    v_and_b32 v27, 0xffff0000, v72
    v_add_u32 v77, s55, v1
    v_add_u32 v77, s60, v77
    s_lshl_b32 s63, s23, 10
    v_add_u32 v77, s63, v77
    v_cvt_pk_bf16_f32 v72, v20, v21
    v_cvt_pk_bf16_f32 v73, v22, v23
    v_cvt_pk_bf16_f32 v74, v24, v25
    v_cvt_pk_bf16_f32 v75, v26, v27
    ds_write_b64 v77, v[72:73] offset:2048
    ds_write_b64 v77, v[74:75] offset:2560
    s_cmp_ge_u32 s61, 2
    s_cbranch_scc1 L44
    v_add_f32 v36, v12, v13
    v_add_f32 v36, v36, v14
    v_add_f32 v36, v36, v15
    v_add_f32 v36, v36, v16
    v_add_f32 v36, v36, v17
    v_add_f32 v36, v36, v18
    v_add_f32 v36, v36, v19
    s_nop 1
    v_add_f32_dpp v36, v36, v36 row_ror:8 row_mask:0xf bank_mask:0xf
    s_nop 1
    v_add_f32_dpp v36, v36, v36 row_ror:4 row_mask:0xf bank_mask:0xf
    s_nop 1
    v_add_f32_dpp v36, v36, v36 row_ror:2 row_mask:0xf bank_mask:0xf
    s_nop 1
    v_add_f32_dpp v36, v36, v36 row_ror:1 row_mask:0xf bank_mask:0xf
    s_nop 1
    v_add_f32_dpp v36, v36, v36 row_bcast:15 row_mask:0xa bank_mask:0xf
    s_nop 1
    v_add_f32_dpp v36, v36, v36 row_bcast:31 row_mask:0xc bank_mask:0xf
    s_nop 0
    v_readlane_b32 s63, v36, 63
    v_mov_b32 v37, 0x3b124925
    s_nop 0
    v_mul_f32 v37, s63, v37
    v_sub_f32 v28, v12, v37
    v_sub_f32 v29, v13, v37
    v_sub_f32 v30, v14, v37
    v_sub_f32 v31, v15, v37
    v_sub_f32 v32, v16, v37
    v_sub_f32 v33, v17, v37
    v_sub_f32 v34, v18, v37
    v_sub_f32 v35, v19, v37
    v_cndmask_b32 v32, 0, v32, s[66:67]
    v_cndmask_b32 v33, 0, v33, s[66:67]
    v_cndmask_b32 v34, 0, v34, s[66:67]
    v_cndmask_b32 v35, 0, v35, s[66:67]
    v_mul_f32 v36, v28, v28
    v_fmac_f32 v36, v29, v29
    v_fmac_f32 v36, v30, v30
    v_fmac_f32 v36, v31, v31
    v_fmac_f32 v36, v32, v32
    v_fmac_f32 v36, v33, v33
    v_fmac_f32 v36, v34, v34
    v_fmac_f32 v36, v35, v35
    s_nop 1
    v_add_f32_dpp v36, v36, v36 row_ror:8 row_mask:0xf bank_mask:0xf
    s_nop 1
    v_add_f32_dpp v36, v36, v36 row_ror:4 row_mask:0xf bank_mask:0xf
    s_nop 1
    v_add_f32_dpp v36, v36, v36 row_ror:2 row_mask:0xf bank_mask:0xf
    s_nop 1
    v_add_f32_dpp v36, v36, v36 row_ror:1 row_mask:0xf bank_mask:0xf
    s_nop 1
    v_add_f32_dpp v36, v36, v36 row_bcast:15 row_mask:0xa bank_mask:0xf
    s_nop 1
    v_add_f32_dpp v36, v36, v36 row_bcast:31 row_mask:0xc bank_mask:0xf
    s_nop 0
    v_readlane_b32 s63, v36, 63
    v_mov_b32 v37, 0x3b124925
    v_mov_b32 v36, 0x3727c5ac
    v_fma_f32 v37, s63, v37, v36
    v_rsq_f32 v37, v37
    s_nop 0
    v_mul_f32 v28, v28, v37
    v_mul_f32 v29, v29, v37
    v_mul_f32 v30, v30, v37
    v_mul_f32 v31, v31, v37
    v_mul_f32 v32, v32, v37
    v_mul_f32 v33, v33, v37
    v_mul_f32 v34, v34, v37
    v_mul_f32 v35, v35, v37
    v_cvt_pk_bf16_f32 v28, v28, v29
    v_cvt_pk_bf16_f32 v29, v30, v31
    v_cvt_pk_bf16_f32 v30, v32, v33
    v_cvt_pk_bf16_f32 v31, v34, v35
    v_add_u32 v36, s55, v1
    ds_write_b64 v36, v[28:29]
    ds_write_b64 v36, v[30:31] offset:512
    s_waitcnt lgkmcnt(0)
    v_add_u32 v77, s55, v2
    ds_read_b128 v[48:51], v77
    ds_read_b128 v[52:55], v77 offset:64
    ds_read_b128 v[56:59], v77 offset:128
    ds_read_b128 v[60:63], v77 offset:192
    ds_read_b128 v[64:67], v77 offset:256
    ds_read_b128 v[68:71], v77 offset:320
    s_waitcnt lgkmcnt(5)
    v_mfma_f32_16x16x32_bf16 v[40:43], v[80:83], v[48:51], 0
    v_mfma_f32_16x16x32_bf16 v[44:47], v[136:139], v[48:51], 0
    ds_read_b128 v[48:51], v77 offset:384
    s_waitcnt lgkmcnt(5)
    v_mfma_f32_16x16x32_bf16 v[40:43], v[84:87], v[52:55], v[40:43]
    v_mfma_f32_16x16x32_bf16 v[44:47], v[140:143], v[52:55], v[44:47]
    ds_read_b128 v[52:55], v77 offset:448
    s_waitcnt lgkmcnt(5)
    v_mfma_f32_16x16x32_bf16 v[40:43], v[88:91], v[56:59], v[40:43]
    v_mfma_f32_16x16x32_bf16 v[44:47], v[144:147], v[56:59], v[44:47]
    ds_read_b128 v[56:59], v77 offset:512
    s_waitcnt lgkmcnt(5)
    v_mfma_f32_16x16x32_bf16 v[40:43], v[92:95], v[60:63], v[40:43]
    v_mfma_f32_16x16x32_bf16 v[44:47], v[148:151], v[60:63], v[44:47]
    ds_read_b128 v[60:63], v77 offset:576
    s_waitcnt lgkmcnt(5)
    v_mfma_f32_16x16x32_bf16 v[40:43], v[96:99], v[64:67], v[40:43]
    v_mfma_f32_16x16x32_bf16 v[44:47], v[152:155], v[64:67], v[44:47]
    ds_read_b128 v[64:67], v77 offset:640
    s_waitcnt lgkmcnt(5)
    v_mfma_f32_16x16x32_bf16 v[40:43], v[100:103], v[68:71], v[40:43]
    v_mfma_f32_16x16x32_bf16 v[44:47], v[156:159], v[68:71], v[44:47]
    ds_read_b128 v[68:71], v77 offset:704
    s_waitcnt lgkmcnt(5)
    v_mfma_f32_16x16x32_bf16 v[40:43], v[104:107], v[48:51], v[40:43]
    v_mfma_f32_16x16x32_bf16 v[44:47], v[160:163], v[48:51], v[44:47]
    ds_read_b128 v[48:51], v77 offset:768
    s_waitcnt lgkmcnt(5)
    v_mfma_f32_16x16x32_bf16 v[40:43], v[108:111], v[52:55], v[40:43]
    v_mfma_f32_16x16x32_bf16 v[44:47], v[164:167], v[52:55], v[44:47]
    ds_read_b128 v[52:55], v77 offset:832
    s_waitcnt lgkmcnt(5)
    v_mfma_f32_16x16x32_bf16 v[40:43], v[112:115], v[56:59], v[40:43]
    v_mfma_f32_16x16x32_bf16 v[44:47], v[168:171], v[56:59], v[44:47]
    s_waitcnt lgkmcnt(4)
    v_mfma_f32_16x16x32_bf16 v[40:43], v[116:119], v[60:63], v[40:43]
    v_mfma_f32_16x16x32_bf16 v[44:47], v[172:175], v[60:63], v[44:47]
    s_waitcnt lgkmcnt(3)
    v_mfma_f32_16x16x32_bf16 v[40:43], v[120:123], v[64:67], v[40:43]
    v_mfma_f32_16x16x32_bf16 v[44:47], v[176:179], v[64:67], v[44:47]
    s_waitcnt lgkmcnt(2)
    v_mfma_f32_16x16x32_bf16 v[40:43], v[124:127], v[68:71], v[40:43]
    v_mfma_f32_16x16x32_bf16 v[44:47], v[180:183], v[68:71], v[44:47]
    s_waitcnt lgkmcnt(1)
    v_mfma_f32_16x16x32_bf16 v[40:43], v[128:131], v[48:51], v[40:43]
    v_mfma_f32_16x16x32_bf16 v[44:47], v[184:187], v[48:51], v[44:47]
    s_waitcnt lgkmcnt(0)
    v_mfma_f32_16x16x32_bf16 v[40:43], v[132:135], v[52:55], v[40:43]
    v_mfma_f32_16x16x32_bf16 v[44:47], v[188:191], v[52:55], v[44:47]
    s_nop 6
    v_cvt_pk_bf16_f32 v38, v40, v41
    v_cvt_pk_bf16_f32 v39, v42, v43
    v_cvt_pk_bf16_f32 v72, v44, v45
    v_cvt_pk_bf16_f32 v73, v46, v47
    v_lshrrev_b32 v74, 1, v2
    s_lshl_b32 s63, s48, 10
    s_lshl_b32 s70, s53, 6
    s_add_u32 s63, s63, s70
    s_add_u32 s63, s63, s21
    s_add_u32 s63, s63, 0x4000
    s_mov_b64 exec, s[24:25]
    s_cmp_eq_u32 s3, 1
    s_cbranch_scc1 L49
    buffer_store_dwordx2 v[38:39], v74, s[12:15], s63 offen sc1
    buffer_store_dwordx2 v[72:73], v74, s[12:15], s63 offen offset:32 sc1
    s_branch L50
L49:
    s_nop 7
    buffer_store_dwordx2 v[38:39], v74, s[12:15], s63 offen
    buffer_store_dwordx2 v[72:73], v74, s[12:15], s63 offen offset:32
L50:
    s_nop 7
    s_mov_b64 exec, -1
    s_waitcnt lgkmcnt(0)
    s_barrier
    s_add_u32 s61, s61, 1
    s_branch L_it
L44:
    s_nop 7
    s_cmp_lg_u32 s52, 0
    s_cbranch_scc1 L_end
    v_cvt_pk_bf16_f32 v48, v12, v13
    v_cvt_pk_bf16_f32 v49, v14, v15
    v_cvt_pk_bf16_f32 v50, v16, v17
    v_cvt_pk_bf16_f32 v51, v18, v19
    buffer_store_dwordx2 v[48:49], v1, s[44:47], 0 offen
    s_mov_b64 exec, s[66:67]
    buffer_store_dwordx2 v[50:51], v1, s[44:47], 0 offen offset:512
    s_mov_b64 exec, -1
    v_cvt_pk_bf16_f32 v52, v20, v21
    v_cvt_pk_bf16_f32 v53, v22, v23
    v_cvt_pk_bf16_f32 v54, v24, v25
    v_cvt_pk_bf16_f32 v55, v26, v27
    buffer_store_dwordx2 v[52:53], v1, s[44:47], 0 offen offset:896
    s_mov_b64 exec, s[66:67]
    buffer_store_dwordx2 v[54:55], v1, s[44:47], 0 offen offset:1408
    s_mov_b64 exec, -1
    s_waitcnt vmcnt(0)
L_end:
    s_endpgm
.section .rodata,"a"
.p2align 6
.amdhsa_kernel interleave_layers__mha_block_cached__glu_gated_bilinear__decode_kernel
  .amdhsa_next_free_vgpr 512
  .amdhsa_next_free_sgpr 102
  .amdhsa_accum_offset 256
  .amdhsa_group_segment_fixed_size 0
  .amdhsa_kernarg_size 96
  .amdhsa_user_sgpr_count 2
  .amdhsa_user_sgpr_kernarg_segment_ptr 1
  .amdhsa_system_sgpr_workgroup_id_x 1
.end_amdhsa_kernel
```
